```python
import torch

def _softmax(x, axis=-1):
    return torch.softmax(x, dim=axis)

def _gelu(x):
    return torch.nn.functional.gelu(x, approximate='tanh')

def _silu(x):
    return torch.nn.functional.silu(x)

def _sigmoid(x):
    return torch.sigmoid(x)

def _layernorm(x, axis=-1, eps=1e-05):
    m = x.mean(dim=axis, keepdim=True)
    v = x.var(dim=axis, keepdim=True, unbiased=False)
    return (x - m) / torch.sqrt(v + eps)

def _scatter_add(tgt, idx, src, axis=0):
    return tgt.clone().index_add_(axis, idx, src)

def _segment_sum(src, seg, n):
    out = torch.zeros((n,) + src.shape[1:], dtype=src.dtype)
    return out.index_add_(0, seg, src)

def _pad(x, pw):
    flat = tuple((v for pair in reversed(pw) for v in pair))
    return torch.nn.functional.pad(x, flat)
kernel_name = 'standalone__window_attn_davit__vision'

def setup_inputs():

    _w = lambda a: (lambda t: t.to(torch.bfloat16) if t.is_floating_point() else t)(torch.as_tensor(a))
    HW = 384
    C0 = 384
    ws = 7
    nh = 4
    H = W = max(HW // ws * ws, ws)
    C = max(C0 // nh * nh, nh)
    k = 3
    return {'x': _w((lambda *s: torch.randn(*s, dtype=torch.bfloat16) * 1.6)(1, H, W, C)), 'dw_pe': _w((lambda *s: torch.randn(*s, dtype=torch.bfloat16) * 1.6)(k, k, C) * 0.1), 'w_qkv': _w((lambda *s: torch.randn(*s, dtype=torch.bfloat16) * 1.6)(C, 3 * C) * C ** (-0.5)), 'w_o': _w((lambda *s: torch.randn(*s, dtype=torch.bfloat16) * 0.8)(C, C) * C ** (-0.5))}

def reference(x, dw_pe, w_qkv, w_o):
    B, H, W, C = x.shape
    ws = 7
    nh = 4
    dh = C // nh
    kk = dw_pe.shape[0]
    pad = kk // 2
    xp = _pad(x, ((0, 0), (pad, pad), (pad, pad), (0, 0)))
    pe = torch.zeros_like(x)
    for i in range(kk):
        for j in range(kk):
            pe = pe + xp[:, i:i + H, j:j + W, :] * dw_pe[i, j][None, None, None, :]
    x0 = x + pe
    h = _layernorm(x0, axis=-1)
    hw = h.reshape(B, H // ws, ws, W // ws, ws, C)
    hw = (lambda x, *d: x.permute(*d))(hw, 0, 1, 3, 2, 4, 5)
    hw = hw.reshape(-1, ws * ws, C)
    qkv = (hw @ w_qkv).reshape(-1, ws * ws, 3, nh, dh)
    q = qkv[:, :, 0].clone()
    k = qkv[:, :, 1].clone()
    v = qkv[:, :, 2].clone()
    scale = dh ** (-0.5)
    attn = torch.einsum('wnhd,wmhd->whnm', q, k) * scale
    attn = _softmax(attn, axis=-1)
    out = torch.einsum('whnm,wmhd->wnhd', attn, v)
    out = out.reshape(-1, ws * ws, C) @ w_o
    out = out.reshape(B, H // ws, W // ws, ws, ws, C)
    out = (lambda x, *d: x.permute(*d))(out, 0, 1, 3, 2, 4, 5)
    out = out.reshape(B, H, W, C)
    return x0 + out
```

```asm
; @launch grid=(255,1,1) block=(256,1,1) lds=163840
.amdgcn_target "amdgcn-amd-amdhsa--gfx950"
.macro wl n
s_waitcnt lgkmcnt(\n)
.endm
.macro dm v,r,s,o
buffer_load_dwordx4 v\v, s[\r:\r+3], s\s offen offset:\o lds
.endm
.macro wv n
s_waitcnt vmcnt(\n)
.endm
.macro mvvvz d,a,b
v_mfma_f32_16x16x32_bf16 v[\d:\d+3], v[\a:\a+3], v[\b:\b+3], 0
.endm
.macro mvvvc d,a,b
v_mfma_f32_16x16x32_bf16 v[\d:\d+3], v[\a:\a+3], v[\b:\b+3], v[\d:\d+3]
.endm
.macro cv d,x,y
v_cvt_pk_bf16_f32 v\d, v\x, v\y
.endm
.macro rv d,a,o
ds_read_b128 v[\d:\d+3], v\a offset:\o
.endm
.macro mu d,x,y
v_mul_f32 v\d, v\x, v\y
.endm
.macro ad d,x,y
v_add_f32 v\d, v\x, v\y
.endm
.macro aw d,x
v_accvgpr_write_b32 a\d, v\x
.endm
.macro ra d,a,o
ds_read_b128 a[\d:\d+3], v\a offset:\o
.endm
.macro mvaaz d,a,b
v_mfma_f32_16x16x32_bf16 v[\d:\d+3], a[\a:\a+3], a[\b:\b+3], 0
.endm
.macro mvaac d,a,b
v_mfma_f32_16x16x32_bf16 v[\d:\d+3], a[\a:\a+3], a[\b:\b+3], v[\d:\d+3]
.endm
.macro mx d,x,y
v_max_f32 v\d, v\x, v\y
.endm
.macro ex d,x
v_exp_f32 v\d, v\x
.endm
.macro mvvac d,a,b
v_mfma_f32_16x16x32_bf16 v[\d:\d+3], v[\a:\a+3], a[\b:\b+3], v[\d:\d+3]
.endm
.macro ar d,x
v_accvgpr_read_b32 v\d, a\x
.endm
.macro mvavc d,a,b
v_mfma_f32_16x16x32_bf16 v[\d:\d+3], a[\a:\a+3], v[\b:\b+3], v[\d:\d+3]
.endm
.text
.globl standalone__window_attn_davit__vision_kernel
.p2align 8
.type standalone__window_attn_davit__vision_kernel,@function
standalone__window_attn_davit__vision_kernel:
s_cmp_lt_u32 s2, 255
s_cbranch_scc1 L_go
s_endpgm
L_go:
s_load_dwordx2 s[4:5], s[0:1], 40
s_load_dwordx2 s[6:7], s[0:1], 32
s_load_dwordx2 s[38:39], s[0:1], 48
s_load_dwordx4 s[40:43], s[0:1], 8
s_load_dwordx2 s[44:45], s[0:1], 24
s_load_dwordx2 s[46:47], s[0:1], 0
wl 0
s_mov_b32 s8, s46
s_mov_b32 s9, s47
s_mov_b32 s10, 0x68a6c00
s_mov_b32 s11, 0x20000
s_mov_b32 s16, s6
s_mov_b32 s17, s7
s_mov_b32 s18, 0x68a6c00
s_mov_b32 s19, 0x20000
s_mov_b32 s12, s38
s_mov_b32 s13, s39
s_mov_b32 s14, 0x1100000
s_mov_b32 s15, 0x20000
s_mov_b32 s6, 0x100
s_mov_b32 s7, 0x20000
v_lshrrev_b32 v26, 6, v0
v_and_b32 v0, 63, v0
v_readfirstlane_b32 s20, v26
v_lshlrev_b32 v1, 4, v0
s_cmp_ge_u32 s2, 12
s_cbranch_scc1 L_main
L_prep:
s_and_b32 s30, s2, 3
s_lshr_b32 s31, s2, 2
s_mov_b32 s24, s42
s_mov_b32 s25, s43
s_mov_b32 s26, 0xd8000
s_mov_b32 s27, 0x20000
s_cmp_eq_u32 s31, 0
s_cselect_b32 s32, 0x180, 0
s_cmp_eq_u32 s31, 2
s_cselect_b32 s32, 0x300, s32
s_mul_i32 s33, s30, 0x60
s_add_u32 s32, s32, s33
s_lshl_b32 s32, s32, 1
s_mul_i32 s33, s30, 18
s_mul_i32 s34, s31, 6
s_add_u32 s33, s33, s34
s_mul_i32 s35, s20, 18
s_mov_b32 s36, 0x1556
s_mov_b32 s37, 0x900
s_add_u32 s38, s35, 0
s_lshl_b32 s39, s38, 6
v_add_u32 v4, s39, v0
v_mul_u32_u24 v5, s36, v4
v_lshrrev_b32 v5, 16, v5
v_mul_u32_u24 v6, 12, v5
v_sub_u32 v6, v4, v6
v_mul_u32_u24 v8, s37, v5
v_lshl_add_u32 v8, v6, 4, v8
s_lshl_b32 m0, s38, 10
s_nop 0
dm 8,24,32,0
s_add_u32 s38, s35, 1
s_lshl_b32 s39, s38, 6
v_add_u32 v4, s39, v0
v_mul_u32_u24 v5, s36, v4
v_lshrrev_b32 v5, 16, v5
v_mul_u32_u24 v6, 12, v5
v_sub_u32 v6, v4, v6
v_mul_u32_u24 v9, s37, v5
v_lshl_add_u32 v9, v6, 4, v9
s_lshl_b32 m0, s38, 10
s_nop 0
dm 9,24,32,0
s_add_u32 s38, s35, 2
s_lshl_b32 s39, s38, 6
v_add_u32 v4, s39, v0
v_mul_u32_u24 v5, s36, v4
v_lshrrev_b32 v5, 16, v5
v_mul_u32_u24 v6, 12, v5
v_sub_u32 v6, v4, v6
v_mul_u32_u24 v10, s37, v5
v_lshl_add_u32 v10, v6, 4, v10
s_lshl_b32 m0, s38, 10
s_nop 0
dm 10,24,32,0
s_add_u32 s38, s35, 3
s_lshl_b32 s39, s38, 6
v_add_u32 v4, s39, v0
v_mul_u32_u24 v5, s36, v4
v_lshrrev_b32 v5, 16, v5
v_mul_u32_u24 v6, 12, v5
v_sub_u32 v6, v4, v6
v_mul_u32_u24 v11, s37, v5
v_lshl_add_u32 v11, v6, 4, v11
s_lshl_b32 m0, s38, 10
s_nop 0
dm 11,24,32,0
s_add_u32 s38, s35, 4
s_lshl_b32 s39, s38, 6
v_add_u32 v4, s39, v0
v_mul_u32_u24 v5, s36, v4
v_lshrrev_b32 v5, 16, v5
v_mul_u32_u24 v6, 12, v5
v_sub_u32 v6, v4, v6
v_mul_u32_u24 v12, s37, v5
v_lshl_add_u32 v12, v6, 4, v12
s_lshl_b32 m0, s38, 10
s_nop 0
dm 12,24,32,0
s_add_u32 s38, s35, 5
s_lshl_b32 s39, s38, 6
v_add_u32 v4, s39, v0
v_mul_u32_u24 v5, s36, v4
v_lshrrev_b32 v5, 16, v5
v_mul_u32_u24 v6, 12, v5
v_sub_u32 v6, v4, v6
v_mul_u32_u24 v13, s37, v5
v_lshl_add_u32 v13, v6, 4, v13
s_lshl_b32 m0, s38, 10
s_nop 0
dm 13,24,32,0
s_add_u32 s38, s35, 6
s_lshl_b32 s39, s38, 6
v_add_u32 v4, s39, v0
v_mul_u32_u24 v5, s36, v4
v_lshrrev_b32 v5, 16, v5
v_mul_u32_u24 v6, 12, v5
v_sub_u32 v6, v4, v6
v_mul_u32_u24 v14, s37, v5
v_lshl_add_u32 v14, v6, 4, v14
s_lshl_b32 m0, s38, 10
s_nop 0
dm 14,24,32,0
s_add_u32 s38, s35, 7
s_lshl_b32 s39, s38, 6
v_add_u32 v4, s39, v0
v_mul_u32_u24 v5, s36, v4
v_lshrrev_b32 v5, 16, v5
v_mul_u32_u24 v6, 12, v5
v_sub_u32 v6, v4, v6
v_mul_u32_u24 v15, s37, v5
v_lshl_add_u32 v15, v6, 4, v15
s_lshl_b32 m0, s38, 10
s_nop 0
dm 15,24,32,0
s_add_u32 s38, s35, 8
s_lshl_b32 s39, s38, 6
v_add_u32 v4, s39, v0
v_mul_u32_u24 v5, s36, v4
v_lshrrev_b32 v5, 16, v5
v_mul_u32_u24 v6, 12, v5
v_sub_u32 v6, v4, v6
v_mul_u32_u24 v16, s37, v5
v_lshl_add_u32 v16, v6, 4, v16
s_lshl_b32 m0, s38, 10
s_nop 0
dm 16,24,32,0
s_add_u32 s38, s35, 9
s_lshl_b32 s39, s38, 6
v_add_u32 v4, s39, v0
v_mul_u32_u24 v5, s36, v4
v_lshrrev_b32 v5, 16, v5
v_mul_u32_u24 v6, 12, v5
v_sub_u32 v6, v4, v6
v_mul_u32_u24 v17, s37, v5
v_lshl_add_u32 v17, v6, 4, v17
s_lshl_b32 m0, s38, 10
s_nop 0
dm 17,24,32,0
s_add_u32 s38, s35, 10
s_lshl_b32 s39, s38, 6
v_add_u32 v4, s39, v0
v_mul_u32_u24 v5, s36, v4
v_lshrrev_b32 v5, 16, v5
v_mul_u32_u24 v6, 12, v5
v_sub_u32 v6, v4, v6
v_mul_u32_u24 v18, s37, v5
v_lshl_add_u32 v18, v6, 4, v18
s_lshl_b32 m0, s38, 10
s_nop 0
dm 18,24,32,0
s_add_u32 s38, s35, 11
s_lshl_b32 s39, s38, 6
v_add_u32 v4, s39, v0
v_mul_u32_u24 v5, s36, v4
v_lshrrev_b32 v5, 16, v5
v_mul_u32_u24 v6, 12, v5
v_sub_u32 v6, v4, v6
v_mul_u32_u24 v19, s37, v5
v_lshl_add_u32 v19, v6, 4, v19
s_lshl_b32 m0, s38, 10
s_nop 0
dm 19,24,32,0
s_add_u32 s38, s35, 12
s_lshl_b32 s39, s38, 6
v_add_u32 v4, s39, v0
v_mul_u32_u24 v5, s36, v4
v_lshrrev_b32 v5, 16, v5
v_mul_u32_u24 v6, 12, v5
v_sub_u32 v6, v4, v6
v_mul_u32_u24 v20, s37, v5
v_lshl_add_u32 v20, v6, 4, v20
s_lshl_b32 m0, s38, 10
s_nop 0
dm 20,24,32,0
s_add_u32 s38, s35, 13
s_lshl_b32 s39, s38, 6
v_add_u32 v4, s39, v0
v_mul_u32_u24 v5, s36, v4
v_lshrrev_b32 v5, 16, v5
v_mul_u32_u24 v6, 12, v5
v_sub_u32 v6, v4, v6
v_mul_u32_u24 v21, s37, v5
v_lshl_add_u32 v21, v6, 4, v21
s_lshl_b32 m0, s38, 10
s_nop 0
dm 21,24,32,0
s_add_u32 s38, s35, 14
s_lshl_b32 s39, s38, 6
v_add_u32 v4, s39, v0
v_mul_u32_u24 v5, s36, v4
v_lshrrev_b32 v5, 16, v5
v_mul_u32_u24 v6, 12, v5
v_sub_u32 v6, v4, v6
v_mul_u32_u24 v22, s37, v5
v_lshl_add_u32 v22, v6, 4, v22
s_lshl_b32 m0, s38, 10
s_nop 0
dm 22,24,32,0
s_add_u32 s38, s35, 15
s_lshl_b32 s39, s38, 6
v_add_u32 v4, s39, v0
v_mul_u32_u24 v5, s36, v4
v_lshrrev_b32 v5, 16, v5
v_mul_u32_u24 v6, 12, v5
v_sub_u32 v6, v4, v6
v_mul_u32_u24 v23, s37, v5
v_lshl_add_u32 v23, v6, 4, v23
s_lshl_b32 m0, s38, 10
s_nop 0
dm 23,24,32,0
s_add_u32 s38, s35, 16
s_lshl_b32 s39, s38, 6
v_add_u32 v4, s39, v0
v_mul_u32_u24 v5, s36, v4
v_lshrrev_b32 v5, 16, v5
v_mul_u32_u24 v6, 12, v5
v_sub_u32 v6, v4, v6
v_mul_u32_u24 v24, s37, v5
v_lshl_add_u32 v24, v6, 4, v24
s_lshl_b32 m0, s38, 10
s_nop 0
dm 24,24,32,0
s_add_u32 s38, s35, 17
s_lshl_b32 s39, s38, 6
v_add_u32 v4, s39, v0
v_mul_u32_u24 v5, s36, v4
v_lshrrev_b32 v5, 16, v5
v_mul_u32_u24 v6, 12, v5
v_sub_u32 v6, v4, v6
v_mul_u32_u24 v25, s37, v5
v_lshl_add_u32 v25, v6, 4, v25
s_lshl_b32 m0, s38, 10
s_nop 0
dm 25,24,32,0
wv 0
s_barrier
s_mov_b32 s46, s20
s_add_u32 s48, s33, s46
s_mul_i32 s48, s48, 0x3000
v_lshrrev_b32 v4, 4, v0
v_bfe_u32 v5, v0, 2, 2
v_and_b32 v6, 3, v0
v_lshrrev_b32 v7, 1, v5
v_lshlrev_b32 v7, 4, v7
v_and_b32 v8, 1, v5
v_add_u32 v7, v7, v8
v_lshl_add_u32 v7, v4, 2, v7
v_mul_u32_u24 v7, 0xc0, v7
v_lshl_add_u32 v7, v6, 3, v7
s_lshl_b32 s47, s46, 5
v_add_u32 v7, s47, v7
v_add_u32 v8, 0xc000, v7
v_mov_b32 v12, 0x3f803f80
v_mov_b32 v13, 0x3f803f80
v_mov_b32 v14, 0x3f803f80
v_mov_b32 v15, 0x3f803f80
ds_read_b64_tr_b16 v[64:65], v7 offset:0
ds_read_b64_tr_b16 v[66:67], v7 offset:6144
ds_read_b64_tr_b16 v[68:69], v7 offset:384
ds_read_b64_tr_b16 v[70:71], v7 offset:6528
ds_read_b64_tr_b16 v[72:73], v7 offset:12288
ds_read_b64_tr_b16 v[74:75], v7 offset:18432
ds_read_b64_tr_b16 v[76:77], v7 offset:12672
ds_read_b64_tr_b16 v[78:79], v7 offset:18816
ds_read_b64_tr_b16 v[80:81], v7 offset:24576
ds_read_b64_tr_b16 v[82:83], v7 offset:30720
ds_read_b64_tr_b16 v[84:85], v7 offset:24960
ds_read_b64_tr_b16 v[86:87], v7 offset:31104
ds_read_b64_tr_b16 v[88:89], v7 offset:36864
ds_read_b64_tr_b16 v[90:91], v7 offset:43008
ds_read_b64_tr_b16 v[92:93], v7 offset:37248
ds_read_b64_tr_b16 v[94:95], v7 offset:43392
ds_read_b64_tr_b16 v[96:97], v8 offset:0
ds_read_b64_tr_b16 v[98:99], v8 offset:6144
ds_read_b64_tr_b16 v[100:101], v8 offset:384
ds_read_b64_tr_b16 v[102:103], v8 offset:6528
ds_read_b64_tr_b16 v[104:105], v8 offset:12288
ds_read_b64_tr_b16 v[106:107], v8 offset:18432
ds_read_b64_tr_b16 v[108:109], v8 offset:12672
ds_read_b64_tr_b16 v[110:111], v8 offset:18816
wl 15
mvvvz 16,12,64
mvvvc 16,12,68
mvvvc 16,12,72
mvvvc 16,12,76
wl 14
mvvvc 16,12,80
wl 12
mvvvc 16,12,84
wl 10
mvvvc 16,12,88
wl 8
mvvvc 16,12,92
wl 6
mvvvc 16,12,96
wl 4
mvvvc 16,12,100
wl 2
mvvvc 16,12,104
wl 0
mvvvc 16,12,108
s_nop 8
v_mul_f32 v20, 0x3b2aaaab, v16
v_lshlrev_b32 v24, 16, v64
v_and_b32 v25, 0xffff0000, v64
v_sub_f32 v24, v24, v20
v_sub_f32 v25, v25, v20
cv 64,24,25
v_lshlrev_b32 v26, 16, v65
v_and_b32 v27, 0xffff0000, v65
v_sub_f32 v26, v26, v20
v_sub_f32 v27, v27, v20
cv 65,26,27
v_lshlrev_b32 v28, 16, v66
v_and_b32 v29, 0xffff0000, v66
v_sub_f32 v28, v28, v20
v_sub_f32 v29, v29, v20
cv 66,28,29
v_lshlrev_b32 v30, 16, v67
v_and_b32 v31, 0xffff0000, v67
v_sub_f32 v30, v30, v20
v_sub_f32 v31, v31, v20
cv 67,30,31
v_lshlrev_b32 v24, 16, v68
v_and_b32 v25, 0xffff0000, v68
v_sub_f32 v24, v24, v20
v_sub_f32 v25, v25, v20
cv 68,24,25
v_lshlrev_b32 v26, 16, v69
v_and_b32 v27, 0xffff0000, v69
v_sub_f32 v26, v26, v20
v_sub_f32 v27, v27, v20
cv 69,26,27
v_lshlrev_b32 v28, 16, v70
v_and_b32 v29, 0xffff0000, v70
v_sub_f32 v28, v28, v20
v_sub_f32 v29, v29, v20
cv 70,28,29
v_lshlrev_b32 v30, 16, v71
v_and_b32 v31, 0xffff0000, v71
v_sub_f32 v30, v30, v20
v_sub_f32 v31, v31, v20
cv 71,30,31
v_lshlrev_b32 v24, 16, v72
v_and_b32 v25, 0xffff0000, v72
v_sub_f32 v24, v24, v20
v_sub_f32 v25, v25, v20
cv 72,24,25
v_lshlrev_b32 v26, 16, v73
v_and_b32 v27, 0xffff0000, v73
v_sub_f32 v26, v26, v20
v_sub_f32 v27, v27, v20
cv 73,26,27
v_lshlrev_b32 v28, 16, v74
v_and_b32 v29, 0xffff0000, v74
v_sub_f32 v28, v28, v20
v_sub_f32 v29, v29, v20
cv 74,28,29
v_lshlrev_b32 v30, 16, v75
v_and_b32 v31, 0xffff0000, v75
v_sub_f32 v30, v30, v20
v_sub_f32 v31, v31, v20
cv 75,30,31
v_lshlrev_b32 v24, 16, v76
v_and_b32 v25, 0xffff0000, v76
v_sub_f32 v24, v24, v20
v_sub_f32 v25, v25, v20
cv 76,24,25
v_lshlrev_b32 v26, 16, v77
v_and_b32 v27, 0xffff0000, v77
v_sub_f32 v26, v26, v20
v_sub_f32 v27, v27, v20
cv 77,26,27
v_lshlrev_b32 v28, 16, v78
v_and_b32 v29, 0xffff0000, v78
v_sub_f32 v28, v28, v20
v_sub_f32 v29, v29, v20
cv 78,28,29
v_lshlrev_b32 v30, 16, v79
v_and_b32 v31, 0xffff0000, v79
v_sub_f32 v30, v30, v20
v_sub_f32 v31, v31, v20
cv 79,30,31
v_lshlrev_b32 v24, 16, v80
v_and_b32 v25, 0xffff0000, v80
v_sub_f32 v24, v24, v20
v_sub_f32 v25, v25, v20
cv 80,24,25
v_lshlrev_b32 v26, 16, v81
v_and_b32 v27, 0xffff0000, v81
v_sub_f32 v26, v26, v20
v_sub_f32 v27, v27, v20
cv 81,26,27
v_lshlrev_b32 v28, 16, v82
v_and_b32 v29, 0xffff0000, v82
v_sub_f32 v28, v28, v20
v_sub_f32 v29, v29, v20
cv 82,28,29
v_lshlrev_b32 v30, 16, v83
v_and_b32 v31, 0xffff0000, v83
v_sub_f32 v30, v30, v20
v_sub_f32 v31, v31, v20
cv 83,30,31
v_lshlrev_b32 v24, 16, v84
v_and_b32 v25, 0xffff0000, v84
v_sub_f32 v24, v24, v20
v_sub_f32 v25, v25, v20
cv 84,24,25
v_lshlrev_b32 v26, 16, v85
v_and_b32 v27, 0xffff0000, v85
v_sub_f32 v26, v26, v20
v_sub_f32 v27, v27, v20
cv 85,26,27
v_lshlrev_b32 v28, 16, v86
v_and_b32 v29, 0xffff0000, v86
v_sub_f32 v28, v28, v20
v_sub_f32 v29, v29, v20
cv 86,28,29
v_lshlrev_b32 v30, 16, v87
v_and_b32 v31, 0xffff0000, v87
v_sub_f32 v30, v30, v20
v_sub_f32 v31, v31, v20
cv 87,30,31
v_lshlrev_b32 v24, 16, v88
v_and_b32 v25, 0xffff0000, v88
v_sub_f32 v24, v24, v20
v_sub_f32 v25, v25, v20
cv 88,24,25
v_lshlrev_b32 v26, 16, v89
v_and_b32 v27, 0xffff0000, v89
v_sub_f32 v26, v26, v20
v_sub_f32 v27, v27, v20
cv 89,26,27
v_lshlrev_b32 v28, 16, v90
v_and_b32 v29, 0xffff0000, v90
v_sub_f32 v28, v28, v20
v_sub_f32 v29, v29, v20
cv 90,28,29
v_lshlrev_b32 v30, 16, v91
v_and_b32 v31, 0xffff0000, v91
v_sub_f32 v30, v30, v20
v_sub_f32 v31, v31, v20
cv 91,30,31
v_lshlrev_b32 v24, 16, v92
v_and_b32 v25, 0xffff0000, v92
v_sub_f32 v24, v24, v20
v_sub_f32 v25, v25, v20
cv 92,24,25
v_lshlrev_b32 v26, 16, v93
v_and_b32 v27, 0xffff0000, v93
v_sub_f32 v26, v26, v20
v_sub_f32 v27, v27, v20
cv 93,26,27
v_lshlrev_b32 v28, 16, v94
v_and_b32 v29, 0xffff0000, v94
v_sub_f32 v28, v28, v20
v_sub_f32 v29, v29, v20
cv 94,28,29
v_lshlrev_b32 v30, 16, v95
v_and_b32 v31, 0xffff0000, v95
v_sub_f32 v30, v30, v20
v_sub_f32 v31, v31, v20
cv 95,30,31
v_lshlrev_b32 v24, 16, v96
v_and_b32 v25, 0xffff0000, v96
v_sub_f32 v24, v24, v20
v_sub_f32 v25, v25, v20
cv 96,24,25
v_lshlrev_b32 v26, 16, v97
v_and_b32 v27, 0xffff0000, v97
v_sub_f32 v26, v26, v20
v_sub_f32 v27, v27, v20
cv 97,26,27
v_lshlrev_b32 v28, 16, v98
v_and_b32 v29, 0xffff0000, v98
v_sub_f32 v28, v28, v20
v_sub_f32 v29, v29, v20
cv 98,28,29
v_lshlrev_b32 v30, 16, v99
v_and_b32 v31, 0xffff0000, v99
v_sub_f32 v30, v30, v20
v_sub_f32 v31, v31, v20
cv 99,30,31
v_lshlrev_b32 v24, 16, v100
v_and_b32 v25, 0xffff0000, v100
v_sub_f32 v24, v24, v20
v_sub_f32 v25, v25, v20
cv 100,24,25
v_lshlrev_b32 v26, 16, v101
v_and_b32 v27, 0xffff0000, v101
v_sub_f32 v26, v26, v20
v_sub_f32 v27, v27, v20
cv 101,26,27
v_lshlrev_b32 v28, 16, v102
v_and_b32 v29, 0xffff0000, v102
v_sub_f32 v28, v28, v20
v_sub_f32 v29, v29, v20
cv 102,28,29
v_lshlrev_b32 v30, 16, v103
v_and_b32 v31, 0xffff0000, v103
v_sub_f32 v30, v30, v20
v_sub_f32 v31, v31, v20
cv 103,30,31
v_lshlrev_b32 v24, 16, v104
v_and_b32 v25, 0xffff0000, v104
v_sub_f32 v24, v24, v20
v_sub_f32 v25, v25, v20
cv 104,24,25
v_lshlrev_b32 v26, 16, v105
v_and_b32 v27, 0xffff0000, v105
v_sub_f32 v26, v26, v20
v_sub_f32 v27, v27, v20
cv 105,26,27
v_lshlrev_b32 v28, 16, v106
v_and_b32 v29, 0xffff0000, v106
v_sub_f32 v28, v28, v20
v_sub_f32 v29, v29, v20
cv 106,28,29
v_lshlrev_b32 v30, 16, v107
v_and_b32 v31, 0xffff0000, v107
v_sub_f32 v30, v30, v20
v_sub_f32 v31, v31, v20
cv 107,30,31
v_lshlrev_b32 v24, 16, v108
v_and_b32 v25, 0xffff0000, v108
v_sub_f32 v24, v24, v20
v_sub_f32 v25, v25, v20
cv 108,24,25
v_lshlrev_b32 v26, 16, v109
v_and_b32 v27, 0xffff0000, v109
v_sub_f32 v26, v26, v20
v_sub_f32 v27, v27, v20
cv 109,26,27
v_lshlrev_b32 v28, 16, v110
v_and_b32 v29, 0xffff0000, v110
v_sub_f32 v28, v28, v20
v_sub_f32 v29, v29, v20
cv 110,28,29
v_lshlrev_b32 v30, 16, v111
v_and_b32 v31, 0xffff0000, v111
v_sub_f32 v30, v30, v20
v_sub_f32 v31, v31, v20
cv 111,30,31
s_add_u32 s39, s48, 0
buffer_store_dwordx4 v[64:67], v1, s[12:15], s39 offen offset:0
s_add_u32 s39, s48, 0x400
buffer_store_dwordx4 v[68:71], v1, s[12:15], s39 offen offset:0
s_add_u32 s39, s48, 0x800
buffer_store_dwordx4 v[72:75], v1, s[12:15], s39 offen offset:0
s_add_u32 s39, s48, 0xc00
buffer_store_dwordx4 v[76:79], v1, s[12:15], s39 offen offset:0
s_add_u32 s39, s48, 0x1000
buffer_store_dwordx4 v[80:83], v1, s[12:15], s39 offen offset:0
s_add_u32 s39, s48, 0x1400
buffer_store_dwordx4 v[84:87], v1, s[12:15], s39 offen offset:0
s_add_u32 s39, s48, 0x1800
buffer_store_dwordx4 v[88:91], v1, s[12:15], s39 offen offset:0
s_add_u32 s39, s48, 0x1c00
buffer_store_dwordx4 v[92:95], v1, s[12:15], s39 offen offset:0
s_add_u32 s39, s48, 0x2000
buffer_store_dwordx4 v[96:99], v1, s[12:15], s39 offen offset:0
s_add_u32 s39, s48, 0x2400
buffer_store_dwordx4 v[100:103], v1, s[12:15], s39 offen offset:0
s_add_u32 s39, s48, 0x2800
buffer_store_dwordx4 v[104:107], v1, s[12:15], s39 offen offset:0
s_add_u32 s39, s48, 0x2c00
buffer_store_dwordx4 v[108:111], v1, s[12:15], s39 offen offset:0
s_cmp_ge_u32 s20, 2
s_cbranch_scc1 L_pq_done
s_add_u32 s46, s20, 4
s_add_u32 s48, s33, s46
s_mul_i32 s48, s48, 0x3000
v_lshrrev_b32 v4, 4, v0
v_bfe_u32 v5, v0, 2, 2
v_and_b32 v6, 3, v0
v_lshrrev_b32 v7, 1, v5
v_lshlrev_b32 v7, 4, v7
v_and_b32 v8, 1, v5
v_add_u32 v7, v7, v8
v_lshl_add_u32 v7, v4, 2, v7
v_mul_u32_u24 v7, 0xc0, v7
v_lshl_add_u32 v7, v6, 3, v7
s_lshl_b32 s47, s46, 5
v_add_u32 v7, s47, v7
v_add_u32 v8, 0xc000, v7
v_mov_b32 v12, 0x3f803f80
v_mov_b32 v13, 0x3f803f80
v_mov_b32 v14, 0x3f803f80
v_mov_b32 v15, 0x3f803f80
ds_read_b64_tr_b16 v[64:65], v7 offset:0
ds_read_b64_tr_b16 v[66:67], v7 offset:6144
ds_read_b64_tr_b16 v[68:69], v7 offset:384
ds_read_b64_tr_b16 v[70:71], v7 offset:6528
ds_read_b64_tr_b16 v[72:73], v7 offset:12288
ds_read_b64_tr_b16 v[74:75], v7 offset:18432
ds_read_b64_tr_b16 v[76:77], v7 offset:12672
ds_read_b64_tr_b16 v[78:79], v7 offset:18816
ds_read_b64_tr_b16 v[80:81], v7 offset:24576
ds_read_b64_tr_b16 v[82:83], v7 offset:30720
ds_read_b64_tr_b16 v[84:85], v7 offset:24960
ds_read_b64_tr_b16 v[86:87], v7 offset:31104
ds_read_b64_tr_b16 v[88:89], v7 offset:36864
ds_read_b64_tr_b16 v[90:91], v7 offset:43008
ds_read_b64_tr_b16 v[92:93], v7 offset:37248
ds_read_b64_tr_b16 v[94:95], v7 offset:43392
ds_read_b64_tr_b16 v[96:97], v8 offset:0
ds_read_b64_tr_b16 v[98:99], v8 offset:6144
ds_read_b64_tr_b16 v[100:101], v8 offset:384
ds_read_b64_tr_b16 v[102:103], v8 offset:6528
ds_read_b64_tr_b16 v[104:105], v8 offset:12288
ds_read_b64_tr_b16 v[106:107], v8 offset:18432
ds_read_b64_tr_b16 v[108:109], v8 offset:12672
ds_read_b64_tr_b16 v[110:111], v8 offset:18816
wl 15
mvvvz 16,12,64
mvvvc 16,12,68
mvvvc 16,12,72
mvvvc 16,12,76
wl 14
mvvvc 16,12,80
wl 12
mvvvc 16,12,84
wl 10
mvvvc 16,12,88
wl 8
mvvvc 16,12,92
wl 6
mvvvc 16,12,96
wl 4
mvvvc 16,12,100
wl 2
mvvvc 16,12,104
wl 0
mvvvc 16,12,108
s_nop 8
v_mul_f32 v20, 0x3b2aaaab, v16
v_lshlrev_b32 v24, 16, v64
v_and_b32 v25, 0xffff0000, v64
v_sub_f32 v24, v24, v20
v_sub_f32 v25, v25, v20
cv 64,24,25
v_lshlrev_b32 v26, 16, v65
v_and_b32 v27, 0xffff0000, v65
v_sub_f32 v26, v26, v20
v_sub_f32 v27, v27, v20
cv 65,26,27
v_lshlrev_b32 v28, 16, v66
v_and_b32 v29, 0xffff0000, v66
v_sub_f32 v28, v28, v20
v_sub_f32 v29, v29, v20
cv 66,28,29
v_lshlrev_b32 v30, 16, v67
v_and_b32 v31, 0xffff0000, v67
v_sub_f32 v30, v30, v20
v_sub_f32 v31, v31, v20
cv 67,30,31
v_lshlrev_b32 v24, 16, v68
v_and_b32 v25, 0xffff0000, v68
v_sub_f32 v24, v24, v20
v_sub_f32 v25, v25, v20
cv 68,24,25
v_lshlrev_b32 v26, 16, v69
v_and_b32 v27, 0xffff0000, v69
v_sub_f32 v26, v26, v20
v_sub_f32 v27, v27, v20
cv 69,26,27
v_lshlrev_b32 v28, 16, v70
v_and_b32 v29, 0xffff0000, v70
v_sub_f32 v28, v28, v20
v_sub_f32 v29, v29, v20
cv 70,28,29
v_lshlrev_b32 v30, 16, v71
v_and_b32 v31, 0xffff0000, v71
v_sub_f32 v30, v30, v20
v_sub_f32 v31, v31, v20
cv 71,30,31
v_lshlrev_b32 v24, 16, v72
v_and_b32 v25, 0xffff0000, v72
v_sub_f32 v24, v24, v20
v_sub_f32 v25, v25, v20
cv 72,24,25
v_lshlrev_b32 v26, 16, v73
v_and_b32 v27, 0xffff0000, v73
v_sub_f32 v26, v26, v20
v_sub_f32 v27, v27, v20
cv 73,26,27
v_lshlrev_b32 v28, 16, v74
v_and_b32 v29, 0xffff0000, v74
v_sub_f32 v28, v28, v20
v_sub_f32 v29, v29, v20
cv 74,28,29
v_lshlrev_b32 v30, 16, v75
v_and_b32 v31, 0xffff0000, v75
v_sub_f32 v30, v30, v20
v_sub_f32 v31, v31, v20
cv 75,30,31
v_lshlrev_b32 v24, 16, v76
v_and_b32 v25, 0xffff0000, v76
v_sub_f32 v24, v24, v20
v_sub_f32 v25, v25, v20
cv 76,24,25
v_lshlrev_b32 v26, 16, v77
v_and_b32 v27, 0xffff0000, v77
v_sub_f32 v26, v26, v20
v_sub_f32 v27, v27, v20
cv 77,26,27
v_lshlrev_b32 v28, 16, v78
v_and_b32 v29, 0xffff0000, v78
v_sub_f32 v28, v28, v20
v_sub_f32 v29, v29, v20
cv 78,28,29
v_lshlrev_b32 v30, 16, v79
v_and_b32 v31, 0xffff0000, v79
v_sub_f32 v30, v30, v20
v_sub_f32 v31, v31, v20
cv 79,30,31
v_lshlrev_b32 v24, 16, v80
v_and_b32 v25, 0xffff0000, v80
v_sub_f32 v24, v24, v20
v_sub_f32 v25, v25, v20
cv 80,24,25
v_lshlrev_b32 v26, 16, v81
v_and_b32 v27, 0xffff0000, v81
v_sub_f32 v26, v26, v20
v_sub_f32 v27, v27, v20
cv 81,26,27
v_lshlrev_b32 v28, 16, v82
v_and_b32 v29, 0xffff0000, v82
v_sub_f32 v28, v28, v20
v_sub_f32 v29, v29, v20
cv 82,28,29
v_lshlrev_b32 v30, 16, v83
v_and_b32 v31, 0xffff0000, v83
v_sub_f32 v30, v30, v20
v_sub_f32 v31, v31, v20
cv 83,30,31
v_lshlrev_b32 v24, 16, v84
v_and_b32 v25, 0xffff0000, v84
v_sub_f32 v24, v24, v20
v_sub_f32 v25, v25, v20
cv 84,24,25
v_lshlrev_b32 v26, 16, v85
v_and_b32 v27, 0xffff0000, v85
v_sub_f32 v26, v26, v20
v_sub_f32 v27, v27, v20
cv 85,26,27
v_lshlrev_b32 v28, 16, v86
v_and_b32 v29, 0xffff0000, v86
v_sub_f32 v28, v28, v20
v_sub_f32 v29, v29, v20
cv 86,28,29
v_lshlrev_b32 v30, 16, v87
v_and_b32 v31, 0xffff0000, v87
v_sub_f32 v30, v30, v20
v_sub_f32 v31, v31, v20
cv 87,30,31
v_lshlrev_b32 v24, 16, v88
v_and_b32 v25, 0xffff0000, v88
v_sub_f32 v24, v24, v20
v_sub_f32 v25, v25, v20
cv 88,24,25
v_lshlrev_b32 v26, 16, v89
v_and_b32 v27, 0xffff0000, v89
v_sub_f32 v26, v26, v20
v_sub_f32 v27, v27, v20
cv 89,26,27
v_lshlrev_b32 v28, 16, v90
v_and_b32 v29, 0xffff0000, v90
v_sub_f32 v28, v28, v20
v_sub_f32 v29, v29, v20
cv 90,28,29
v_lshlrev_b32 v30, 16, v91
v_and_b32 v31, 0xffff0000, v91
v_sub_f32 v30, v30, v20
v_sub_f32 v31, v31, v20
cv 91,30,31
v_lshlrev_b32 v24, 16, v92
v_and_b32 v25, 0xffff0000, v92
v_sub_f32 v24, v24, v20
v_sub_f32 v25, v25, v20
cv 92,24,25
v_lshlrev_b32 v26, 16, v93
v_and_b32 v27, 0xffff0000, v93
v_sub_f32 v26, v26, v20
v_sub_f32 v27, v27, v20
cv 93,26,27
v_lshlrev_b32 v28, 16, v94
v_and_b32 v29, 0xffff0000, v94
v_sub_f32 v28, v28, v20
v_sub_f32 v29, v29, v20
cv 94,28,29
v_lshlrev_b32 v30, 16, v95
v_and_b32 v31, 0xffff0000, v95
v_sub_f32 v30, v30, v20
v_sub_f32 v31, v31, v20
cv 95,30,31
v_lshlrev_b32 v24, 16, v96
v_and_b32 v25, 0xffff0000, v96
v_sub_f32 v24, v24, v20
v_sub_f32 v25, v25, v20
cv 96,24,25
v_lshlrev_b32 v26, 16, v97
v_and_b32 v27, 0xffff0000, v97
v_sub_f32 v26, v26, v20
v_sub_f32 v27, v27, v20
cv 97,26,27
v_lshlrev_b32 v28, 16, v98
v_and_b32 v29, 0xffff0000, v98
v_sub_f32 v28, v28, v20
v_sub_f32 v29, v29, v20
cv 98,28,29
v_lshlrev_b32 v30, 16, v99
v_and_b32 v31, 0xffff0000, v99
v_sub_f32 v30, v30, v20
v_sub_f32 v31, v31, v20
cv 99,30,31
v_lshlrev_b32 v24, 16, v100
v_and_b32 v25, 0xffff0000, v100
v_sub_f32 v24, v24, v20
v_sub_f32 v25, v25, v20
cv 100,24,25
v_lshlrev_b32 v26, 16, v101
v_and_b32 v27, 0xffff0000, v101
v_sub_f32 v26, v26, v20
v_sub_f32 v27, v27, v20
cv 101,26,27
v_lshlrev_b32 v28, 16, v102
v_and_b32 v29, 0xffff0000, v102
v_sub_f32 v28, v28, v20
v_sub_f32 v29, v29, v20
cv 102,28,29
v_lshlrev_b32 v30, 16, v103
v_and_b32 v31, 0xffff0000, v103
v_sub_f32 v30, v30, v20
v_sub_f32 v31, v31, v20
cv 103,30,31
v_lshlrev_b32 v24, 16, v104
v_and_b32 v25, 0xffff0000, v104
v_sub_f32 v24, v24, v20
v_sub_f32 v25, v25, v20
cv 104,24,25
v_lshlrev_b32 v26, 16, v105
v_and_b32 v27, 0xffff0000, v105
v_sub_f32 v26, v26, v20
v_sub_f32 v27, v27, v20
cv 105,26,27
v_lshlrev_b32 v28, 16, v106
v_and_b32 v29, 0xffff0000, v106
v_sub_f32 v28, v28, v20
v_sub_f32 v29, v29, v20
cv 106,28,29
v_lshlrev_b32 v30, 16, v107
v_and_b32 v31, 0xffff0000, v107
v_sub_f32 v30, v30, v20
v_sub_f32 v31, v31, v20
cv 107,30,31
v_lshlrev_b32 v24, 16, v108
v_and_b32 v25, 0xffff0000, v108
v_sub_f32 v24, v24, v20
v_sub_f32 v25, v25, v20
cv 108,24,25
v_lshlrev_b32 v26, 16, v109
v_and_b32 v27, 0xffff0000, v109
v_sub_f32 v26, v26, v20
v_sub_f32 v27, v27, v20
cv 109,26,27
v_lshlrev_b32 v28, 16, v110
v_and_b32 v29, 0xffff0000, v110
v_sub_f32 v28, v28, v20
v_sub_f32 v29, v29, v20
cv 110,28,29
v_lshlrev_b32 v30, 16, v111
v_and_b32 v31, 0xffff0000, v111
v_sub_f32 v30, v30, v20
v_sub_f32 v31, v31, v20
cv 111,30,31
s_add_u32 s39, s48, 0
buffer_store_dwordx4 v[64:67], v1, s[12:15], s39 offen offset:0
s_add_u32 s39, s48, 0x400
buffer_store_dwordx4 v[68:71], v1, s[12:15], s39 offen offset:0
s_add_u32 s39, s48, 0x800
buffer_store_dwordx4 v[72:75], v1, s[12:15], s39 offen offset:0
s_add_u32 s39, s48, 0xc00
buffer_store_dwordx4 v[76:79], v1, s[12:15], s39 offen offset:0
s_add_u32 s39, s48, 0x1000
buffer_store_dwordx4 v[80:83], v1, s[12:15], s39 offen offset:0
s_add_u32 s39, s48, 0x1400
buffer_store_dwordx4 v[84:87], v1, s[12:15], s39 offen offset:0
s_add_u32 s39, s48, 0x1800
buffer_store_dwordx4 v[88:91], v1, s[12:15], s39 offen offset:0
s_add_u32 s39, s48, 0x1c00
buffer_store_dwordx4 v[92:95], v1, s[12:15], s39 offen offset:0
s_add_u32 s39, s48, 0x2000
buffer_store_dwordx4 v[96:99], v1, s[12:15], s39 offen offset:0
s_add_u32 s39, s48, 0x2400
buffer_store_dwordx4 v[100:103], v1, s[12:15], s39 offen offset:0
s_add_u32 s39, s48, 0x2800
buffer_store_dwordx4 v[104:107], v1, s[12:15], s39 offen offset:0
s_add_u32 s39, s48, 0x2c00
buffer_store_dwordx4 v[108:111], v1, s[12:15], s39 offen offset:0
L_pq_done:
wv 0
s_barrier
s_cmp_lg_u32 s20, 0
s_cbranch_scc1 L_pub1
buffer_wbl2 sc1
wv 0
v_mov_b32 v2, 1
v_mov_b32 v3, 0
s_mov_b64 exec, 1
buffer_atomic_add v2, v3, s[4:7], 0 offen sc1
wv 0
s_mov_b64 exec, -1
L_pub1:
s_barrier
s_cmp_ge_u32 s2, 6
s_cbranch_scc1 L_prep_dw
s_mov_b32 s24, s44
s_mov_b32 s25, s45
s_mov_b32 s26, 0x48000
s_lshl_b32 s32, s2, 7
s_mul_i32 s35, s20, 12
s_add_u32 s38, s35, 0
s_lshl_b32 s39, s38, 6
v_add_u32 v4, s39, v0
v_lshrrev_b32 v5, 3, v4
v_and_b32 v6, 7, v4
v_mul_u32_u24 v8, 0x300, v5
v_lshl_add_u32 v8, v6, 4, v8
s_lshl_b32 m0, s38, 10
s_nop 0
dm 8,24,32,0
s_add_u32 s38, s35, 1
s_lshl_b32 s39, s38, 6
v_add_u32 v4, s39, v0
v_lshrrev_b32 v5, 3, v4
v_and_b32 v6, 7, v4
v_mul_u32_u24 v9, 0x300, v5
v_lshl_add_u32 v9, v6, 4, v9
s_lshl_b32 m0, s38, 10
s_nop 0
dm 9,24,32,0
s_add_u32 s38, s35, 2
s_lshl_b32 s39, s38, 6
v_add_u32 v4, s39, v0
v_lshrrev_b32 v5, 3, v4
v_and_b32 v6, 7, v4
v_mul_u32_u24 v10, 0x300, v5
v_lshl_add_u32 v10, v6, 4, v10
s_lshl_b32 m0, s38, 10
s_nop 0
dm 10,24,32,0
s_add_u32 s38, s35, 3
s_lshl_b32 s39, s38, 6
v_add_u32 v4, s39, v0
v_lshrrev_b32 v5, 3, v4
v_and_b32 v6, 7, v4
v_mul_u32_u24 v11, 0x300, v5
v_lshl_add_u32 v11, v6, 4, v11
s_lshl_b32 m0, s38, 10
s_nop 0
dm 11,24,32,0
s_add_u32 s38, s35, 4
s_lshl_b32 s39, s38, 6
v_add_u32 v4, s39, v0
v_lshrrev_b32 v5, 3, v4
v_and_b32 v6, 7, v4
v_mul_u32_u24 v12, 0x300, v5
v_lshl_add_u32 v12, v6, 4, v12
s_lshl_b32 m0, s38, 10
s_nop 0
dm 12,24,32,0
s_add_u32 s38, s35, 5
s_lshl_b32 s39, s38, 6
v_add_u32 v4, s39, v0
v_lshrrev_b32 v5, 3, v4
v_and_b32 v6, 7, v4
v_mul_u32_u24 v13, 0x300, v5
v_lshl_add_u32 v13, v6, 4, v13
s_lshl_b32 m0, s38, 10
s_nop 0
dm 13,24,32,0
s_add_u32 s38, s35, 6
s_lshl_b32 s39, s38, 6
v_add_u32 v4, s39, v0
v_lshrrev_b32 v5, 3, v4
v_and_b32 v6, 7, v4
v_mul_u32_u24 v14, 0x300, v5
v_lshl_add_u32 v14, v6, 4, v14
s_lshl_b32 m0, s38, 10
s_nop 0
dm 14,24,32,0
s_add_u32 s38, s35, 7
s_lshl_b32 s39, s38, 6
v_add_u32 v4, s39, v0
v_lshrrev_b32 v5, 3, v4
v_and_b32 v6, 7, v4
v_mul_u32_u24 v15, 0x300, v5
v_lshl_add_u32 v15, v6, 4, v15
s_lshl_b32 m0, s38, 10
s_nop 0
dm 15,24,32,0
s_add_u32 s38, s35, 8
s_lshl_b32 s39, s38, 6
v_add_u32 v4, s39, v0
v_lshrrev_b32 v5, 3, v4
v_and_b32 v6, 7, v4
v_mul_u32_u24 v16, 0x300, v5
v_lshl_add_u32 v16, v6, 4, v16
s_lshl_b32 m0, s38, 10
s_nop 0
dm 16,24,32,0
s_add_u32 s38, s35, 9
s_lshl_b32 s39, s38, 6
v_add_u32 v4, s39, v0
v_lshrrev_b32 v5, 3, v4
v_and_b32 v6, 7, v4
v_mul_u32_u24 v17, 0x300, v5
v_lshl_add_u32 v17, v6, 4, v17
s_lshl_b32 m0, s38, 10
s_nop 0
dm 17,24,32,0
s_add_u32 s38, s35, 10
s_lshl_b32 s39, s38, 6
v_add_u32 v4, s39, v0
v_lshrrev_b32 v5, 3, v4
v_and_b32 v6, 7, v4
v_mul_u32_u24 v18, 0x300, v5
v_lshl_add_u32 v18, v6, 4, v18
s_lshl_b32 m0, s38, 10
s_nop 0
dm 18,24,32,0
s_add_u32 s38, s35, 11
s_lshl_b32 s39, s38, 6
v_add_u32 v4, s39, v0
v_lshrrev_b32 v5, 3, v4
v_and_b32 v6, 7, v4
v_mul_u32_u24 v19, 0x300, v5
v_lshl_add_u32 v19, v6, 4, v19
s_lshl_b32 m0, s38, 10
s_nop 0
dm 19,24,32,0
wv 0
s_barrier
s_lshl_b32 s48, s2, 2
s_add_u32 s48, s48, s20
s_mul_i32 s48, s48, 0x3000
s_add_u32 s48, s48, 0xd8000
v_and_b32 v4, 15, v0
v_lshrrev_b32 v5, 4, v0
v_lshlrev_b32 v6, 9, v5
v_lshl_add_u32 v6, v4, 3, v6
s_lshl_b32 s47, s20, 1
v_add_u32 v6, s47, v6
ds_read_u16 v64, v6 offset:0
ds_read_u16 v65, v6 offset:128
ds_read_u16 v66, v6 offset:256
ds_read_u16 v67, v6 offset:384
ds_read_u16 v68, v6 offset:2048
ds_read_u16 v69, v6 offset:2176
ds_read_u16 v70, v6 offset:2304
ds_read_u16 v71, v6 offset:2432
ds_read_u16 v72, v6 offset:4096
ds_read_u16 v73, v6 offset:4224
ds_read_u16 v74, v6 offset:4352
ds_read_u16 v75, v6 offset:4480
ds_read_u16 v76, v6 offset:6144
ds_read_u16 v77, v6 offset:6272
ds_read_u16 v78, v6 offset:6400
ds_read_u16 v79, v6 offset:6528
ds_read_u16 v80, v6 offset:8192
ds_read_u16 v81, v6 offset:8320
ds_read_u16 v82, v6 offset:8448
ds_read_u16 v83, v6 offset:8576
ds_read_u16 v84, v6 offset:10240
ds_read_u16 v85, v6 offset:10368
ds_read_u16 v86, v6 offset:10496
ds_read_u16 v87, v6 offset:10624
ds_read_u16 v88, v6 offset:12288
ds_read_u16 v89, v6 offset:12416
ds_read_u16 v90, v6 offset:12544
ds_read_u16 v91, v6 offset:12672
ds_read_u16 v92, v6 offset:14336
ds_read_u16 v93, v6 offset:14464
ds_read_u16 v94, v6 offset:14592
ds_read_u16 v95, v6 offset:14720
ds_read_u16 v96, v6 offset:16384
ds_read_u16 v97, v6 offset:16512
ds_read_u16 v98, v6 offset:16640
ds_read_u16 v99, v6 offset:16768
ds_read_u16 v100, v6 offset:18432
ds_read_u16 v101, v6 offset:18560
ds_read_u16 v102, v6 offset:18688
ds_read_u16 v103, v6 offset:18816
ds_read_u16 v104, v6 offset:20480
ds_read_u16 v105, v6 offset:20608
ds_read_u16 v106, v6 offset:20736
ds_read_u16 v107, v6 offset:20864
ds_read_u16 v108, v6 offset:22528
ds_read_u16 v109, v6 offset:22656
ds_read_u16 v110, v6 offset:22784
ds_read_u16 v111, v6 offset:22912
ds_read_u16 v112, v6 offset:24576
ds_read_u16 v113, v6 offset:24704
ds_read_u16 v114, v6 offset:24832
ds_read_u16 v115, v6 offset:24960
ds_read_u16 v116, v6 offset:26624
ds_read_u16 v117, v6 offset:26752
ds_read_u16 v118, v6 offset:26880
ds_read_u16 v119, v6 offset:27008
ds_read_u16 v120, v6 offset:28672
ds_read_u16 v121, v6 offset:28800
ds_read_u16 v122, v6 offset:28928
ds_read_u16 v123, v6 offset:29056
ds_read_u16 v124, v6 offset:30720
ds_read_u16 v125, v6 offset:30848
ds_read_u16 v126, v6 offset:30976
ds_read_u16 v127, v6 offset:31104
ds_read_u16 v128, v6 offset:32768
ds_read_u16 v129, v6 offset:32896
ds_read_u16 v130, v6 offset:33024
ds_read_u16 v131, v6 offset:33152
ds_read_u16 v132, v6 offset:34816
ds_read_u16 v133, v6 offset:34944
ds_read_u16 v134, v6 offset:35072
ds_read_u16 v135, v6 offset:35200
ds_read_u16 v136, v6 offset:36864
ds_read_u16 v137, v6 offset:36992
ds_read_u16 v138, v6 offset:37120
ds_read_u16 v139, v6 offset:37248
ds_read_u16 v140, v6 offset:38912
ds_read_u16 v141, v6 offset:39040
ds_read_u16 v142, v6 offset:39168
ds_read_u16 v143, v6 offset:39296
ds_read_u16 v144, v6 offset:40960
ds_read_u16 v145, v6 offset:41088
ds_read_u16 v146, v6 offset:41216
ds_read_u16 v147, v6 offset:41344
ds_read_u16 v148, v6 offset:43008
ds_read_u16 v149, v6 offset:43136
ds_read_u16 v150, v6 offset:43264
ds_read_u16 v151, v6 offset:43392
ds_read_u16 v152, v6 offset:45056
ds_read_u16 v153, v6 offset:45184
ds_read_u16 v154, v6 offset:45312
ds_read_u16 v155, v6 offset:45440
ds_read_u16 v156, v6 offset:47104
ds_read_u16 v157, v6 offset:47232
ds_read_u16 v158, v6 offset:47360
ds_read_u16 v159, v6 offset:47488
wl 15
v_lshl_or_b32 v160, v65, 16, v64
v_lshl_or_b32 v161, v67, 16, v66
v_lshl_or_b32 v162, v69, 16, v68
v_lshl_or_b32 v163, v71, 16, v70
v_lshl_or_b32 v164, v73, 16, v72
v_lshl_or_b32 v165, v75, 16, v74
v_lshl_or_b32 v166, v77, 16, v76
v_lshl_or_b32 v167, v79, 16, v78
v_lshl_or_b32 v168, v81, 16, v80
v_lshl_or_b32 v169, v83, 16, v82
v_lshl_or_b32 v170, v85, 16, v84
v_lshl_or_b32 v171, v87, 16, v86
v_lshl_or_b32 v172, v89, 16, v88
v_lshl_or_b32 v173, v91, 16, v90
v_lshl_or_b32 v174, v93, 16, v92
v_lshl_or_b32 v175, v95, 16, v94
v_lshl_or_b32 v176, v97, 16, v96
v_lshl_or_b32 v177, v99, 16, v98
v_lshl_or_b32 v178, v101, 16, v100
v_lshl_or_b32 v179, v103, 16, v102
v_lshl_or_b32 v180, v105, 16, v104
v_lshl_or_b32 v181, v107, 16, v106
v_lshl_or_b32 v182, v109, 16, v108
v_lshl_or_b32 v183, v111, 16, v110
v_lshl_or_b32 v184, v113, 16, v112
v_lshl_or_b32 v185, v115, 16, v114
v_lshl_or_b32 v186, v117, 16, v116
v_lshl_or_b32 v187, v119, 16, v118
v_lshl_or_b32 v188, v121, 16, v120
v_lshl_or_b32 v189, v123, 16, v122
v_lshl_or_b32 v190, v125, 16, v124
v_lshl_or_b32 v191, v127, 16, v126
v_lshl_or_b32 v192, v129, 16, v128
v_lshl_or_b32 v193, v131, 16, v130
v_lshl_or_b32 v194, v133, 16, v132
v_lshl_or_b32 v195, v135, 16, v134
v_lshl_or_b32 v196, v137, 16, v136
v_lshl_or_b32 v197, v139, 16, v138
v_lshl_or_b32 v198, v141, 16, v140
v_lshl_or_b32 v199, v143, 16, v142
wl 14
v_lshl_or_b32 v200, v145, 16, v144
wl 12
v_lshl_or_b32 v201, v147, 16, v146
wl 10
v_lshl_or_b32 v202, v149, 16, v148
wl 8
v_lshl_or_b32 v203, v151, 16, v150
wl 6
v_lshl_or_b32 v204, v153, 16, v152
wl 4
v_lshl_or_b32 v205, v155, 16, v154
wl 2
v_lshl_or_b32 v206, v157, 16, v156
wl 0
v_lshl_or_b32 v207, v159, 16, v158
s_add_u32 s39, s48, 0
buffer_store_dwordx4 v[160:163], v1, s[12:15], s39 offen offset:0
s_add_u32 s39, s48, 0x400
buffer_store_dwordx4 v[164:167], v1, s[12:15], s39 offen offset:0
s_add_u32 s39, s48, 0x800
buffer_store_dwordx4 v[168:171], v1, s[12:15], s39 offen offset:0
s_add_u32 s39, s48, 0xc00
buffer_store_dwordx4 v[172:175], v1, s[12:15], s39 offen offset:0
s_add_u32 s39, s48, 0x1000
buffer_store_dwordx4 v[176:179], v1, s[12:15], s39 offen offset:0
s_add_u32 s39, s48, 0x1400
buffer_store_dwordx4 v[180:183], v1, s[12:15], s39 offen offset:0
s_add_u32 s39, s48, 0x1800
buffer_store_dwordx4 v[184:187], v1, s[12:15], s39 offen offset:0
s_add_u32 s39, s48, 0x1c00
buffer_store_dwordx4 v[188:191], v1, s[12:15], s39 offen offset:0
s_add_u32 s39, s48, 0x2000
buffer_store_dwordx4 v[192:195], v1, s[12:15], s39 offen offset:0
s_add_u32 s39, s48, 0x2400
buffer_store_dwordx4 v[196:199], v1, s[12:15], s39 offen offset:0
s_add_u32 s39, s48, 0x2800
buffer_store_dwordx4 v[200:203], v1, s[12:15], s39 offen offset:0
s_add_u32 s39, s48, 0x2c00
buffer_store_dwordx4 v[204:207], v1, s[12:15], s39 offen offset:0
wv 0
s_barrier
s_cmp_lg_u32 s20, 0
s_cbranch_scc1 L_pub2
buffer_wbl2 sc1
wv 0
v_mov_b32 v2, 1
v_mov_b32 v3, 4
s_mov_b64 exec, 1
buffer_atomic_add v2, v3, s[4:7], 0 offen sc1
wv 0
s_mov_b64 exec, -1
L_pub2:
s_endpgm
L_prep_dw:
s_mov_b32 s24, s40
s_mov_b32 s25, s41
s_mov_b32 s26, 0x1b00
s_sub_u32 s21, s2, 6
s_lshl_b32 s21, s21, 2
s_add_u32 s21, s21, s20
s_mul_i32 s22, s21, 0xc00
s_add_u32 s22, s22, 0x120000
v_and_b32 v3, 15, v0
v_lshrrev_b32 v4, 4, v0
v_and_b32 v8, 1, v4
v_lshrrev_b32 v9, 3, v3
v_cmp_eq_u32 vcc, v8, v9
v_and_b32 v10, 1, v3
v_lshlrev_b32 v10, 4, v10
v_mov_b32 v11, 0xffff
v_lshlrev_b32 v11, v10, v11
v_cndmask_b32 v11, 0, v11, vcc
v_bfe_u32 v12, v3, 1, 2
v_cmp_eq_u32 vcc, 0, v12
s_nop 1
v_cndmask_b32 v20, 0, v11, vcc
v_cmp_eq_u32 vcc, 1, v12
s_nop 1
v_cndmask_b32 v21, 0, v11, vcc
v_cmp_eq_u32 vcc, 2, v12
s_nop 1
v_cndmask_b32 v22, 0, v11, vcc
v_cmp_eq_u32 vcc, 3, v12
s_nop 1
v_cndmask_b32 v23, 0, v11, vcc
v_lshrrev_b32 v8, 2, v3
v_cmp_eq_u32 vcc, 0, v8
v_mov_b32 v44, 0xffff
s_nop 0
v_cndmask_b32 v44, 0, v44, vcc
v_cmp_eq_u32 vcc, 1, v8
v_mov_b32 v45, 0xffff
s_nop 0
v_cndmask_b32 v45, 0, v45, vcc
v_cmp_eq_u32 vcc, 2, v8
v_mov_b32 v46, 0xffff
s_nop 0
v_cndmask_b32 v46, 0, v46, vcc
v_cmp_eq_u32 vcc, 3, v8
v_mov_b32 v47, 0xffff
s_nop 0
v_cndmask_b32 v47, 0, v47, vcc
s_lshl_b32 s31, s21, 5
v_add_u32 v14, 0, v4
v_mul_u32_u24 v15, 0x300, v14
v_lshl_add_u32 v16, v3, 1, v15
buffer_load_ushort v17, v16, s[24:27], s31 offen offset:0
wv 0
v_and_b32 v24, v17, v44
v_and_b32 v25, v17, v45
v_and_b32 v26, v17, v46
v_and_b32 v27, v17, v47
s_add_u32 s32, s22, 0
buffer_store_dwordx4 v[24:27], v1, s[12:15], s32 offen offset:0
v_add_u32 v14, 4, v4
v_mul_u32_u24 v15, 0x300, v14
v_lshl_add_u32 v16, v3, 1, v15
buffer_load_ushort v17, v16, s[24:27], s31 offen offset:0
wv 0
v_and_b32 v28, v17, v44
v_and_b32 v29, v17, v45
v_and_b32 v30, v17, v46
v_and_b32 v31, v17, v47
s_add_u32 s32, s22, 0x400
buffer_store_dwordx4 v[28:31], v1, s[12:15], s32 offen offset:0
v_lshrrev_b32 v13, 1, v4
v_add_u32 v14, 8, v13
v_mul_u32_u24 v15, 0x300, v14
v_lshl_add_u32 v16, v3, 1, v15
buffer_load_ushort v17, v16, s[24:27], s31 offen offset:0
v_cmp_eq_u32 vcc, 9, v14
v_mov_b32 v18, 0x3f80
wv 0
v_cndmask_b32 v17, v17, v18, vcc
v_lshl_or_b32 v17, v17, 16, v17
v_and_b32 v32, v17, v20
v_and_b32 v33, v17, v21
v_and_b32 v34, v17, v22
v_and_b32 v35, v17, v23
s_add_u32 s32, s22, 0x800
buffer_store_dwordx4 v[32:35], v1, s[12:15], s32 offen offset:0
wv 0
s_barrier
s_cmp_lg_u32 s20, 0
s_cbranch_scc1 L_pub3
buffer_wbl2 sc1
wv 0
v_mov_b32 v2, 1
v_mov_b32 v3, 4
s_mov_b64 exec, 1
buffer_atomic_add v2, v3, s[4:7], 0 offen sc1
wv 0
s_mov_b64 exec, -1
L_pub3:
s_endpgm
L_main:
s_mov_b32 s96, s40
s_mov_b32 s97, s41
s_mov_b32 s98, 0x1b00
s_mov_b32 s99, 0x20000
s_and_b32 s48, s2, 7
s_lshr_b32 s49, s2, 3
s_cmp_lt_u32 s48, 4
s_cselect_b32 s62, 2, 1
s_sub_u32 s49, s49, s62
s_mul_i32 s62, s48, 30
s_add_u32 s49, s49, s62
s_max_u32 s62, s48, 4
s_sub_u32 s62, s62, 4
s_add_u32 s63, s49, s62
s_mul_i32 s37, s63, 0x97c
s_lshr_b32 s37, s37, 16
s_mul_i32 s38, s37, 27
s_sub_u32 s36, s63, s38
s_mul_i32 s35, s37, 3
s_mul_i32 s34, s36, 14
s_mul_i32 s23, s20, 0x1800
s_lshl_b32 s80, s20, 12
s_mov_b32 s32, 0x3e16c740
s_mov_b32 s61, 0xbe16c740
s_mov_b32 s75, 0x3b2aaaab
s_mov_b32 s76, 0x3727c5ac
s_mov_b32 s21, 0
s_lshl_b32 s60, s63, 2
s_add_u32 s60, s60, s20
s_mul_i32 s60, s60, 0x1800
s_add_u32 s60, s60, 0x200000
s_lshl_b32 s37, s63, 2
s_add_u32 s37, s37, s20
s_lshl_b32 s37, s37, 13
s_add_u32 s77, s37, 0x900000
s_and_b32 s38, s20, 1
s_mul_i32 s72, s38, 0x3000
s_mul_i32 s74, s38, 7
s_lshr_b32 s38, s20, 1
s_mul_i32 s73, s38, 7
s_mov_b32 s26, 49
s_cmp_eq_u32 s20, 1
s_cselect_b32 s26, 43, s26
s_cmp_eq_u32 s20, 2
s_cselect_b32 s26, 7, s26
s_cmp_eq_u32 s20, 3
s_cselect_b32 s26, 1, s26
v_and_b32 v27, 15, v0
v_lshrrev_b32 v28, 4, v0
v_and_b32 v29, 3, v27
v_cmp_eq_u32 s[50:51], 1, v29
v_cmp_eq_u32 s[52:53], 2, v29
v_cmp_eq_u32 s[54:55], 3, v29
v_cmp_gt_u32 s[56:57], 12, v27
v_cmp_eq_u32 s[58:59], 0, v27
v_cmp_eq_u32 vcc, 0, v28
s_nop 1
v_cndmask_b32 v23, 0, 1.0, vcc
v_mul_u32_u24 v22, 0x910, v27
v_lshl_add_u32 v22, v28, 4, v22
v_add_u32 v22, 0x21340, v22
s_mov_b32 s66, 0x300
s_cmp_eq_u32 s20, 1
s_cselect_b32 s66, 0x308, s66
s_cmp_eq_u32 s20, 2
s_cselect_b32 s66, 0x340, s66
s_cmp_eq_u32 s20, 3
s_cselect_b32 s66, 0x348, s66
s_mov_b32 s67, 0x380
s_cmp_eq_u32 s20, 1
s_cselect_b32 s67, 0x388, s67
s_cmp_eq_u32 s20, 2
s_cselect_b32 s67, 0, s67
s_cmp_eq_u32 s20, 3
s_cselect_b32 s67, 8, s67
s_mov_b32 s68, 64
s_cmp_eq_u32 s20, 1
s_cselect_b32 s68, 0x48, s68
s_cmp_eq_u32 s20, 2
s_cselect_b32 s68, 0x80, s68
s_cmp_eq_u32 s20, 3
s_cselect_b32 s68, 0x88, s68
s_mov_b32 s69, 0x600
s_cmp_eq_u32 s20, 1
s_cselect_b32 s69, 0x608, s69
s_cmp_eq_u32 s20, 2
s_cselect_b32 s69, 0x640, s69
s_cmp_eq_u32 s20, 3
s_cselect_b32 s69, 0x648, s69
s_mov_b32 s70, 0x680
s_cmp_eq_u32 s20, 1
s_cselect_b32 s70, 0x688, s70
s_cmp_eq_u32 s20, 2
s_cselect_b32 s70, 0x680, s70
s_cmp_eq_u32 s20, 3
s_cselect_b32 s70, 0x688, s70
L_pro:
s_add_u32 s37, s35, s21
s_lshl_b32 s39, s21, 2
s_add_u32 s39, s39, s20
s_mul_i32 s39, s39, 0x910
v_lshrrev_b32 v28, 4, v0
s_add_u32 s39, s39, 0x21340
v_lshlrev_b32 v20, 4, v28
v_add_u32 v20, s39, v20
s_mul_i32 s33, s37, 14
s_add_u32 s39, s39, 0x600
s_mov_b32 s27, 0
s_add_u32 s37, s27, 0
s_and_b32 s37, s37, 3
s_mul_i32 s28, s37, 0x6000
s_add_u32 s37, s27, 1
s_and_b32 s37, s37, 3
s_mul_i32 s29, s37, 0x6000
s_add_u32 s37, s27, 2
s_and_b32 s37, s37, 3
s_mul_i32 s30, s37, 0x6000
s_add_u32 s37, s27, 3
s_and_b32 s37, s37, 3
s_lshl_b32 s81, s20, 2
s_add_u32 s81, s81, s33
s_sub_u32 s81, s81, 1
s_add_u32 s82, s81, 0
s_mul_i32 s42, s82, 0x46e00
s_cmp_lt_u32 s82, 0x17a
s_cselect_b32 s42, s42, 0x80000000
s_add_u32 s82, s81, 1
s_mul_i32 s43, s82, 0x46e00
s_cmp_lt_u32 s82, 0x17a
s_cselect_b32 s43, s43, 0x80000000
s_add_u32 s82, s81, 2
s_mul_i32 s46, s82, 0x46e00
s_cmp_lt_u32 s82, 0x17a
s_cselect_b32 s46, s46, 0x80000000
s_add_u32 s82, s81, 3
v_and_b32 v27, 15, v0
s_mul_i32 s47, s82, 0x46e00
s_cmp_lt_u32 s82, 0x17a
v_lshrrev_b32 v29, 2, v27
s_cselect_b32 s47, s47, 0x80000000
v_lshlrev_b32 v29, 4, v29
v_and_b32 v30, 3, v27
s_lshl_b32 s81, s20, 2
v_lshl_add_u32 v29, v30, 1, v29
v_and_b32 v27, 15, v0
s_sub_u32 s83, s34, 1
v_add_u32 v21, s39, v29
v_lshrrev_b32 v26, 4, v0
v_lshrrev_b32 v30, 1, v27
s_add_u32 s82, s81, 0
v_and_b32 v29, 1, v26
v_add_u32 v32, s82, v30
v_lshlrev_b32 v29, 3, v29
v_and_b32 v32, 7, v32
v_add_u32 v32, v32, v29
v_add_u32 v33, s83, v32
s_add_u32 s82, s81, 1
v_add_u32 v32, s82, v30
s_mov_b32 s86, 0x17a
v_and_b32 v32, 7, v32
v_mul_u32_u24 v116, 0x300, v33
v_cmp_gt_u32 vcc, s86, v33
v_add_u32 v32, v32, v29
v_add_u32 v33, s83, v32
s_add_u32 s82, s81, 2
v_add_u32 v32, s82, v30
s_add_u32 s82, s81, 3
s_lshl_b32 s44, s20, 10
s_add_u32 s45, s44, 0
s_add_u32 m0, s45, 0x22340
s_lshl_b32 s44, s20, 10
v_and_b32 v31, 1, v27
v_lshrrev_b32 v28, 1, v26
v_lshlrev_b32 v31, 4, v31
dm 1,96,45,0
s_add_u32 s45, s44, 0x1000
s_add_u32 m0, s45, 0x22340
v_lshl_add_u32 v31, v28, 5, v31
v_mov_b32 v34, 0x80000000
v_add_u32 v116, v116, v31
v_cndmask_b32 v116, v34, v116, vcc
dm 1,96,45,0
s_add_u32 m0, s80, 0
s_add_u32 s81, s42, 0
v_cmp_gt_u32 vcc, s86, v33
v_mul_u32_u24 v117, 0x300, v33
v_add_u32 v117, v117, v31
v_cndmask_b32 v117, v34, v117, vcc
buffer_load_dwordx4 v116, s[8:11], s81 offen offset:0 nt lds
s_add_u32 m0, s80, 0x4000
s_add_u32 s81, s42, 64
v_and_b32 v32, 7, v32
v_add_u32 v32, v32, v29
v_add_u32 v33, s83, v32
v_cmp_gt_u32 vcc, s86, v33
buffer_load_dwordx4 v116, s[8:11], s81 offen offset:0 nt lds
s_add_u32 m0, s80, 0x400
s_add_u32 s81, s43, 0
v_mul_u32_u24 v118, 0x300, v33
v_add_u32 v118, v118, v31
v_cndmask_b32 v118, v34, v118, vcc
v_add_u32 v32, s82, v30
buffer_load_dwordx4 v117, s[8:11], s81 offen offset:0 nt lds
s_add_u32 m0, s80, 0x4400
s_add_u32 s81, s43, 64
v_and_b32 v32, 7, v32
v_add_u32 v32, v32, v29
v_add_u32 v33, s83, v32
v_cmp_gt_u32 vcc, s86, v33
buffer_load_dwordx4 v117, s[8:11], s81 offen offset:0 nt lds
s_add_u32 m0, s80, 0x800
s_add_u32 s81, s46, 0
v_mul_u32_u24 v119, 0x300, v33
v_add_u32 v119, v119, v31
v_cndmask_b32 v119, v34, v119, vcc
s_mov_b32 s84, 0x3e0400
buffer_load_dwordx4 v118, s[8:11], s81 offen offset:0 nt lds
s_add_u32 m0, s80, 0x4800
s_add_u32 s81, s46, 64
s_mov_b32 s85, 0x46e00
s_mul_i32 s83, s35, 14
s_mul_i32 s86, s20, 0x2800
v_mov_b32 v9, 0
buffer_load_dwordx4 v118, s[8:11], s81 offen offset:0 nt lds
s_add_u32 m0, s80, 0xc00
s_add_u32 s81, s47, 0
s_mul_i32 s31, s37, 0x6000
v_mov_b32 v32, -1
v_mov_b32 v33, -1
v_mov_b32 v90, 0xffff
buffer_load_dwordx4 v119, s[8:11], s81 offen offset:0 nt lds
s_add_u32 m0, s80, 0x4c00
s_add_u32 s81, s47, 64
s_add_u32 s83, s83, 5
s_mul_i32 s83, s83, 0x46e00
v_mov_b32 v91, 0xffff
v_mov_b32 v92, 0xffff
buffer_load_dwordx4 v119, s[8:11], s81 offen offset:0 nt lds
s_mul_i32 s81, s20, 0x280
v_add_u32 v26, s81, v0
v_add_u32 v26, 0, v26
v_mul_u32_u24 v28, 0x53a, v26
v_lshrrev_b32 v28, 16, v28
v_mul_u32_u24 v30, 49, v28
v_sub_u32 v29, v26, v30
v_lshrrev_b32 v27, 4, v28
v_bfe_u32 v30, v28, 2, 2
v_mul_lo_u32 v36, v27, s84
v_mul_lo_u32 v30, v30, s85
v_add_u32 v36, v36, v30
v_and_b32 v30, 3, v28
v_mul_u32_u24 v30, 0x300, v30
v_cmp_gt_u32 vcc, 48, v28
v_add_u32 v36, v36, v30
v_lshl_add_u32 v36, v29, 4, v36
v_mov_b32 v30, 0x80000000
v_cndmask_b32 v36, v30, v36, vcc
v_cmp_gt_u32 vcc, 48, v29
v_add_u32 v26, s81, v0
v_add_u32 v26, 64, v26
v_mul_u32_u24 v28, 0x53a, v26
v_cndmask_b32 v36, v30, v36, vcc
v_lshrrev_b32 v28, 16, v28
v_mul_u32_u24 v30, 49, v28
v_sub_u32 v29, v26, v30
v_lshrrev_b32 v27, 4, v28
v_bfe_u32 v30, v28, 2, 2
v_mul_lo_u32 v37, v27, s84
v_mul_lo_u32 v30, v30, s85
v_add_u32 v37, v37, v30
v_and_b32 v30, 3, v28
v_mul_u32_u24 v30, 0x300, v30
v_cmp_gt_u32 vcc, 48, v28
v_add_u32 v37, v37, v30
v_lshl_add_u32 v37, v29, 4, v37
v_mov_b32 v30, 0x80000000
v_cndmask_b32 v37, v30, v37, vcc
v_cmp_gt_u32 vcc, 48, v29
v_add_u32 v26, s81, v0
v_add_u32 v26, 0x80, v26
v_mul_u32_u24 v28, 0x53a, v26
v_cndmask_b32 v37, v30, v37, vcc
v_lshrrev_b32 v28, 16, v28
v_mul_u32_u24 v30, 49, v28
v_sub_u32 v29, v26, v30
v_lshrrev_b32 v27, 4, v28
v_bfe_u32 v30, v28, 2, 2
v_mul_lo_u32 v38, v27, s84
v_mul_lo_u32 v30, v30, s85
v_add_u32 v38, v38, v30
v_and_b32 v30, 3, v28
v_mul_u32_u24 v30, 0x300, v30
v_cmp_gt_u32 vcc, 48, v28
v_add_u32 v38, v38, v30
v_lshl_add_u32 v38, v29, 4, v38
v_mov_b32 v30, 0x80000000
v_cndmask_b32 v38, v30, v38, vcc
v_cmp_gt_u32 vcc, 48, v29
v_add_u32 v26, s81, v0
v_add_u32 v26, 0xc0, v26
v_mul_u32_u24 v28, 0x53a, v26
v_cndmask_b32 v38, v30, v38, vcc
v_lshrrev_b32 v28, 16, v28
v_mul_u32_u24 v30, 49, v28
v_sub_u32 v29, v26, v30
v_lshrrev_b32 v27, 4, v28
v_bfe_u32 v30, v28, 2, 2
v_mul_lo_u32 v39, v27, s84
v_mul_lo_u32 v30, v30, s85
v_add_u32 v39, v39, v30
v_and_b32 v30, 3, v28
v_mul_u32_u24 v30, 0x300, v30
v_cmp_gt_u32 vcc, 48, v28
v_add_u32 v39, v39, v30
v_lshl_add_u32 v39, v29, 4, v39
v_mov_b32 v30, 0x80000000
v_cndmask_b32 v39, v30, v39, vcc
v_cmp_gt_u32 vcc, 48, v29
v_add_u32 v26, s81, v0
v_add_u32 v26, 0x100, v26
v_mul_u32_u24 v28, 0x53a, v26
v_cndmask_b32 v39, v30, v39, vcc
v_lshrrev_b32 v28, 16, v28
v_mul_u32_u24 v30, 49, v28
v_sub_u32 v29, v26, v30
v_lshrrev_b32 v27, 4, v28
v_bfe_u32 v30, v28, 2, 2
v_mul_lo_u32 v40, v27, s84
v_mul_lo_u32 v30, v30, s85
v_add_u32 v40, v40, v30
v_and_b32 v30, 3, v28
v_mul_u32_u24 v30, 0x300, v30
v_cmp_gt_u32 vcc, 48, v28
v_add_u32 v40, v40, v30
v_lshl_add_u32 v40, v29, 4, v40
v_mov_b32 v30, 0x80000000
v_cndmask_b32 v40, v30, v40, vcc
v_cmp_gt_u32 vcc, 48, v29
v_add_u32 v26, s81, v0
v_add_u32 v26, 0x140, v26
v_mul_u32_u24 v28, 0x53a, v26
v_cndmask_b32 v40, v30, v40, vcc
v_lshrrev_b32 v28, 16, v28
v_mul_u32_u24 v30, 49, v28
v_sub_u32 v29, v26, v30
v_lshrrev_b32 v27, 4, v28
v_bfe_u32 v30, v28, 2, 2
v_mul_lo_u32 v41, v27, s84
v_mul_lo_u32 v30, v30, s85
v_add_u32 v41, v41, v30
v_and_b32 v30, 3, v28
v_mul_u32_u24 v30, 0x300, v30
v_cmp_gt_u32 vcc, 48, v28
v_add_u32 v41, v41, v30
v_lshl_add_u32 v41, v29, 4, v41
v_mov_b32 v30, 0x80000000
v_cndmask_b32 v41, v30, v41, vcc
v_cmp_gt_u32 vcc, 48, v29
v_add_u32 v26, s81, v0
v_add_u32 v26, 0x180, v26
v_mul_u32_u24 v28, 0x53a, v26
v_cndmask_b32 v41, v30, v41, vcc
v_lshrrev_b32 v28, 16, v28
v_mul_u32_u24 v30, 49, v28
v_sub_u32 v29, v26, v30
v_lshrrev_b32 v27, 4, v28
v_bfe_u32 v30, v28, 2, 2
v_mul_lo_u32 v42, v27, s84
v_mul_lo_u32 v30, v30, s85
v_add_u32 v42, v42, v30
v_and_b32 v30, 3, v28
v_mul_u32_u24 v30, 0x300, v30
v_cmp_gt_u32 vcc, 48, v28
v_add_u32 v42, v42, v30
v_lshl_add_u32 v42, v29, 4, v42
v_mov_b32 v30, 0x80000000
v_cndmask_b32 v42, v30, v42, vcc
v_cmp_gt_u32 vcc, 48, v29
v_add_u32 v26, s81, v0
v_add_u32 v26, 0x1c0, v26
v_mul_u32_u24 v28, 0x53a, v26
v_cndmask_b32 v42, v30, v42, vcc
v_lshrrev_b32 v28, 16, v28
v_mul_u32_u24 v30, 49, v28
v_sub_u32 v29, v26, v30
v_lshrrev_b32 v27, 4, v28
v_bfe_u32 v30, v28, 2, 2
v_mul_lo_u32 v43, v27, s84
v_mul_lo_u32 v30, v30, s85
v_add_u32 v43, v43, v30
v_and_b32 v30, 3, v28
v_mul_u32_u24 v30, 0x300, v30
v_cmp_gt_u32 vcc, 48, v28
v_add_u32 v43, v43, v30
v_lshl_add_u32 v43, v29, 4, v43
v_mov_b32 v30, 0x80000000
v_cndmask_b32 v43, v30, v43, vcc
v_cmp_gt_u32 vcc, 48, v29
v_add_u32 v26, s81, v0
v_add_u32 v26, 0x200, v26
v_mul_u32_u24 v28, 0x53a, v26
v_cndmask_b32 v43, v30, v43, vcc
v_lshrrev_b32 v28, 16, v28
v_mul_u32_u24 v30, 49, v28
v_sub_u32 v29, v26, v30
v_lshrrev_b32 v27, 4, v28
v_bfe_u32 v30, v28, 2, 2
v_mul_lo_u32 v44, v27, s84
v_mul_lo_u32 v30, v30, s85
v_add_u32 v44, v44, v30
v_add_u32 v26, s81, v0
v_and_b32 v30, 3, v28
v_cmp_gt_u32 vcc, 48, v28
v_add_u32 v26, 0x240, v26
v_mul_u32_u24 v28, 0x53a, v26
v_lshrrev_b32 v28, 16, v28
v_lshrrev_b32 v27, 4, v28
v_mul_lo_u32 v45, v27, s84
s_add_u32 s84, s34, 5
s_mul_i32 s84, s84, 0x300
s_add_u32 s48, s83, s84
s_add_u32 m0, s86, 0x18000
s_mul_i32 s86, s20, 0x2800
v_mul_u32_u24 v30, 0x300, v30
v_add_u32 v44, v44, v30
v_lshl_add_u32 v44, v29, 4, v44
buffer_load_dwordx4 v36, s[8:11], s48 offen offset:0 nt lds
s_add_u32 m0, s86, 0x18400
s_mul_i32 s86, s20, 0x2800
v_mov_b32 v30, 0x80000000
v_cndmask_b32 v44, v30, v44, vcc
v_cmp_gt_u32 vcc, 48, v29
buffer_load_dwordx4 v37, s[8:11], s48 offen offset:0 nt lds
s_add_u32 m0, s86, 0x18800
s_mul_i32 s86, s20, 0x2800
v_cndmask_b32 v44, v30, v44, vcc
v_mul_u32_u24 v30, 49, v28
v_sub_u32 v29, v26, v30
buffer_load_dwordx4 v38, s[8:11], s48 offen offset:0 nt lds
s_add_u32 m0, s86, 0x18c00
s_mul_i32 s86, s20, 0x2800
v_bfe_u32 v30, v28, 2, 2
v_mul_lo_u32 v30, v30, s85
v_add_u32 v45, v45, v30
buffer_load_dwordx4 v39, s[8:11], s48 offen offset:0 nt lds
s_add_u32 m0, s86, 0x19000
s_mul_i32 s86, s20, 0x2800
v_and_b32 v30, 3, v28
v_mul_u32_u24 v30, 0x300, v30
v_cmp_gt_u32 vcc, 48, v28
buffer_load_dwordx4 v40, s[8:11], s48 offen offset:0 nt lds
s_add_u32 m0, s86, 0x19400
s_mul_i32 s86, s20, 0x2800
v_add_u32 v45, v45, v30
v_lshl_add_u32 v45, v29, 4, v45
v_mov_b32 v30, 0x80000000
buffer_load_dwordx4 v41, s[8:11], s48 offen offset:0 nt lds
s_add_u32 m0, s86, 0x19800
s_mul_i32 s86, s20, 0x2800
v_cndmask_b32 v45, v30, v45, vcc
v_cmp_gt_u32 vcc, 48, v29
s_mul_i32 s81, s20, 0x280
buffer_load_dwordx4 v42, s[8:11], s48 offen offset:0 nt lds
s_add_u32 m0, s86, 0x19c00
s_mul_i32 s86, s20, 0x2800
v_cndmask_b32 v45, v30, v45, vcc
v_and_b32 v26, 15, v0
v_add_u32 v35, 1, v26
buffer_load_dwordx4 v43, s[8:11], s48 offen offset:0 nt lds
s_add_u32 m0, s86, 0x1a000
s_mul_i32 s86, s20, 0x2800
v_subrev_u32 v30, s26, v35
v_lshrrev_b32 v30, 31, v30
v_sub_u32 v35, v35, v30
buffer_load_dwordx4 v44, s[8:11], s48 offen offset:0 nt lds
s_add_u32 m0, s86, 0x1a400
v_lshrrev_b32 v27, 4, v0
v_mul_u32_u24 v30, 37, v35
v_lshrrev_b32 v28, 1, v27
v_lshrrev_b32 v30, 8, v30
buffer_load_dwordx4 v45, s[8:11], s48 offen offset:0 nt lds
s_add_u32 m0, s80, 0x8000
s_add_u32 s81, s42, 0x80
v_cmp_eq_u32 vcc, 1, v28
v_mul_u32_u24 v31, 7, v30
v_sub_u32 v31, v35, v31
v_mov_b32 v35, -1
buffer_load_dwordx4 v116, s[8:11], s81 offen offset:0 nt lds
s_add_u32 m0, s80, 0xc000
s_add_u32 s81, s42, 0xc0
v_cndmask_b32 v32, v32, v35, vcc
v_mov_b32 v35, 0
v_cndmask_b32 v33, v33, v35, vcc
v_mov_b32 v35, 0
buffer_load_dwordx4 v116, s[8:11], s81 offen offset:0 nt lds
s_add_u32 m0, s80, 0x8400
s_add_u32 s81, s43, 0x80
v_and_b32 v29, 1, v27
v_lshlrev_b32 v29, 4, v29
v_lshrrev_b32 v27, 4, v0
v_lshrrev_b32 v28, 1, v27
buffer_load_dwordx4 v117, s[8:11], s81 offen offset:0 nt lds
s_add_u32 m0, s80, 0xc400
s_add_u32 s81, s43, 0xc0
wv 21
s_barrier
v_and_b32 v88, 3, v0
v_mov_b32 v93, 0xffff
s_mov_b32 s98, L_pro_b-L_cp1
buffer_load_dwordx4 v117, s[8:11], s81 offen offset:0 nt lds
s_add_u32 m0, s80, 0x8800
s_add_u32 s81, s46, 0x80
s_getpc_b64 s[96:97]
L_cp1:
s_mov_b32 s99, L_round-L_pro_b
v_lshlrev_b32 v234, 7, v0
v_lshrrev_b32 v95, 4, v0
buffer_load_dwordx4 v118, s[8:11], s81 offen offset:0 nt lds
s_add_u32 m0, s80, 0xc800
s_add_u32 s81, s46, 0xc0
v_lshlrev_b32 v95, 2, v95
v_add_u32 v96, 1, v95
v_subrev_u32 v97, s26, v96
v_lshrrev_b32 v97, 31, v97
buffer_load_dwordx4 v118, s[8:11], s81 offen offset:0 nt lds
s_add_u32 m0, s80, 0x8c00
s_add_u32 s81, s47, 0x80
v_sub_u32 v96, v96, v97
v_mul_u32_u24 v97, 37, v96
v_lshrrev_b32 v97, 8, v97
v_mul_u32_u24 v98, 7, v97
buffer_load_dwordx4 v119, s[8:11], s81 offen offset:0 nt lds
s_add_u32 m0, s80, 0xcc00
s_add_u32 s81, s47, 0xc0
s_add_u32 s37, s73, 1
s_add_u32 s38, s74, 1
v_add_u32 v30, s37, v30
v_add_u32 v31, s38, v31
buffer_load_dwordx4 v119, s[8:11], s81 offen offset:0 nt lds
v_add_u32 v32, v32, v30
v_add_u32 v33, v33, v31
v_mul_u32_u24 v34, 7, v32
v_add_u32 v34, v34, v33
v_and_b32 v34, 7, v34
v_lshlrev_b32 v100, 10, v32
v_lshl_add_u32 v100, v34, 5, v100
v_lshrrev_b32 v33, 3, v33
v_mov_b32 v32, -1
v_lshl_add_u32 v100, v33, 8, v100
v_cndmask_b32 v32, v32, v35, vcc
v_mov_b32 v33, 1
v_mov_b32 v35, -1
v_add_u32 v32, v32, v30
v_cndmask_b32 v33, v33, v35, vcc
v_add_u32 v33, v33, v31
v_mul_u32_u24 v34, 7, v32
v_add_u32 v34, v34, v33
v_and_b32 v34, 7, v34
v_lshlrev_b32 v101, 10, v32
v_lshl_add_u32 v101, v34, 5, v101
v_lshrrev_b32 v33, 3, v33
v_mov_b32 v32, 0
v_mov_b32 v35, 0
v_lshl_add_u32 v101, v33, 8, v101
v_cndmask_b32 v32, v32, v35, vcc
v_mov_b32 v33, 0
v_mov_b32 v35, 1
v_add_u32 v32, v32, v30
v_cndmask_b32 v33, v33, v35, vcc
v_add_u32 v33, v33, v31
v_mul_u32_u24 v34, 7, v32
v_add_u32 v34, v34, v33
v_and_b32 v34, 7, v34
v_lshlrev_b32 v102, 10, v32
v_lshl_add_u32 v102, v34, 5, v102
v_lshrrev_b32 v33, 3, v33
v_mov_b32 v32, 1
v_mov_b32 v35, 1
v_lshl_add_u32 v102, v33, 8, v102
v_cndmask_b32 v32, v32, v35, vcc
v_mov_b32 v33, -1
v_mov_b32 v35, 0
v_add_u32 v32, v32, v30
v_cndmask_b32 v33, v33, v35, vcc
v_add_u32 v33, v33, v31
v_mul_u32_u24 v34, 7, v32
v_add_u32 v34, v34, v33
v_and_b32 v34, 7, v34
v_lshlrev_b32 v103, 10, v32
v_lshl_add_u32 v103, v34, 5, v103
v_lshrrev_b32 v33, 3, v33
v_mov_b32 v32, 1
v_mov_b32 v35, 0
v_lshl_add_u32 v103, v33, 8, v103
v_cndmask_b32 v32, v32, v35, vcc
v_mov_b32 v33, 1
v_mov_b32 v35, 0
v_cndmask_b32 v33, v33, v35, vcc
v_add_u32 v32, v32, v30
v_add_u32 v35, 17, v26
v_subrev_u32 v30, s26, v35
v_lshrrev_b32 v30, 31, v30
v_sub_u32 v35, v35, v30
v_mul_u32_u24 v30, 37, v35
v_add_u32 v33, v33, v31
v_mul_u32_u24 v34, 7, v32
v_lshrrev_b32 v30, 8, v30
v_add_u32 v34, v34, v33
v_mul_u32_u24 v31, 7, v30
v_and_b32 v34, 7, v34
v_lshlrev_b32 v104, 10, v32
v_sub_u32 v31, v35, v31
v_lshl_add_u32 v104, v34, 5, v104
v_lshrrev_b32 v33, 3, v33
v_mov_b32 v32, -1
v_mov_b32 v35, -1
v_lshl_add_u32 v104, v33, 8, v104
s_add_u32 s37, s73, 1
v_cndmask_b32 v32, v32, v35, vcc
s_add_u32 s38, s74, 1
v_add_u32 v30, s37, v30
v_mov_b32 v33, -1
v_mov_b32 v35, 0
v_add_u32 v31, s38, v31
v_add_u32 v32, v32, v30
v_cndmask_b32 v33, v33, v35, vcc
v_add_u32 v33, v33, v31
v_mul_u32_u24 v34, 7, v32
v_add_u32 v34, v34, v33
v_and_b32 v34, 7, v34
v_lshlrev_b32 v105, 10, v32
v_lshl_add_u32 v105, v34, 5, v105
v_lshrrev_b32 v33, 3, v33
v_mov_b32 v32, -1
v_mov_b32 v35, 0
v_lshl_add_u32 v105, v33, 8, v105
v_cndmask_b32 v32, v32, v35, vcc
v_mov_b32 v33, 1
v_mov_b32 v35, -1
v_add_u32 v32, v32, v30
v_cndmask_b32 v33, v33, v35, vcc
v_add_u32 v33, v33, v31
v_mul_u32_u24 v34, 7, v32
v_add_u32 v34, v34, v33
v_and_b32 v34, 7, v34
v_lshlrev_b32 v106, 10, v32
v_lshl_add_u32 v106, v34, 5, v106
v_lshrrev_b32 v33, 3, v33
v_mov_b32 v32, 0
v_mov_b32 v35, 0
v_lshl_add_u32 v106, v33, 8, v106
v_cndmask_b32 v32, v32, v35, vcc
v_mov_b32 v33, 0
v_mov_b32 v35, 1
v_add_u32 v32, v32, v30
v_cndmask_b32 v33, v33, v35, vcc
v_add_u32 v33, v33, v31
v_mul_u32_u24 v34, 7, v32
v_add_u32 v34, v34, v33
v_and_b32 v34, 7, v34
v_lshlrev_b32 v107, 10, v32
v_lshl_add_u32 v107, v34, 5, v107
v_lshrrev_b32 v33, 3, v33
v_mov_b32 v32, 1
v_mov_b32 v35, 1
v_lshl_add_u32 v107, v33, 8, v107
v_cndmask_b32 v32, v32, v35, vcc
v_mov_b32 v33, -1
v_mov_b32 v35, 0
v_add_u32 v32, v32, v30
v_cndmask_b32 v33, v33, v35, vcc
v_add_u32 v33, v33, v31
v_mul_u32_u24 v34, 7, v32
v_add_u32 v34, v34, v33
v_and_b32 v34, 7, v34
v_lshlrev_b32 v108, 10, v32
v_lshl_add_u32 v108, v34, 5, v108
v_lshrrev_b32 v33, 3, v33
v_mov_b32 v32, 1
v_mov_b32 v35, 0
v_lshl_add_u32 v108, v33, 8, v108
v_cndmask_b32 v32, v32, v35, vcc
v_mov_b32 v33, 1
v_mov_b32 v35, 0
v_cndmask_b32 v33, v33, v35, vcc
v_add_u32 v32, v32, v30
v_add_u32 v35, 33, v26
v_subrev_u32 v30, s26, v35
v_lshrrev_b32 v30, 31, v30
v_sub_u32 v35, v35, v30
v_mul_u32_u24 v30, 37, v35
v_add_u32 v33, v33, v31
v_mul_u32_u24 v34, 7, v32
v_lshrrev_b32 v30, 8, v30
v_add_u32 v34, v34, v33
v_mul_u32_u24 v31, 7, v30
v_and_b32 v34, 7, v34
v_lshlrev_b32 v109, 10, v32
v_sub_u32 v31, v35, v31
v_lshl_add_u32 v109, v34, 5, v109
v_lshrrev_b32 v33, 3, v33
v_mov_b32 v32, -1
v_mov_b32 v35, -1
v_lshl_add_u32 v109, v33, 8, v109
s_add_u32 s37, s73, 1
v_cndmask_b32 v32, v32, v35, vcc
s_add_u32 s38, s74, 1
v_add_u32 v30, s37, v30
v_mov_b32 v33, -1
v_mov_b32 v35, 0
v_add_u32 v31, s38, v31
v_add_u32 v32, v32, v30
v_cndmask_b32 v33, v33, v35, vcc
v_add_u32 v33, v33, v31
v_mul_u32_u24 v34, 7, v32
v_add_u32 v34, v34, v33
v_and_b32 v34, 7, v34
v_lshlrev_b32 v110, 10, v32
v_lshl_add_u32 v110, v34, 5, v110
v_lshrrev_b32 v33, 3, v33
v_mov_b32 v32, -1
v_mov_b32 v35, 0
v_lshl_add_u32 v110, v33, 8, v110
v_cndmask_b32 v32, v32, v35, vcc
v_mov_b32 v33, 1
v_mov_b32 v35, -1
v_add_u32 v32, v32, v30
v_cndmask_b32 v33, v33, v35, vcc
v_add_u32 v33, v33, v31
v_mul_u32_u24 v34, 7, v32
v_add_u32 v34, v34, v33
v_and_b32 v34, 7, v34
v_lshlrev_b32 v111, 10, v32
v_lshl_add_u32 v111, v34, 5, v111
v_lshrrev_b32 v33, 3, v33
v_mov_b32 v32, 0
v_mov_b32 v35, 0
v_lshl_add_u32 v111, v33, 8, v111
v_cndmask_b32 v32, v32, v35, vcc
v_mov_b32 v33, 0
v_mov_b32 v35, 1
v_add_u32 v32, v32, v30
v_cndmask_b32 v33, v33, v35, vcc
v_add_u32 v33, v33, v31
v_mul_u32_u24 v34, 7, v32
v_add_u32 v34, v34, v33
v_and_b32 v34, 7, v34
v_lshlrev_b32 v112, 10, v32
v_lshl_add_u32 v112, v34, 5, v112
v_lshrrev_b32 v33, 3, v33
v_mov_b32 v32, 1
v_mov_b32 v35, 1
v_lshl_add_u32 v112, v33, 8, v112
v_cndmask_b32 v32, v32, v35, vcc
v_mov_b32 v33, -1
v_mov_b32 v35, 0
v_add_u32 v32, v32, v30
v_cndmask_b32 v33, v33, v35, vcc
v_add_u32 v33, v33, v31
v_mul_u32_u24 v34, 7, v32
v_add_u32 v34, v34, v33
v_and_b32 v34, 7, v34
v_lshlrev_b32 v113, 10, v32
v_lshl_add_u32 v113, v34, 5, v113
v_lshrrev_b32 v33, 3, v33
v_mov_b32 v32, 1
v_mov_b32 v35, 0
v_lshl_add_u32 v113, v33, 8, v113
v_cndmask_b32 v32, v32, v35, vcc
v_mov_b32 v33, 1
v_mov_b32 v35, 0
v_add_u32 v32, v32, v30
v_cndmask_b32 v33, v33, v35, vcc
v_add_u32 v33, v33, v31
v_mul_u32_u24 v34, 7, v32
v_add_u32 v34, v34, v33
v_and_b32 v34, 7, v34
v_lshlrev_b32 v114, 10, v32
v_lshl_add_u32 v114, v34, 5, v114
v_lshrrev_b32 v33, 3, v33
v_and_b32 v26, 15, v0
v_lshl_add_u32 v114, v33, 8, v114
v_min_u32 v26, 11, v26
v_add_u32 v100, v100, v29
v_add_u32 v101, v101, v29
v_add_u32 v102, v102, v29
v_add_u32 v103, v103, v29
v_add_u32 v104, v104, v29
v_add_u32 v105, v105, v29
v_add_u32 v106, v106, v29
v_add_u32 v107, v107, v29
v_add_u32 v108, v108, v29
v_add_u32 v109, v109, v29
v_add_u32 v110, v110, v29
v_add_u32 v111, v111, v29
v_add_u32 v112, v112, v29
v_add_u32 v113, v113, v29
v_add_u32 v114, v114, v29
v_lshrrev_b32 v32, 2, v26
v_mul_u32_u24 v29, 0x3100, v32
v_and_b32 v32, 1, v27
v_cmp_eq_u32 vcc, 1, v28
v_lshl_add_u32 v29, v32, 4, v29
v_mov_b32 v30, 0
v_mov_b32 v32, 0
v_cndmask_b32 v30, v30, v32, vcc
v_bfe_u32 v32, v26, 1, 1
v_add_u32 v30, v30, v32
v_mov_b32 v31, 0
v_mov_b32 v32, 1
v_cndmask_b32 v31, v31, v32, vcc
v_and_b32 v32, 1, v26
v_add_u32 v31, v31, v32
v_lshl_add_u32 v30, v30, 2, v31
v_add_u32 v29, 0x18000, v29
v_mul_u32_u24 v30, 0x310, v30
v_add_u32 v82, v30, v29
v_mov_b32 v30, 0
v_mov_b32 v32, 1
v_cndmask_b32 v30, v30, v32, vcc
v_bfe_u32 v32, v26, 1, 1
v_add_u32 v30, v30, v32
v_mov_b32 v31, 2
v_mov_b32 v32, 0
v_cndmask_b32 v31, v31, v32, vcc
v_and_b32 v32, 1, v26
v_add_u32 v31, v31, v32
v_lshl_add_u32 v30, v30, 2, v31
v_mul_u32_u24 v30, 0x310, v30
v_add_u32 v83, v30, v29
v_mov_b32 v30, 1
v_mov_b32 v32, 1
v_cndmask_b32 v30, v30, v32, vcc
v_bfe_u32 v32, v26, 1, 1
v_add_u32 v30, v30, v32
v_mov_b32 v31, 1
v_mov_b32 v32, 2
v_cndmask_b32 v31, v31, v32, vcc
v_and_b32 v32, 1, v26
v_add_u32 v31, v31, v32
v_lshl_add_u32 v30, v30, 2, v31
v_mul_u32_u24 v30, 0x310, v30
v_add_u32 v84, v30, v29
v_mov_b32 v30, 2
v_mov_b32 v32, 2
v_cndmask_b32 v30, v30, v32, vcc
v_bfe_u32 v32, v26, 1, 1
v_add_u32 v30, v30, v32
v_mov_b32 v31, 0
v_mov_b32 v32, 1
v_cndmask_b32 v31, v31, v32, vcc
v_and_b32 v32, 1, v26
v_add_u32 v31, v31, v32
v_lshl_add_u32 v30, v30, 2, v31
v_mul_u32_u24 v30, 0x310, v30
v_add_u32 v85, v30, v29
v_mov_b32 v30, 2
v_mov_b32 v32, 1
v_cndmask_b32 v30, v30, v32, vcc
v_bfe_u32 v32, v26, 1, 1
v_add_u32 v30, v30, v32
v_mov_b32 v31, 2
v_mov_b32 v32, 1
v_cndmask_b32 v31, v31, v32, vcc
v_and_b32 v32, 1, v26
v_add_u32 v31, v31, v32
v_lshl_add_u32 v30, v30, 2, v31
v_mul_u32_u24 v30, 0x310, v30
v_add_u32 v86, v30, v29
v_and_b32 v26, 15, v0
v_and_b32 v30, 1, v26
v_lshrrev_b32 v27, 4, v0
v_lshlrev_b32 v30, 4, v30
v_mov_b32 v31, 0xffff
v_and_b32 v28, 1, v27
v_lshrrev_b32 v29, 3, v26
v_lshlrev_b32 v31, v30, v31
v_cmp_eq_u32 vcc, v28, v29
v_lshlrev_b32 v30, 2, v0
v_mov_b32 v29, 0x3f803f80
v_add_u32 v30, 0x23e40, v30
v_lshrrev_b32 v28, 1, v27
v_mul_u32_u24 v68, 0x300, v28
v_lshl_add_u32 v68, v26, 1, v68
v_add_u32 v68, 0x22340, v68
ds_write_b32 v30, v29 offset:0
ds_write_b32 v30, v29 offset:256
ds_write_b32 v30, v29 offset:512
v_cndmask_b32 v31, 0, v31, vcc
v_bfe_u32 v32, v26, 1, 2
v_cmp_eq_u32 vcc, 0, v32
v_mul_u32_u24 v89, 0x300, v27
v_lshl_add_u32 v89, v26, 1, v89
v_cndmask_b32 v60, 0, v31, vcc
v_cmp_eq_u32 vcc, 1, v32
s_waitcnt vmcnt(8) lgkmcnt(0)
s_barrier
ds_read_u16 v78, v68 offset:6144
rv 192,104,0
rv 196,109,0
v_cndmask_b32 v61, 0, v31, vcc
rv 144,100,0
v_cmp_eq_u32 vcc, 2, v32
rv 148,101,0
s_nop 0
v_cndmask_b32 v62, 0, v31, vcc
rv 152,102,0
v_cmp_eq_u32 vcc, 3, v32
rv 156,103,0
v_add_u32 v89, 0x22340, v89
ds_read_u16 v76, v89 offset:0
ds_read_u16 v77, v89 offset:3072
rv 160,105,0
v_cndmask_b32 v63, 0, v31, vcc
rv 164,106,0
wl 10
v_lshl_or_b32 v78, v78, 16, v78
rv 176,110,0
v_and_b32 v128, v78, v60
rv 180,111,0
v_and_b32 v129, v78, v61
rv 168,107,0
v_and_b32 v130, v78, v62
rv 172,108,0
v_and_b32 v131, v78, v63
v_lshrrev_b32 v28, 2, v26
v_cmp_eq_u32 vcc, 0, v28
wl 13
mvvvz 200,128,192
wl 12
rv 192,114,0
v_cndmask_b32 v90, 0, v90, vcc
mvvvz 204,128,196
rv 196,86,0
rv 184,112,0
v_cmp_eq_u32 vcc, 1, v28
rv 188,113,0
s_nop 0
v_cndmask_b32 v91, 0, v91, vcc
ds_read_u16 v79, v89 offset:32
ds_read_u16 v80, v89 offset:3104
ds_read_u16 v78, v89 offset:3136
v_cmp_eq_u32 vcc, 2, v28
wl 14
v_and_b32 v120, v76, v90
v_and_b32 v121, v76, v91
v_cndmask_b32 v92, 0, v92, vcc
v_cmp_eq_u32 vcc, 3, v28
v_xor_b32 v28, 1, v88
v_lshl_or_b32 v88, v28, 2, v88
v_cndmask_b32 v93, 0, v93, vcc
v_mul_u32_u24 v88, 0x1111, v88
wl 6
mvvvz 208,128,192
wl 5
rv 192,104,512
v_and_b32 v122, v76, v92
mvvvz 212,128,196
s_add_u32 m0, s80, 0x10000
rv 196,109,512
v_and_b32 v123, v76, v93
v_and_b32 v124, v77, v90
v_and_b32 v125, v77, v91
v_smfmac_f32_16x16x64_bf16 v[200:203], v[120:123], v[144:151], v88
rv 144,82,0
v_and_b32 v126, v77, v92
v_smfmac_f32_16x16x64_bf16 v[204:207], v[120:123], v[160:167], v88
rv 148,83,0
v_and_b32 v127, v77, v93
v_smfmac_f32_16x16x64_bf16 v[208:211], v[120:123], v[176:183], v88
wl 6
ds_read_u16 v76, v68 offset:6176
v_and_b32 v132, v79, v90
v_smfmac_f32_16x16x64_bf16 v[200:203], v[124:127], v[152:159], v88
rv 152,84,0
rv 156,85,0
v_smfmac_f32_16x16x64_bf16 v[204:207], v[124:127], v[168:175], v88
rv 160,100,512
v_and_b32 v133, v79, v91
v_smfmac_f32_16x16x64_bf16 v[208:211], v[124:127], v[184:191], v88
rv 164,101,512
rv 168,102,512
rv 172,103,512
rv 176,105,512
rv 180,106,512
mu 228,200,200
wl 9
v_smfmac_f32_16x16x64_bf16 v[212:215], v[120:123], v[144:151], v88
wl 8
rv 184,107,512
rv 188,108,512
v_lshl_or_b32 v76, v76, 16, v76
v_and_b32 v140, v76, v60
v_and_b32 v141, v76, v61
v_and_b32 v142, v76, v62
v_and_b32 v143, v76, v63
v_and_b32 v134, v79, v92
v_and_b32 v135, v79, v93
wl 8
v_smfmac_f32_16x16x64_bf16 v[212:215], v[124:127], v[152:159], v88
rv 144,110,512
ad 224,200,201
mvvvz 216,140,192
wl 7
rv 192,114,512
rv 148,111,512
v_smfmac_f32_16x16x64_bf16 v[216:219], v[132:135], v[160:167], v88
rv 152,112,512
rv 156,113,512
mvvvz 220,140,196
rv 196,86,32
v_fma_f32 v228, v201, v201, v228
ad 224,224,202
v_fma_f32 v228, v202, v202, v228
ad 224,224,203
v_fma_f32 v228, v203, v203, v228
cv 70,200,201
cv 71,202,203
wl 8
v_smfmac_f32_16x16x64_bf16 v[220:223], v[132:135], v[176:183], v88
ds_read_u16 v79, v68 offset:6208
mu 229,204,204
ad 225,204,205
v_fma_f32 v229, v205, v205, v229
ad 225,225,206
v_fma_f32 v229, v206, v206, v229
ad 225,225,207
v_fma_f32 v229, v207, v207, v229
cv 72,204,205
cv 73,206,207
mu 230,208,208
ad 226,208,209
v_fma_f32 v230, v209, v209, v230
v_and_b32 v136, v80, v90
wl 5
mvvvz 200,140,192
wl 4
ds_read_u16 v77, v89 offset:64
v_and_b32 v137, v80, v91
v_smfmac_f32_16x16x64_bf16 v[200:203], v[132:135], v[144:151], v88
rv 160,82,32
v_and_b32 v138, v80, v92
v_and_b32 v139, v80, v93
ad 226,226,210
v_fma_f32 v230, v210, v210, v230
v_smfmac_f32_16x16x64_bf16 v[216:219], v[136:139], v[168:175], v88
wl 4
s_barrier
rv 192,104,16384
ad 226,226,211
v_smfmac_f32_16x16x64_bf16 v[220:223], v[136:139], v[184:191], v88
wl 3
rv 164,83,32
v_lshl_or_b32 v79, v79, 16, v79
v_smfmac_f32_16x16x64_bf16 v[200:203], v[136:139], v[152:159], v88
rv 176,100,16384
v_and_b32 v128, v79, v60
mvvvz 204,140,196
rv 196,109,16384
rv 180,101,16384
v_and_b32 v129, v79, v61
rv 168,84,32
v_and_b32 v130, v79, v62
rv 172,85,32
v_and_b32 v131, v79, v63
v_fma_f32 v230, v211, v211, v230
cv 74,208,209
cv 75,210,211
wl 6
mvvvz 208,128,192
wl 5
rv 184,102,16384
mu 231,212,212
v_smfmac_f32_16x16x64_bf16 v[204:207], v[132:135], v[160:167], v88
rv 188,103,16384
rv 192,114,16384
ad 227,212,213
rv 144,105,16384
v_fma_f32 v231, v213, v213, v231
aw 0,70
aw 12,71
ad 227,227,214
v_fma_f32 v231, v214, v214, v231
ad 227,227,215
v_fma_f32 v231, v215, v215, v231
cv 70,212,213
cv 71,214,215
wl 7
mvvvz 212,128,196
wl 4
rv 196,86,64
v_and_b32 v120, v77, v90
v_smfmac_f32_16x16x64_bf16 v[204:207], v[136:139], v[168:175], v88
s_add_u32 s81, s42, 0x100
rv 148,106,16384
rv 160,110,16384
v_and_b32 v121, v77, v91
rv 164,111,16384
v_and_b32 v122, v77, v92
rv 152,107,16384
v_and_b32 v123, v77, v93
ad 224,224,216
v_fma_f32 v228, v216, v216, v228
v_smfmac_f32_16x16x64_bf16 v[208:211], v[120:123], v[176:183], v88
rv 176,82,64
rv 180,83,64
ad 224,224,217
v_fma_f32 v228, v217, v217, v228
v_and_b32 v124, v78, v90
v_and_b32 v125, v78, v91
v_and_b32 v126, v78, v92
v_and_b32 v127, v78, v93
aw 4,72
aw 16,73
wl 9
v_smfmac_f32_16x16x64_bf16 v[208:211], v[124:127], v[184:191], v88
wl 5
ds_read_u16 v77, v68 offset:6240
ad 224,224,218
v_smfmac_f32_16x16x64_bf16 v[212:215], v[120:123], v[144:151], v88
s_mov_b32 s39, 0x46e00
rv 156,108,16384
rv 168,112,16384
v_fma_f32 v228, v218, v218, v228
rv 172,113,16384
ad 224,224,219
rv 184,84,64
v_fma_f32 v228, v219, v219, v228
rv 188,85,64
cv 72,216,217
ds_read_u16 v80, v89 offset:96
cv 73,218,219
mvvvz 216,128,192
wl 10
rv 192,104,16896
ad 225,225,220
v_smfmac_f32_16x16x64_bf16 v[216:219], v[120:123], v[160:167], v88
wl 6
rv 144,100,16896
v_fma_f32 v229, v220, v220, v229
v_smfmac_f32_16x16x64_bf16 v[212:215], v[124:127], v[152:159], v88
rv 148,101,16896
ad 225,225,221
v_fma_f32 v229, v221, v221, v229
aw 8,74
aw 20,75
ad 225,225,222
wl 6
v_smfmac_f32_16x16x64_bf16 v[216:219], v[124:127], v[168:175], v88
rv 152,102,16896
rv 156,103,16896
v_fma_f32 v229, v222, v222, v229
rv 160,105,16896
ad 225,225,223
rv 164,106,16896
v_fma_f32 v229, v223, v223, v229
rv 168,107,16896
cv 74,220,221
rv 172,108,16896
cv 75,222,223
mvvvz 220,128,196
rv 196,109,16896
ad 226,226,200
v_smfmac_f32_16x16x64_bf16 v[220:223], v[120:123], v[176:183], v88
wl 11
rv 176,110,16896
v_fma_f32 v230, v200, v200, v230
v_smfmac_f32_16x16x64_bf16 v[220:223], v[124:127], v[184:191], v88
rv 180,111,16896
v_lshl_or_b32 v77, v77, 16, v77
rv 184,112,16896
ad 226,226,201
rv 188,113,16896
v_fma_f32 v230, v201, v201, v230
ds_read_u16 v76, v89 offset:3168
ds_read_u16 v78, v89 offset:128
ds_read_u16 v79, v89 offset:3200
v_and_b32 v140, v77, v60
v_and_b32 v141, v77, v61
v_and_b32 v142, v77, v62
v_and_b32 v143, v77, v63
ds_read_u16 v77, v89 offset:3232
aw 144,70
aw 148,71
ad 226,226,202
v_fma_f32 v230, v202, v202, v230
ad 226,226,203
v_fma_f32 v230, v203, v203, v230
cv 70,200,201
cv 71,202,203
wl 15
mvvvz 200,140,192
rv 192,114,16896
ad 227,227,204
v_fma_f32 v231, v204, v204, v231
ad 227,227,205
v_fma_f32 v231, v205, v205, v231
aw 1,72
aw 13,73
ad 227,227,206
v_fma_f32 v231, v206, v206, v231
ad 227,227,207
v_fma_f32 v231, v207, v207, v231
cv 72,204,205
cv 73,206,207
wl 9
mvvvz 204,140,196
rv 196,86,96
buffer_load_dwordx4 v116, s[8:11], s81 offen offset:0 nt lds
s_add_u32 m0, s80, 0x14000
s_add_u32 s81, s42, 0x140
ad 224,224,208
v_fma_f32 v228, v208, v208, v228
v_and_b32 v132, v80, v90
v_and_b32 v133, v80, v91
v_and_b32 v134, v80, v92
v_and_b32 v135, v80, v93
ad 224,224,209
v_fma_f32 v228, v209, v209, v228
v_smfmac_f32_16x16x64_bf16 v[200:203], v[132:135], v[144:151], v88
buffer_load_dwordx4 v116, s[8:11], s81 offen offset:0 nt lds
v_smfmac_f32_16x16x64_bf16 v[204:207], v[132:135], v[160:167], v88
s_add_u32 m0, s80, 0x10400
ds_read_u16 v80, v68 offset:6272
rv 144,82,96
rv 148,83,96
s_add_u32 s81, s43, 0x100
aw 5,74
aw 17,75
ad 224,224,210
v_fma_f32 v228, v210, v210, v228
ad 224,224,211
v_fma_f32 v228, v211, v211, v228
cv 74,208,209
cv 75,210,211
wl 4
mvvvz 208,140,192
buffer_load_dwordx4 v117, s[8:11], s81 offen offset:0 nt lds
v_smfmac_f32_16x16x64_bf16 v[208:211], v[132:135], v[176:183], v88
s_add_u32 m0, s80, 0x14400
s_add_u32 s81, s43, 0x140
s_ashr_i32 s100, s98, 31
s_add_u32 s96, s96, s98
s_addc_u32 s97, s97, s100
s_lshr_b32 s100, s2, 3
s_and_b32 s100, s100, 31
wv 4
s_barrier
rv 192,104,32768
rv 160,100,32768
s_lshl_b32 s100, s100, 13
rv 164,101,32768
s_add_u32 s101, s99, 0x1fff
s_and_b32 s101, s101, 0xffffe000
s_lshl_b32 s98, s101, 3
rv 176,105,32768
s_cmp_ge_u32 s100, s98
s_cselect_b32 s98, s98, 0
s_sub_u32 s100, s100, s98
rv 180,106,32768
s_lshl_b32 s98, s101, 2
buffer_load_dwordx4 v117, s[8:11], s81 offen offset:0 nt lds
ad 225,225,212
v_fma_f32 v229, v212, v212, v229
s_cmp_ge_u32 s100, s98
ad 225,225,213
v_fma_f32 v229, v213, v213, v229
s_cselect_b32 s98, s98, 0
aw 9,70
aw 21,71
ad 225,225,214
v_fma_f32 v229, v214, v214, v229
s_sub_u32 s100, s100, s98
ad 225,225,215
v_fma_f32 v229, v215, v215, v229
cv 70,212,213
cv 71,214,215
wl 8
mvvvz 212,140,196
wl 5
rv 196,109,32768
s_lshl_b32 s98, s101, 1
v_smfmac_f32_16x16x64_bf16 v[212:215], v[132:135], v[144:151], v88
s_cmp_ge_u32 s100, s98
rv 144,110,32768
rv 148,111,32768
s_cselect_b32 s98, s98, 0
s_sub_u32 s100, s100, s98
s_lshl_b32 s98, s101, 0
s_cmp_ge_u32 s100, s98
s_cselect_b32 s98, s98, 0
s_sub_u32 s100, s100, s98
s_sub_u32 s99, s99, 4
v_add_u32 v234, s100, v234
v_min_u32 v234, s99, v234
s_add_u32 m0, s80, 0x10800
v_add_co_u32 v232, vcc, s96, v234
s_add_u32 s81, s46, 0x100
v_mov_b32 v233, s97
v_addc_co_u32 v233, vcc, 0, v233, vcc
ad 226,226,216
v_fma_f32 v230, v216, v216, v230
v_lshl_or_b32 v80, v80, 16, v80
ad 226,226,217
v_fma_f32 v230, v217, v217, v230
v_and_b32 v136, v76, v90
v_and_b32 v137, v76, v91
v_and_b32 v138, v76, v92
v_and_b32 v139, v76, v93
v_and_b32 v128, v80, v60
v_and_b32 v129, v80, v61
v_smfmac_f32_16x16x64_bf16 v[200:203], v[136:139], v[152:159], v88
global_load_dword a254, v[232:233], off
v_smfmac_f32_16x16x64_bf16 v[204:207], v[136:139], v[168:175], v88
buffer_load_dwordx4 v118, s[8:11], s81 offen offset:0 nt lds
v_smfmac_f32_16x16x64_bf16 v[208:211], v[136:139], v[184:191], v88
s_add_u32 m0, s80, 0x14800
rv 152,84,96
rv 156,85,96
v_and_b32 v130, v80, v62
rv 168,102,32768
v_and_b32 v131, v80, v63
rv 172,103,32768
aw 145,72
rv 184,107,32768
aw 149,73
rv 188,108,32768
ad 226,226,218
ds_read_u16 v76, v89 offset:160
v_fma_f32 v230, v218, v218, v230
ad 226,226,219
v_fma_f32 v230, v219, v219, v230
cv 72,216,217
cv 73,218,219
wl 14
mvvvz 216,128,192
wl 5
rv 192,114,32768
s_add_u32 s81, s46, 0x140
v_smfmac_f32_16x16x64_bf16 v[212:215], v[136:139], v[152:159], v88
rv 152,112,32768
rv 156,113,32768
ad 227,227,220
ds_read_u16 v80, v89 offset:3264
v_fma_f32 v231, v220, v220, v231
ad 227,227,221
v_fma_f32 v231, v221, v221, v231
aw 2,74
aw 14,75
ad 227,227,222
v_fma_f32 v231, v222, v222, v231
ad 227,227,223
v_fma_f32 v231, v223, v223, v231
cv 74,220,221
cv 75,222,223
mvvvz 220,128,196
rv 196,86,128
buffer_load_dwordx4 v118, s[8:11], s81 offen offset:0 nt lds
s_add_u32 m0, s80, 0x10c00
s_add_u32 s81, s47, 0x100
v_and_b32 v120, v78, v90
v_and_b32 v121, v78, v91
v_and_b32 v122, v78, v92
v_and_b32 v123, v78, v93
ad 224,224,200
v_fma_f32 v228, v200, v200, v228
v_smfmac_f32_16x16x64_bf16 v[216:219], v[120:123], v[160:167], v88
buffer_load_dwordx4 v119, s[8:11], s81 offen offset:0 nt lds
v_smfmac_f32_16x16x64_bf16 v[220:223], v[120:123], v[176:183], v88
s_add_u32 m0, s80, 0x14c00
rv 160,82,128
rv 164,83,128
ad 224,224,201
ds_read_u16 v78, v68 offset:6304
rv 176,100,33280
v_fma_f32 v228, v201, v201, v228
rv 180,101,33280
v_and_b32 v124, v79, v90
v_and_b32 v125, v79, v91
v_and_b32 v126, v79, v92
v_and_b32 v127, v79, v93
aw 6,70
aw 18,71
wl 13
v_smfmac_f32_16x16x64_bf16 v[216:219], v[124:127], v[168:175], v88
wl 11
rv 168,84,128
ad 224,224,202
v_smfmac_f32_16x16x64_bf16 v[220:223], v[124:127], v[184:191], v88
s_add_u32 s81, s47, 0x140
rv 172,85,128
rv 184,102,33280
v_fma_f32 v228, v202, v202, v228
rv 188,103,33280
ad 224,224,203
ds_read_u16 v79, v89 offset:192
v_fma_f32 v228, v203, v203, v228
cv 70,200,201
cv 71,202,203
wl 14
mvvvz 200,128,192
rv 192,104,33280
ad 225,225,204
v_smfmac_f32_16x16x64_bf16 v[200:203], v[120:123], v[144:151], v88
wl 13
rv 144,105,33280
v_fma_f32 v229, v204, v204, v229
v_smfmac_f32_16x16x64_bf16 v[200:203], v[124:127], v[152:159], v88
rv 148,106,33280
rv 152,107,33280
ad 225,225,205
rv 156,108,33280
v_fma_f32 v229, v205, v205, v229
aw 10,72
aw 22,73
ad 225,225,206
v_fma_f32 v229, v206, v206, v229
ad 225,225,207
v_fma_f32 v229, v207, v207, v229
cv 72,204,205
cv 73,206,207
wl 15
mvvvz 204,128,196
wl 13
rv 196,109,33280
ad 226,226,208
v_smfmac_f32_16x16x64_bf16 v[204:207], v[120:123], v[160:167], v88
wl 9
rv 160,110,33280
v_fma_f32 v230, v208, v208, v230
v_smfmac_f32_16x16x64_bf16 v[204:207], v[124:127], v[168:175], v88
rv 164,111,33280
rv 168,112,33280
v_lshl_or_b32 v78, v78, 16, v78
rv 172,113,33280
ad 226,226,209
v_fma_f32 v230, v209, v209, v230
v_and_b32 v140, v78, v60
v_and_b32 v141, v78, v61
v_and_b32 v142, v78, v62
v_and_b32 v143, v78, v63
ds_read_u16 v78, v89 offset:3296
aw 146,74
aw 150,75
ad 226,226,210
v_fma_f32 v230, v210, v210, v230
ad 226,226,211
v_fma_f32 v230, v211, v211, v230
cv 74,208,209
cv 75,210,211
wl 10
mvvvz 208,140,192
rv 192,114,33280
ad 227,227,212
v_fma_f32 v231, v212, v212, v231
ad 227,227,213
v_fma_f32 v231, v213, v213, v231
aw 3,70
aw 15,71
ad 227,227,214
v_fma_f32 v231, v214, v214, v231
ad 227,227,215
v_fma_f32 v231, v215, v215, v231
cv 70,212,213
cv 71,214,215
wl 6
mvvvz 212,140,196
rv 196,86,160
ad 224,224,216
v_fma_f32 v228, v216, v216, v228
v_and_b32 v132, v76, v90
v_and_b32 v133, v76, v91
v_and_b32 v134, v76, v92
v_and_b32 v135, v76, v93
ad 224,224,217
v_fma_f32 v228, v217, v217, v228
v_smfmac_f32_16x16x64_bf16 v[208:211], v[132:135], v[176:183], v88
ds_read_u16 v76, v68 offset:6336
aw 7,72
v_smfmac_f32_16x16x64_bf16 v[212:215], v[132:135], v[144:151], v88
s_waitcnt vmcnt(8) lgkmcnt(2)
s_barrier
rv 176,82,160
rv 180,83,160
aw 19,73
rv 144,100,49152
ad 224,224,218
rv 148,101,49152
v_fma_f32 v228, v218, v218, v228
ad 224,224,219
v_fma_f32 v228, v219, v219, v228
cv 72,216,217
cv 73,218,219
mvvvz 216,140,192
rv 192,104,49152
ad 225,225,220
v_smfmac_f32_16x16x64_bf16 v[216:219], v[132:135], v[160:167], v88
rv 160,105,49152
rv 164,106,49152
v_fma_f32 v229, v220, v220, v229
ad 225,225,221
v_fma_f32 v229, v221, v221, v229
aw 11,74
aw 23,75
ad 225,225,222
v_fma_f32 v229, v222, v222, v229
ad 225,225,223
v_fma_f32 v229, v223, v223, v229
cv 74,220,221
cv 75,222,223
wl 8
mvvvz 220,140,196
wl 5
rv 196,109,49152
ad 226,226,200
v_smfmac_f32_16x16x64_bf16 v[220:223], v[132:135], v[176:183], v88
rv 176,110,49152
rv 180,111,49152
v_fma_f32 v230, v200, v200, v230
v_lshl_or_b32 v76, v76, 16, v76
ad 226,226,201
v_fma_f32 v230, v201, v201, v230
v_and_b32 v136, v77, v90
v_and_b32 v137, v77, v91
v_and_b32 v138, v77, v92
v_and_b32 v139, v77, v93
v_and_b32 v128, v76, v60
v_and_b32 v129, v76, v61
v_smfmac_f32_16x16x64_bf16 v[208:211], v[136:139], v[184:191], v88
rv 184,84,160
v_and_b32 v130, v76, v62
v_smfmac_f32_16x16x64_bf16 v[212:215], v[136:139], v[152:159], v88
rv 188,85,160
v_and_b32 v131, v76, v63
v_smfmac_f32_16x16x64_bf16 v[216:219], v[136:139], v[168:175], v88
rv 152,102,49152
rv 156,103,49152
aw 147,70
rv 168,107,49152
aw 151,71
rv 172,108,49152
ad 226,226,202
ds_read_u16 v77, v89 offset:224
v_fma_f32 v230, v202, v202, v230
ad 226,226,203
v_fma_f32 v230, v203, v203, v230
cv 70,200,201
cv 71,202,203
wl 12
mvvvz 200,128,192
wl 5
rv 192,114,49152
ad 227,227,204
v_smfmac_f32_16x16x64_bf16 v[220:223], v[136:139], v[184:191], v88
rv 184,112,49152
rv 188,113,49152
v_fma_f32 v231, v204, v204, v231
ds_read_u16 v76, v89 offset:3328
ad 227,227,205
v_fma_f32 v231, v205, v205, v231
aw 24,72
aw 36,73
ad 227,227,206
v_fma_f32 v231, v206, v206, v231
ad 227,227,207
v_fma_f32 v231, v207, v207, v231
cv 72,204,205
cv 73,206,207
mvvvz 204,128,196
rv 196,86,192
v_and_b32 v120, v79, v90
v_and_b32 v121, v79, v91
v_and_b32 v122, v79, v92
v_and_b32 v123, v79, v93
ad 224,224,208
v_fma_f32 v228, v208, v208, v228
v_smfmac_f32_16x16x64_bf16 v[200:203], v[120:123], v[144:151], v88
buffer_load_dwordx4 v119, s[8:11], s81 offen offset:0 nt lds
v_smfmac_f32_16x16x64_bf16 v[204:207], v[120:123], v[160:167], v88
s_add_u32 m0, s80, 0
rv 144,82,192
rv 148,83,192
ad 224,224,209
ds_read_u16 v79, v68 offset:6368
rv 160,100,49664
v_fma_f32 v228, v209, v209, v228
rv 164,101,49664
v_and_b32 v124, v80, v90
v_and_b32 v125, v80, v91
v_and_b32 v126, v80, v92
v_and_b32 v127, v80, v93
aw 28,74
aw 40,75
wl 13
v_smfmac_f32_16x16x64_bf16 v[200:203], v[124:127], v[152:159], v88
wl 11
rv 152,84,192
ad 224,224,210
v_smfmac_f32_16x16x64_bf16 v[204:207], v[124:127], v[168:175], v88
s_add_u32 s81, s42, 0x180
rv 156,85,192
rv 168,102,49664
v_fma_f32 v228, v210, v210, v228
rv 172,103,49664
ad 224,224,211
ds_read_u16 v80, v89 offset:256
v_fma_f32 v228, v211, v211, v228
cv 74,208,209
cv 75,210,211
wl 14
mvvvz 208,128,192
rv 192,104,49664
ad 225,225,212
v_smfmac_f32_16x16x64_bf16 v[208:211], v[120:123], v[176:183], v88
wl 13
buffer_load_dwordx4 v116, s[8:11], s81 offen offset:0 nt lds
v_smfmac_f32_16x16x64_bf16 v[208:211], v[124:127], v[184:191], v88
s_add_u32 m0, s80, 0x4000
rv 176,105,49664
rv 180,106,49664
v_fma_f32 v229, v212, v212, v229
rv 184,107,49664
ad 225,225,213
rv 188,108,49664
v_fma_f32 v229, v213, v213, v229
aw 32,70
aw 44,71
ad 225,225,214
v_fma_f32 v229, v214, v214, v229
ad 225,225,215
v_fma_f32 v229, v215, v215, v229
cv 70,212,213
cv 71,214,215
wl 15
mvvvz 212,128,196
wl 13
rv 196,109,49664
ad 226,226,216
v_smfmac_f32_16x16x64_bf16 v[212:215], v[120:123], v[144:151], v88
wl 9
rv 144,110,49664
v_fma_f32 v230, v216, v216, v230
v_smfmac_f32_16x16x64_bf16 v[212:215], v[124:127], v[152:159], v88
s_add_u32 s81, s42, 0x1c0
rv 148,111,49664
rv 152,112,49664
v_lshl_or_b32 v79, v79, 16, v79
rv 156,113,49664
ad 226,226,217
v_fma_f32 v230, v217, v217, v230
v_and_b32 v140, v79, v60
v_and_b32 v141, v79, v61
v_and_b32 v142, v79, v62
v_and_b32 v143, v79, v63
ds_read_u16 v79, v89 offset:3360
aw 152,72
aw 156,73
ad 226,226,218
v_fma_f32 v230, v218, v218, v230
ad 226,226,219
v_fma_f32 v230, v219, v219, v230
cv 72,216,217
cv 73,218,219
wl 10
mvvvz 216,140,192
rv 192,114,49664
ad 227,227,220
v_fma_f32 v231, v220, v220, v231
ad 227,227,221
v_fma_f32 v231, v221, v221, v231
aw 25,74
aw 37,75
ad 227,227,222
v_fma_f32 v231, v222, v222, v231
ad 227,227,223
v_fma_f32 v231, v223, v223, v231
cv 74,220,221
cv 75,222,223
wl 6
mvvvz 220,140,196
rv 196,86,224
ad 224,224,200
v_fma_f32 v228, v200, v200, v228
v_and_b32 v132, v77, v90
v_and_b32 v133, v77, v91
v_and_b32 v134, v77, v92
v_and_b32 v135, v77, v93
buffer_load_dwordx4 v116, s[8:11], s81 offen offset:0 nt lds
s_nop 0
v_smfmac_f32_16x16x64_bf16 v[216:219], v[132:135], v[160:167], v88
ds_read_u16 v77, v68 offset:6400
ad 224,224,201
v_smfmac_f32_16x16x64_bf16 v[220:223], v[132:135], v[176:183], v88
s_add_u32 m0, s80, 0x400
rv 160,82,224
rv 164,83,224
v_fma_f32 v228, v201, v201, v228
aw 29,70
aw 41,71
ad 224,224,202
v_fma_f32 v228, v202, v202, v228
ad 224,224,203
v_fma_f32 v228, v203, v203, v228
cv 70,200,201
cv 71,202,203
wl 4
mvvvz 200,140,192
v_add_u32 v244, 0x10000, v104
s_add_u32 s81, s43, 0x180
v_smfmac_f32_16x16x64_bf16 v[200:203], v[132:135], v[144:151], v88
wv 3
s_barrier
rv 192,244,0
ad 225,225,204
v_fma_f32 v229, v204, v204, v229
ad 225,225,205
v_fma_f32 v229, v205, v205, v229
aw 33,72
aw 45,73
ad 225,225,206
v_fma_f32 v229, v206, v206, v229
ad 225,225,207
v_fma_f32 v229, v207, v207, v229
cv 72,204,205
cv 73,206,207
wl 4
mvvvz 204,140,196
wl 1
buffer_load_dwordx4 v117, s[8:11], s81 offen offset:0 nt lds
v_smfmac_f32_16x16x64_bf16 v[204:207], v[132:135], v[160:167], v88
s_add_u32 m0, s80, 0x4400
s_add_u32 s81, s43, 0x1c0
v_add_u32 v249, 0x10000, v109
rv 196,249,0
s_add_u32 s48, s77, 0x1000
buffer_load_dwordx4 v117, s[8:11], s81 offen offset:0 nt lds
s_add_u32 m0, s80, 0x800
s_add_u32 s81, s46, 0x180
v_add_u32 v240, 0x10000, v100
rv 176,240,0
v_add_u32 v241, 0x10000, v101
rv 180,241,0
ad 226,226,208
v_fma_f32 v230, v208, v208, v230
v_lshl_or_b32 v77, v77, 16, v77
ad 226,226,209
v_fma_f32 v230, v209, v209, v230
v_and_b32 v136, v78, v90
v_and_b32 v137, v78, v91
v_and_b32 v138, v78, v92
v_and_b32 v139, v78, v93
v_and_b32 v128, v77, v60
v_and_b32 v129, v77, v61
v_smfmac_f32_16x16x64_bf16 v[216:219], v[136:139], v[168:175], v88
buffer_load_dwordx4 v118, s[8:11], s81 offen offset:0 nt lds
v_smfmac_f32_16x16x64_bf16 v[220:223], v[136:139], v[184:191], v88
rv 168,84,224
v_and_b32 v130, v77, v62
v_smfmac_f32_16x16x64_bf16 v[200:203], v[136:139], v[152:159], v88
s_add_u32 m0, s80, 0x4800
rv 172,85,224
ds_read_u16 v78, v89 offset:288
v_and_b32 v131, v77, v63
ds_read_u16 v77, v89 offset:3392
aw 153,74
aw 157,75
ad 226,226,210
v_fma_f32 v230, v210, v210, v230
ad 226,226,211
v_fma_f32 v230, v211, v211, v230
cv 74,208,209
cv 75,210,211
wl 7
mvvvz 208,128,192
v_add_u32 v242, 0x10000, v102
v_add_u32 v243, 0x10000, v103
v_add_u32 v254, 0x10000, v114
s_add_u32 s81, s46, 0x1c0
rv 184,242,0
v_add_u32 v36, 0x15000, v100
v_add_u32 v37, 0x15000, v101
v_add_u32 v38, 0x15000, v102
v_add_u32 v39, 0x15000, v103
ad 227,227,212
v_fma_f32 v231, v212, v212, v231
wl 3
v_smfmac_f32_16x16x64_bf16 v[204:207], v[136:139], v[168:175], v88
rv 188,243,0
rv 192,254,0
ad 227,227,213
v_fma_f32 v231, v213, v213, v231
v_add_u32 v40, 0x15000, v104
v_add_u32 v41, 0x15000, v105
v_add_u32 v42, 0x15000, v106
v_add_u32 v43, 0x15000, v107
aw 26,70
aw 38,71
ad 227,227,214
v_fma_f32 v231, v214, v214, v231
ad 227,227,215
v_fma_f32 v231, v215, v215, v231
cv 70,212,213
cv 71,214,215
mvvvz 212,128,196
rv 196,86,256
buffer_store_dwordx4 v[36:39], v1, s[12:15], s77 offen offset:0
buffer_load_dwordx4 v118, s[8:11], s81 offen offset:0 nt lds
s_add_u32 m0, s80, 0xc00
buffer_store_dwordx4 v[40:43], v1, s[12:15], s77 offen offset:1024
s_add_u32 s81, s47, 0x180
v_and_b32 v120, v80, v90
v_and_b32 v121, v80, v91
v_and_b32 v122, v80, v92
v_and_b32 v123, v80, v93
v_add_u32 v245, 0x10000, v105
v_add_u32 v246, 0x10000, v106
v_smfmac_f32_16x16x64_bf16 v[208:211], v[120:123], v[176:183], v88
rv 144,245,0
rv 148,246,0
v_add_u32 v250, 0x10000, v110
rv 160,250,0
v_add_u32 v251, 0x10000, v111
rv 164,251,0
ad 224,224,216
rv 176,82,256
v_fma_f32 v228, v216, v216, v228
rv 180,83,256
ad 224,224,217
ds_read_u16 v80, v68 offset:6432
v_fma_f32 v228, v217, v217, v228
v_and_b32 v124, v76, v90
v_and_b32 v125, v76, v91
v_and_b32 v126, v76, v92
v_and_b32 v127, v76, v93
aw 30,72
aw 42,73
wl 9
v_smfmac_f32_16x16x64_bf16 v[208:211], v[124:127], v[184:191], v88
wl 5
buffer_load_dwordx4 v119, s[8:11], s81 offen offset:0 nt lds
v_smfmac_f32_16x16x64_bf16 v[212:215], v[120:123], v[144:151], v88
s_add_u32 m0, s80, 0x4c00
rv 184,84,256
rv 188,85,256
ad 224,224,218
rv 144,240,512
v_fma_f32 v228, v218, v218, v228
rv 148,241,512
ad 224,224,219
ds_read_u16 v76, v89 offset:320
v_fma_f32 v228, v219, v219, v228
cv 72,216,217
cv 73,218,219
mvvvz 216,128,192
wl 8
rv 192,244,512
v_add_u32 v247, 0x10000, v107
v_smfmac_f32_16x16x64_bf16 v[216:219], v[120:123], v[160:167], v88
s_add_u32 s81, s47, 0x1c0
rv 152,247,0
rv 160,245,512
v_add_u32 v248, 0x10000, v108
rv 156,248,0
v_add_u32 v252, 0x10000, v112
rv 168,252,0
v_add_u32 v253, 0x10000, v113
rv 172,253,0
ad 225,225,220
rv 164,246,512
v_fma_f32 v229, v220, v220, v229
ad 225,225,221
v_fma_f32 v229, v221, v221, v229
aw 34,74
aw 46,75
ad 225,225,222
v_fma_f32 v229, v222, v222, v229
ad 225,225,223
v_fma_f32 v229, v223, v223, v229
cv 74,220,221
cv 75,222,223
mvvvz 220,128,196
wl 13
rv 196,249,512
v_and_b32 v94, 15, v0
v_smfmac_f32_16x16x64_bf16 v[220:223], v[120:123], v[176:183], v88
wl 4
rv 176,250,512
v_sub_u32 v98, v96, v98
v_smfmac_f32_16x16x64_bf16 v[212:215], v[124:127], v[152:159], v88
rv 152,242,512
v_lshlrev_b32 v94, 3, v94
v_smfmac_f32_16x16x64_bf16 v[220:223], v[124:127], v[184:191], v88
wl 4
rv 156,243,512
v_mul_lo_u32 v97, v97, s39
v_smfmac_f32_16x16x64_bf16 v[216:219], v[124:127], v[168:175], v88
rv 168,247,512
rv 172,248,512
v_mul_u32_u24 v98, 0x300, v98
rv 180,251,512
v_add3_u32 v52, v97, v98, v94
rv 184,252,512
v_add_u32 v96, 2, v95
rv 188,253,512
ad 226,226,200
v_fma_f32 v230, v200, v200, v230
v_lshl_or_b32 v80, v80, 16, v80
v_subrev_u32 v97, s26, v96
ad 226,226,201
v_fma_f32 v230, v201, v201, v230
v_and_b32 v140, v80, v60
v_and_b32 v141, v80, v61
v_and_b32 v142, v80, v62
v_and_b32 v143, v80, v63
ds_read_u16 v80, v89 offset:3424
v_lshrrev_b32 v97, 31, v97
aw 154,70
aw 158,71
ad 226,226,202
v_fma_f32 v230, v202, v202, v230
v_sub_u32 v96, v96, v97
ad 226,226,203
v_fma_f32 v230, v203, v203, v230
cv 70,200,201
cv 71,202,203
mvvvz 200,140,192
rv 192,254,512
v_mul_u32_u24 v97, 37, v96
v_lshrrev_b32 v97, 8, v97
v_mul_u32_u24 v98, 7, v97
v_sub_u32 v98, v96, v98
v_mul_lo_u32 v97, v97, s39
v_mul_u32_u24 v98, 0x300, v98
v_add3_u32 v53, v97, v98, v94
v_add_u32 v96, 3, v95
v_subrev_u32 v97, s26, v96
v_lshrrev_b32 v97, 31, v97
v_sub_u32 v96, v96, v97
ad 227,227,204
v_fma_f32 v231, v204, v204, v231
v_mul_u32_u24 v97, 37, v96
ad 227,227,205
v_fma_f32 v231, v205, v205, v231
v_lshrrev_b32 v97, 8, v97
aw 27,72
aw 39,73
ad 227,227,206
v_fma_f32 v231, v206, v206, v231
v_mul_u32_u24 v98, 7, v97
ad 227,227,207
v_fma_f32 v231, v207, v207, v231
cv 72,204,205
cv 73,206,207
wl 10
mvvvz 204,140,196
s_waitcnt vmcnt(9) lgkmcnt(0)
s_barrier
rv 196,86,288
v_sub_u32 v98, v96, v98
v_mul_lo_u32 v97, v97, s39
v_mul_u32_u24 v98, 0x300, v98
v_add3_u32 v54, v97, v98, v94
v_add_u32 v96, 4, v95
v_add_u32 v44, 0x15000, v108
v_add_u32 v45, 0x15000, v109
v_add_u32 v46, 0x15000, v110
v_add_u32 v47, 0x15000, v111
v_subrev_u32 v97, s26, v96
v_lshrrev_b32 v97, 31, v97
v_sub_u32 v96, v96, v97
v_mul_u32_u24 v97, 37, v96
v_lshrrev_b32 v97, 8, v97
v_mul_u32_u24 v98, 7, v97
v_sub_u32 v98, v96, v98
v_mul_lo_u32 v97, v97, s39
v_mul_u32_u24 v98, 0x300, v98
v_add3_u32 v55, v97, v98, v94
v_add_u32 v96, 17, v95
v_subrev_u32 v97, s26, v96
v_lshrrev_b32 v97, 31, v97
ad 224,224,208
v_fma_f32 v228, v208, v208, v228
v_and_b32 v132, v78, v90
v_and_b32 v133, v78, v91
v_and_b32 v134, v78, v92
v_and_b32 v135, v78, v93
v_sub_u32 v96, v96, v97
ad 224,224,209
v_smfmac_f32_16x16x64_bf16 v[200:203], v[132:135], v[144:151], v88
buffer_store_dwordx4 v[44:47], v1, s[12:15], s77 offen offset:2048
v_smfmac_f32_16x16x64_bf16 v[204:207], v[132:135], v[160:167], v88
ds_read_u16 v78, v68 offset:6464
rv 144,82,288
rv 148,83,288
v_fma_f32 v228, v209, v209, v228
rv 160,240,16384
v_mul_u32_u24 v97, 37, v96
rv 164,241,16384
aw 31,74
aw 43,75
ad 224,224,210
v_fma_f32 v228, v210, v210, v228
v_lshrrev_b32 v97, 8, v97
ad 224,224,211
v_fma_f32 v228, v211, v211, v228
cv 74,208,209
cv 75,210,211
mvvvz 208,140,192
rv 192,244,16384
v_mul_u32_u24 v98, 7, v97
v_smfmac_f32_16x16x64_bf16 v[208:211], v[132:135], v[176:183], v88
rv 176,245,16384
rv 180,246,16384
v_sub_u32 v98, v96, v98
v_mul_lo_u32 v97, v97, s39
v_mul_u32_u24 v98, 0x300, v98
v_add3_u32 v56, v97, v98, v94
v_add_u32 v96, 18, v95
v_subrev_u32 v97, s26, v96
v_mov_b32 v115, 0
v_lshrrev_b32 v97, 31, v97
v_add_u32 v48, 0x15000, v112
v_add_u32 v49, 0x15000, v113
v_add_u32 v50, 0x15000, v114
v_add_u32 v51, 0x15000, v115
v_sub_u32 v96, v96, v97
v_mul_u32_u24 v97, 37, v96
v_lshrrev_b32 v97, 8, v97
ad 225,225,212
v_fma_f32 v229, v212, v212, v229
v_mul_u32_u24 v98, 7, v97
ad 225,225,213
v_fma_f32 v229, v213, v213, v229
v_sub_u32 v98, v96, v98
aw 35,70
aw 47,71
ad 225,225,214
v_fma_f32 v229, v214, v214, v229
v_mul_lo_u32 v97, v97, s39
v_mul_u32_u24 v98, 0x300, v98
ad 225,225,215
v_fma_f32 v229, v215, v215, v229
cv 70,212,213
cv 71,214,215
wl 8
mvvvz 212,140,196
wl 5
buffer_store_dwordx4 v[48:51], v1, s[12:15], s77 offen offset:3072
v_smfmac_f32_16x16x64_bf16 v[212:215], v[132:135], v[144:151], v88
rv 196,249,16384
rv 144,250,16384
v_add3_u32 v57, v97, v98, v94
rv 148,251,16384
v_add_u32 v96, 19, v95
v_subrev_u32 v97, s26, v96
v_lshrrev_b32 v97, 31, v97
v_sub_u32 v96, v96, v97
v_mul_u32_u24 v97, 37, v96
v_lshrrev_b32 v97, 8, v97
v_mul_u32_u24 v98, 7, v97
v_sub_u32 v98, v96, v98
v_mul_lo_u32 v97, v97, s39
v_mul_u32_u24 v98, 0x300, v98
v_add3_u32 v58, v97, v98, v94
v_add_u32 v96, 20, v95
v_subrev_u32 v97, s26, v96
v_lshrrev_b32 v97, 31, v97
v_sub_u32 v96, v96, v97
ad 226,226,216
v_fma_f32 v230, v216, v216, v230
v_lshl_or_b32 v78, v78, 16, v78
v_mul_u32_u24 v97, 37, v96
ad 226,226,217
v_fma_f32 v230, v217, v217, v230
v_and_b32 v136, v79, v90
v_and_b32 v137, v79, v91
v_and_b32 v138, v79, v92
v_and_b32 v139, v79, v93
v_and_b32 v128, v78, v60
v_and_b32 v129, v78, v61
v_smfmac_f32_16x16x64_bf16 v[200:203], v[136:139], v[152:159], v88
buffer_load_dwordx4 v119, s[8:11], s81 offen offset:0 nt lds
v_smfmac_f32_16x16x64_bf16 v[204:207], v[136:139], v[168:175], v88
buffer_store_dwordx4 v[52:55], v1, s[12:15], s48 offen offset:0
v_smfmac_f32_16x16x64_bf16 v[208:211], v[136:139], v[184:191], v88
s_add_u32 m0, s80, 0x8000
rv 152,84,288
rv 156,85,288
v_and_b32 v130, v78, v62
rv 168,242,16384
v_and_b32 v131, v78, v63
rv 172,243,16384
v_lshrrev_b32 v97, 8, v97
rv 184,247,16384
aw 155,72
rv 188,248,16384
aw 159,73
ds_read_u16 v79, v89 offset:352
ad 226,226,218
v_fma_f32 v230, v218, v218, v230
v_mul_u32_u24 v98, 7, v97
ad 226,226,219
v_fma_f32 v230, v219, v219, v230
cv 72,216,217
cv 73,218,219
wl 12
mvvvz 216,128,192
wl 5
rv 192,254,16384
v_sub_u32 v98, v96, v98
v_smfmac_f32_16x16x64_bf16 v[212:215], v[136:139], v[152:159], v88
s_add_u32 s81, s42, 0x200
rv 152,252,16384
rv 156,253,16384
v_mul_lo_u32 v97, v97, s39
ds_read_u16 v78, v89 offset:3456
v_mul_u32_u24 v98, 0x300, v98
v_add3_u32 v59, v97, v98, v94
v_add_u32 v96, 33, v95
v_subrev_u32 v97, s26, v96
v_lshrrev_b32 v97, 31, v97
v_sub_u32 v96, v96, v97
v_mul_u32_u24 v97, 37, v96
v_lshrrev_b32 v97, 8, v97
v_mul_u32_u24 v98, 7, v97
ad 227,227,220
v_fma_f32 v231, v220, v220, v231
v_sub_u32 v98, v96, v98
ad 227,227,221
v_fma_f32 v231, v221, v221, v231
v_mul_lo_u32 v97, v97, s39
v_mul_u32_u24 v98, 0x300, v98
aw 48,74
aw 60,75
ad 227,227,222
v_fma_f32 v231, v222, v222, v231
v_add3_u32 v64, v97, v98, v94
v_add_u32 v96, 34, v95
ad 227,227,223
v_fma_f32 v231, v223, v223, v231
cv 74,220,221
cv 75,222,223
mvvvz 220,128,196
rv 196,86,320
v_subrev_u32 v97, s26, v96
v_lshrrev_b32 v97, 31, v97
v_sub_u32 v96, v96, v97
v_mul_u32_u24 v97, 37, v96
v_lshrrev_b32 v97, 8, v97
v_mul_u32_u24 v98, 7, v97
v_sub_u32 v98, v96, v98
v_mul_lo_u32 v97, v97, s39
v_mul_u32_u24 v98, 0x300, v98
v_add3_u32 v65, v97, v98, v94
v_add_u32 v96, 35, v95
v_subrev_u32 v97, s26, v96
v_lshrrev_b32 v97, 31, v97
v_and_b32 v120, v76, v90
v_and_b32 v121, v76, v91
v_and_b32 v122, v76, v92
v_and_b32 v123, v76, v93
v_sub_u32 v96, v96, v97
buffer_load_dwordx4 v116, s[8:11], s81 offen offset:0 nt lds
v_smfmac_f32_16x16x64_bf16 v[216:219], v[120:123], v[160:167], v88
buffer_store_dwordx4 v[56:59], v1, s[12:15], s48 offen offset:1024
v_smfmac_f32_16x16x64_bf16 v[220:223], v[120:123], v[176:183], v88
s_add_u32 m0, s80, 0xc000
rv 160,82,320
rv 164,83,320
v_mul_u32_u24 v97, 37, v96
ds_read_u16 v76, v68 offset:6496
rv 176,240,16896
v_lshrrev_b32 v97, 8, v97
rv 180,241,16896
ad 224,224,200
v_fma_f32 v228, v200, v200, v228
v_mul_u32_u24 v98, 7, v97
s_add_u32 s81, s42, 0x240
ad 224,224,201
v_fma_f32 v228, v201, v201, v228
v_and_b32 v124, v77, v90
v_and_b32 v125, v77, v91
v_and_b32 v126, v77, v92
v_and_b32 v127, v77, v93
v_sub_u32 v98, v96, v98
aw 52,70
wl 13
v_smfmac_f32_16x16x64_bf16 v[216:219], v[124:127], v[168:175], v88
wl 11
rv 168,84,320
aw 64,71
v_smfmac_f32_16x16x64_bf16 v[220:223], v[124:127], v[184:191], v88
rv 172,85,320
rv 184,242,16896
ad 224,224,202
rv 188,243,16896
v_fma_f32 v228, v202, v202, v228
ds_read_u16 v77, v89 offset:384
v_mul_lo_u32 v97, v97, s39
v_mul_u32_u24 v98, 0x300, v98
ad 224,224,203
v_fma_f32 v228, v203, v203, v228
cv 70,200,201
cv 71,202,203
wl 14
mvvvz 200,128,192
rv 192,244,16896
v_add3_u32 v66, v97, v98, v94
v_smfmac_f32_16x16x64_bf16 v[200:203], v[120:123], v[144:151], v88
wl 13
buffer_load_dwordx4 v116, s[8:11], s81 offen offset:0 nt lds
v_smfmac_f32_16x16x64_bf16 v[200:203], v[124:127], v[152:159], v88
s_add_u32 m0, s80, 0x8400
rv 144,245,16896
rv 148,246,16896
v_add_u32 v96, 36, v95
rv 152,247,16896
v_subrev_u32 v97, s26, v96
rv 156,248,16896
v_lshrrev_b32 v97, 31, v97
v_sub_u32 v96, v96, v97
v_mul_u32_u24 v97, 37, v96
v_lshrrev_b32 v97, 8, v97
v_mul_u32_u24 v98, 7, v97
v_sub_u32 v98, v96, v98
v_mul_lo_u32 v97, v97, s39
v_mul_u32_u24 v98, 0x300, v98
ad 225,225,204
v_fma_f32 v229, v204, v204, v229
v_add3_u32 v67, v97, v98, v94
ad 225,225,205
v_fma_f32 v229, v205, v205, v229
aw 56,72
aw 68,73
ad 225,225,206
v_fma_f32 v229, v206, v206, v229
ad 225,225,207
v_fma_f32 v229, v207, v207, v229
cv 72,204,205
cv 73,206,207
wl 15
mvvvz 204,128,196
wl 13
buffer_store_dwordx4 v[64:67], v1, s[12:15], s48 offen offset:2048
v_smfmac_f32_16x16x64_bf16 v[204:207], v[120:123], v[160:167], v88
wl 8
rv 196,249,16896
s_add_u32 s81, s43, 0x200
v_smfmac_f32_16x16x64_bf16 v[204:207], v[124:127], v[168:175], v88
rv 160,250,16896
rv 164,251,16896
ad 226,226,208
rv 168,252,16896
v_fma_f32 v230, v208, v208, v230
rv 172,253,16896
v_lshl_or_b32 v76, v76, 16, v76
ad 226,226,209
v_fma_f32 v230, v209, v209, v230
v_and_b32 v140, v76, v60
v_and_b32 v141, v76, v61
v_and_b32 v142, v76, v62
v_and_b32 v143, v76, v63
ds_read_u16 v76, v89 offset:3488
aw 160,74
aw 164,75
ad 226,226,210
v_fma_f32 v230, v210, v210, v230
ad 226,226,211
v_fma_f32 v230, v211, v211, v230
cv 74,208,209
cv 75,210,211
wl 10
mvvvz 208,140,192
rv 192,254,16896
ad 227,227,212
v_fma_f32 v231, v212, v212, v231
ad 227,227,213
v_fma_f32 v231, v213, v213, v231
aw 49,70
aw 61,71
ad 227,227,214
v_fma_f32 v231, v214, v214, v231
ad 227,227,215
v_fma_f32 v231, v215, v215, v231
cv 70,212,213
cv 71,214,215
wl 6
mvvvz 212,140,196
rv 196,86,352
buffer_load_dwordx4 v117, s[8:11], s81 offen offset:0 nt lds
s_add_u32 m0, s80, 0xc400
s_add_u32 s81, s43, 0x240
ad 224,224,216
v_fma_f32 v228, v216, v216, v228
v_and_b32 v132, v79, v90
v_and_b32 v133, v79, v91
v_and_b32 v134, v79, v92
v_and_b32 v135, v79, v93
ad 224,224,217
v_fma_f32 v228, v217, v217, v228
v_smfmac_f32_16x16x64_bf16 v[208:211], v[132:135], v[176:183], v88
buffer_load_dwordx4 v117, s[8:11], s81 offen offset:0 nt lds
v_smfmac_f32_16x16x64_bf16 v[212:215], v[132:135], v[144:151], v88
s_waitcnt vmcnt(10) lgkmcnt(1)
s_barrier
ds_read_u16 v79, v68 offset:6528
rv 176,82,352
rv 180,83,352
aw 53,72
rv 144,100,0
aw 65,73
rv 148,101,0
ad 224,224,218
v_fma_f32 v228, v218, v218, v228
ad 224,224,219
v_fma_f32 v228, v219, v219, v228
cv 72,216,217
cv 73,218,219
mvvvz 216,140,192
rv 192,104,0
ad 225,225,220
v_smfmac_f32_16x16x64_bf16 v[216:219], v[132:135], v[160:167], v88
s_add_u32 m0, s80, 0x8800
rv 160,105,0
rv 164,106,0
v_fma_f32 v229, v220, v220, v229
ad 225,225,221
v_fma_f32 v229, v221, v221, v229
aw 57,74
aw 69,75
ad 225,225,222
v_fma_f32 v229, v222, v222, v229
ad 225,225,223
v_fma_f32 v229, v223, v223, v229
cv 74,220,221
cv 75,222,223
wl 8
mvvvz 220,140,196
wl 5
rv 196,109,0
s_add_u32 s81, s46, 0x200
v_smfmac_f32_16x16x64_bf16 v[220:223], v[132:135], v[176:183], v88
rv 176,110,0
rv 180,111,0
ad 226,226,200
v_fma_f32 v230, v200, v200, v230
v_lshl_or_b32 v79, v79, 16, v79
ad 226,226,201
v_fma_f32 v230, v201, v201, v230
v_and_b32 v136, v80, v90
v_and_b32 v137, v80, v91
v_and_b32 v138, v80, v92
v_and_b32 v139, v80, v93
v_and_b32 v128, v79, v60
v_and_b32 v129, v79, v61
v_smfmac_f32_16x16x64_bf16 v[208:211], v[136:139], v[184:191], v88
buffer_load_dwordx4 v118, s[8:11], s81 offen offset:0 nt lds
v_smfmac_f32_16x16x64_bf16 v[212:215], v[136:139], v[152:159], v88
rv 184,84,352
v_and_b32 v130, v79, v62
v_smfmac_f32_16x16x64_bf16 v[216:219], v[136:139], v[168:175], v88
s_add_u32 m0, s80, 0xc800
rv 188,85,352
rv 152,102,0
v_and_b32 v131, v79, v63
rv 156,103,0
aw 161,70
rv 168,107,0
aw 165,71
rv 172,108,0
ad 226,226,202
ds_read_u16 v80, v89 offset:416
v_fma_f32 v230, v202, v202, v230
ad 226,226,203
v_fma_f32 v230, v203, v203, v230
cv 70,200,201
cv 71,202,203
wl 12
mvvvz 200,128,192
wl 5
rv 192,114,0
s_add_u32 s81, s46, 0x240
v_smfmac_f32_16x16x64_bf16 v[220:223], v[136:139], v[184:191], v88
rv 184,112,0
rv 188,113,0
ad 227,227,204
ds_read_u16 v79, v89 offset:3520
v_fma_f32 v231, v204, v204, v231
ad 227,227,205
v_fma_f32 v231, v205, v205, v231
aw 50,72
aw 62,73
ad 227,227,206
v_fma_f32 v231, v206, v206, v231
ad 227,227,207
v_fma_f32 v231, v207, v207, v231
cv 72,204,205
cv 73,206,207
mvvvz 204,128,196
rv 196,86,384
buffer_load_dwordx4 v118, s[8:11], s81 offen offset:0 nt lds
s_add_u32 m0, s80, 0x8c00
s_add_u32 s81, s47, 0x200
v_and_b32 v120, v77, v90
v_and_b32 v121, v77, v91
v_and_b32 v122, v77, v92
v_and_b32 v123, v77, v93
ad 224,224,208
v_fma_f32 v228, v208, v208, v228
v_smfmac_f32_16x16x64_bf16 v[200:203], v[120:123], v[144:151], v88
buffer_load_dwordx4 v119, s[8:11], s81 offen offset:0 nt lds
v_smfmac_f32_16x16x64_bf16 v[204:207], v[120:123], v[160:167], v88
s_add_u32 m0, s80, 0xcc00
rv 144,82,384
rv 148,83,384
ad 224,224,209
ds_read_u16 v77, v68 offset:6560
rv 160,100,512
v_fma_f32 v228, v209, v209, v228
rv 164,101,512
v_and_b32 v124, v78, v90
v_and_b32 v125, v78, v91
v_and_b32 v126, v78, v92
v_and_b32 v127, v78, v93
aw 54,74
aw 66,75
wl 13
v_smfmac_f32_16x16x64_bf16 v[200:203], v[124:127], v[152:159], v88
wl 11
rv 152,84,384
ad 224,224,210
v_smfmac_f32_16x16x64_bf16 v[204:207], v[124:127], v[168:175], v88
s_add_u32 s81, s47, 0x240
rv 156,85,384
rv 168,102,512
v_fma_f32 v228, v210, v210, v228
rv 172,103,512
ad 224,224,211
ds_read_u16 v78, v89 offset:448
v_fma_f32 v228, v211, v211, v228
cv 74,208,209
cv 75,210,211
wl 14
mvvvz 208,128,192
rv 192,104,512
ad 225,225,212
v_smfmac_f32_16x16x64_bf16 v[208:211], v[120:123], v[176:183], v88
wl 13
rv 176,105,512
v_fma_f32 v229, v212, v212, v229
v_smfmac_f32_16x16x64_bf16 v[208:211], v[124:127], v[184:191], v88
rv 180,106,512
rv 184,107,512
ad 225,225,213
rv 188,108,512
v_fma_f32 v229, v213, v213, v229
aw 58,70
aw 70,71
ad 225,225,214
v_fma_f32 v229, v214, v214, v229
ad 225,225,215
v_fma_f32 v229, v215, v215, v229
cv 70,212,213
cv 71,214,215
wl 15
mvvvz 212,128,196
wl 13
rv 196,109,512
ad 226,226,216
v_smfmac_f32_16x16x64_bf16 v[212:215], v[120:123], v[144:151], v88
wl 9
rv 144,110,512
v_fma_f32 v230, v216, v216, v230
v_smfmac_f32_16x16x64_bf16 v[212:215], v[124:127], v[152:159], v88
rv 148,111,512
rv 152,112,512
v_lshl_or_b32 v77, v77, 16, v77
rv 156,113,512
ad 226,226,217
v_fma_f32 v230, v217, v217, v230
v_and_b32 v140, v77, v60
v_and_b32 v141, v77, v61
v_and_b32 v142, v77, v62
v_and_b32 v143, v77, v63
ds_read_u16 v77, v89 offset:3552
aw 162,72
aw 166,73
ad 226,226,218
v_fma_f32 v230, v218, v218, v230
ad 226,226,219
v_fma_f32 v230, v219, v219, v230
cv 72,216,217
cv 73,218,219
wl 10
mvvvz 216,140,192
rv 192,114,512
ad 227,227,220
v_fma_f32 v231, v220, v220, v231
ad 227,227,221
v_fma_f32 v231, v221, v221, v231
aw 51,74
aw 63,75
ad 227,227,222
v_fma_f32 v231, v222, v222, v231
ad 227,227,223
v_fma_f32 v231, v223, v223, v231
cv 74,220,221
cv 75,222,223
wl 6
mvvvz 220,140,196
rv 196,86,416
buffer_load_dwordx4 v119, s[8:11], s81 offen offset:0 nt lds
s_add_u32 m0, s80, 0x10000
s_add_u32 s81, s42, 0x280
ad 224,224,200
v_fma_f32 v228, v200, v200, v228
v_and_b32 v132, v80, v90
v_and_b32 v133, v80, v91
v_and_b32 v134, v80, v92
v_and_b32 v135, v80, v93
ad 224,224,201
v_fma_f32 v228, v201, v201, v228
v_smfmac_f32_16x16x64_bf16 v[216:219], v[132:135], v[160:167], v88
ds_read_u16 v80, v68 offset:6592
aw 55,70
v_smfmac_f32_16x16x64_bf16 v[220:223], v[132:135], v[176:183], v88
s_waitcnt vmcnt(11) lgkmcnt(2)
s_barrier
rv 160,82,416
rv 164,83,416
aw 67,71
rv 176,100,16384
ad 224,224,202
rv 180,101,16384
v_fma_f32 v228, v202, v202, v228
ad 224,224,203
v_fma_f32 v228, v203, v203, v228
cv 70,200,201
cv 71,202,203
mvvvz 200,140,192
buffer_load_dwordx4 v116, s[8:11], s81 offen offset:0 nt lds
v_smfmac_f32_16x16x64_bf16 v[200:203], v[132:135], v[144:151], v88
s_add_u32 m0, s80, 0x14000
rv 192,104,16384
rv 144,105,16384
ad 225,225,204
rv 148,106,16384
v_fma_f32 v229, v204, v204, v229
ad 225,225,205
v_fma_f32 v229, v205, v205, v229
aw 59,72
aw 71,73
ad 225,225,206
v_fma_f32 v229, v206, v206, v229
ad 225,225,207
v_fma_f32 v229, v207, v207, v229
cv 72,204,205
cv 73,206,207
wl 8
mvvvz 204,140,196
wl 5
rv 196,109,16384
v_and_b32 v136, v76, v90
v_smfmac_f32_16x16x64_bf16 v[204:207], v[132:135], v[160:167], v88
s_add_u32 s81, s42, 0x2c0
rv 160,110,16384
rv 164,111,16384
v_and_b32 v137, v76, v91
v_and_b32 v138, v76, v92
v_and_b32 v139, v76, v93
ad 226,226,208
v_fma_f32 v230, v208, v208, v230
v_smfmac_f32_16x16x64_bf16 v[216:219], v[136:139], v[168:175], v88
buffer_load_dwordx4 v116, s[8:11], s81 offen offset:0 nt lds
v_smfmac_f32_16x16x64_bf16 v[220:223], v[136:139], v[184:191], v88
rv 168,84,416
v_lshl_or_b32 v80, v80, 16, v80
v_smfmac_f32_16x16x64_bf16 v[200:203], v[136:139], v[152:159], v88
s_add_u32 m0, s80, 0x10400
rv 172,85,416
rv 184,102,16384
ad 226,226,209
rv 188,103,16384
v_fma_f32 v230, v209, v209, v230
rv 152,107,16384
v_and_b32 v128, v80, v60
rv 156,108,16384
v_and_b32 v129, v80, v61
ds_read_u16 v76, v89 offset:480
v_and_b32 v130, v80, v62
v_and_b32 v131, v80, v63
aw 163,74
aw 167,75
ad 226,226,210
v_fma_f32 v230, v210, v210, v230
ad 226,226,211
v_fma_f32 v230, v211, v211, v230
cv 74,208,209
wl 5
v_smfmac_f32_16x16x64_bf16 v[204:207], v[136:139], v[168:175], v88
s_add_u32 s81, s43, 0x280
rv 168,112,16384
rv 172,113,16384
cv 75,210,211
mvvvz 208,128,192
rv 192,114,16384
ad 227,227,212
ds_read_u16 v80, v89 offset:3584
v_fma_f32 v231, v212, v212, v231
ad 227,227,213
v_fma_f32 v231, v213, v213, v231
aw 72,70
aw 84,71
ad 227,227,214
v_fma_f32 v231, v214, v214, v231
ad 227,227,215
v_fma_f32 v231, v215, v215, v231
cv 70,212,213
cv 71,214,215
mvvvz 212,128,196
rv 196,86,448
v_and_b32 v120, v78, v90
v_and_b32 v121, v78, v91
v_and_b32 v122, v78, v92
v_and_b32 v123, v78, v93
ad 224,224,216
v_fma_f32 v228, v216, v216, v228
v_smfmac_f32_16x16x64_bf16 v[208:211], v[120:123], v[176:183], v88
buffer_load_dwordx4 v117, s[8:11], s81 offen offset:0 nt lds
v_smfmac_f32_16x16x64_bf16 v[212:215], v[120:123], v[144:151], v88
s_add_u32 m0, s80, 0x14400
rv 176,82,448
rv 180,83,448
ad 224,224,217
ds_read_u16 v78, v68 offset:6624
rv 144,100,16896
v_fma_f32 v228, v217, v217, v228
rv 148,101,16896
v_and_b32 v124, v79, v90
v_and_b32 v125, v79, v91
v_and_b32 v126, v79, v92
v_and_b32 v127, v79, v93
aw 76,72
aw 88,73
wl 13
v_smfmac_f32_16x16x64_bf16 v[208:211], v[124:127], v[184:191], v88
wl 11
rv 184,84,448
ad 224,224,218
v_smfmac_f32_16x16x64_bf16 v[212:215], v[124:127], v[152:159], v88
s_add_u32 s81, s43, 0x2c0
rv 188,85,448
rv 152,102,16896
v_fma_f32 v228, v218, v218, v228
rv 156,103,16896
ad 224,224,219
ds_read_u16 v79, v89 offset:512
v_fma_f32 v228, v219, v219, v228
cv 72,216,217
cv 73,218,219
wl 12
mvvvz 216,128,192
rv 192,104,16896
ad 225,225,220
v_smfmac_f32_16x16x64_bf16 v[216:219], v[120:123], v[160:167], v88
buffer_load_dwordx4 v117, s[8:11], s81 offen offset:0 nt lds
v_smfmac_f32_16x16x64_bf16 v[216:219], v[124:127], v[168:175], v88
s_add_u32 m0, s80, 0x10800
rv 160,105,16896
rv 164,106,16896
v_fma_f32 v229, v220, v220, v229
rv 168,107,16896
ad 225,225,221
rv 172,108,16896
v_fma_f32 v229, v221, v221, v229
aw 80,74
aw 92,75
ad 225,225,222
v_fma_f32 v229, v222, v222, v229
ad 225,225,223
v_fma_f32 v229, v223, v223, v229
cv 74,220,221
cv 75,222,223
wl 15
mvvvz 220,128,196
wl 13
rv 196,109,16896
ad 226,226,200
v_smfmac_f32_16x16x64_bf16 v[220:223], v[120:123], v[176:183], v88
wl 9
rv 176,110,16896
v_fma_f32 v230, v200, v200, v230
v_smfmac_f32_16x16x64_bf16 v[220:223], v[124:127], v[184:191], v88
s_add_u32 s81, s46, 0x280
rv 180,111,16896
rv 184,112,16896
v_lshl_or_b32 v78, v78, 16, v78
rv 188,113,16896
ad 226,226,201
v_fma_f32 v230, v201, v201, v230
v_and_b32 v140, v78, v60
v_and_b32 v141, v78, v61
v_and_b32 v142, v78, v62
v_and_b32 v143, v78, v63
ds_read_u16 v78, v89 offset:3616
aw 168,70
aw 172,71
ad 226,226,202
v_fma_f32 v230, v202, v202, v230
ad 226,226,203
v_fma_f32 v230, v203, v203, v230
cv 70,200,201
cv 71,202,203
wl 10
mvvvz 200,140,192
rv 192,114,16896
ad 227,227,204
v_fma_f32 v231, v204, v204, v231
ad 227,227,205
v_fma_f32 v231, v205, v205, v231
aw 73,72
aw 85,73
ad 227,227,206
v_fma_f32 v231, v206, v206, v231
ad 227,227,207
v_fma_f32 v231, v207, v207, v231
cv 72,204,205
cv 73,206,207
wl 6
mvvvz 204,140,196
rv 196,86,480
v_and_b32 v132, v76, v90
v_and_b32 v133, v76, v91
v_and_b32 v134, v76, v92
v_and_b32 v135, v76, v93
buffer_load_dword v8, v9, s[4:7], 0 offen offset:0 sc1
s_nop 0
v_smfmac_f32_16x16x64_bf16 v[200:203], v[132:135], v[144:151], v88
buffer_load_dwordx4 v118, s[8:11], s81 offen offset:0 nt lds
v_smfmac_f32_16x16x64_bf16 v[204:207], v[132:135], v[160:167], v88
s_add_u32 m0, s80, 0x14800
ds_read_u16 v76, v68 offset:6656
rv 144,82,480
rv 148,83,480
ad 224,224,208
v_fma_f32 v228, v208, v208, v228
ad 224,224,209
v_fma_f32 v228, v209, v209, v228
aw 77,74
aw 89,75
ad 224,224,210
v_fma_f32 v228, v210, v210, v228
ad 224,224,211
v_fma_f32 v228, v211, v211, v228
cv 74,208,209
cv 75,210,211
wl 4
mvvvz 208,140,192
v_and_b32 v136, v77, v90
v_and_b32 v137, v77, v91
v_smfmac_f32_16x16x64_bf16 v[208:211], v[132:135], v[176:183], v88
s_add_u32 s81, s46, 0x2c0
wv 7
s_barrier
rv 192,104,32768
rv 160,100,32768
v_and_b32 v138, v77, v92
rv 164,101,32768
v_and_b32 v139, v77, v93
ad 225,225,212
v_fma_f32 v229, v212, v212, v229
v_smfmac_f32_16x16x64_bf16 v[200:203], v[136:139], v[152:159], v88
buffer_load_dwordx4 v118, s[8:11], s81 offen offset:0 nt lds
v_smfmac_f32_16x16x64_bf16 v[204:207], v[136:139], v[168:175], v88
rv 152,84,480
ad 225,225,213
v_smfmac_f32_16x16x64_bf16 v[208:211], v[136:139], v[184:191], v88
s_add_u32 m0, s80, 0x10c00
rv 156,85,480
rv 168,102,32768
v_fma_f32 v229, v213, v213, v229
rv 172,103,32768
aw 81,70
rv 176,105,32768
aw 93,71
rv 180,106,32768
ad 225,225,214
rv 184,107,32768
v_fma_f32 v229, v214, v214, v229
rv 188,108,32768
ad 225,225,215
ds_read_u16 v77, v89 offset:544
v_fma_f32 v229, v215, v215, v229
cv 70,212,213
cv 71,214,215
wl 15
mvvvz 212,140,196
wl 12
rv 196,109,32768
s_add_u32 s81, s47, 0x280
v_smfmac_f32_16x16x64_bf16 v[212:215], v[132:135], v[144:151], v88
wl 8
rv 144,110,32768
ad 226,226,216
v_smfmac_f32_16x16x64_bf16 v[212:215], v[136:139], v[152:159], v88
rv 148,111,32768
rv 152,112,32768
v_fma_f32 v230, v216, v216, v230
rv 156,113,32768
v_lshl_or_b32 v76, v76, 16, v76
ad 226,226,217
v_fma_f32 v230, v217, v217, v230
v_and_b32 v128, v76, v60
v_and_b32 v129, v76, v61
v_and_b32 v130, v76, v62
v_and_b32 v131, v76, v63
aw 169,72
aw 173,73
ad 226,226,218
v_fma_f32 v230, v218, v218, v230
ad 226,226,219
v_fma_f32 v230, v219, v219, v230
cv 72,216,217
cv 73,218,219
mvvvz 216,128,192
rv 192,114,32768
ad 227,227,220
v_fma_f32 v231, v220, v220, v231
ad 227,227,221
v_fma_f32 v231, v221, v221, v231
aw 74,74
aw 86,75
ad 227,227,222
v_fma_f32 v231, v222, v222, v231
ad 227,227,223
v_fma_f32 v231, v223, v223, v231
cv 74,220,221
cv 75,222,223
wl 5
mvvvz 220,128,196
rv 196,86,512
v_and_b32 v120, v79, v90
v_and_b32 v121, v79, v91
v_and_b32 v122, v79, v92
v_and_b32 v123, v79, v93
buffer_load_dwordx4 v119, s[8:11], s81 offen offset:0 nt lds
s_nop 0
v_smfmac_f32_16x16x64_bf16 v[216:219], v[120:123], v[160:167], v88
ds_read_u16 v79, v68 offset:6688
s_add_u32 m0, s80, 0x14c00
v_smfmac_f32_16x16x64_bf16 v[220:223], v[120:123], v[176:183], v88
s_add_u32 s81, s47, 0x2c0
rv 160,82,512
rv 164,83,512
v_and_b32 v124, v80, v90
rv 176,100,33280
v_and_b32 v125, v80, v91
rv 180,101,33280
v_and_b32 v126, v80, v92
v_and_b32 v127, v80, v93
ad 224,224,200
v_fma_f32 v228, v200, v200, v228
v_smfmac_f32_16x16x64_bf16 v[216:219], v[124:127], v[168:175], v88
buffer_load_dwordx4 v119, s[8:11], s81 offen offset:0 nt lds
v_smfmac_f32_16x16x64_bf16 v[220:223], v[124:127], v[184:191], v88
rv 168,84,512
rv 172,85,512
ad 224,224,201
rv 184,102,33280
v_fma_f32 v228, v201, v201, v228
rv 188,103,33280
aw 78,70
aw 90,71
ad 224,224,202
v_fma_f32 v228, v202, v202, v228
ad 224,224,203
v_fma_f32 v228, v203, v203, v228
cv 70,200,201
cv 71,202,203
wl 10
mvvvz 200,128,192
rv 192,104,33280
ad 225,225,204
v_smfmac_f32_16x16x64_bf16 v[200:203], v[120:123], v[144:151], v88
rv 144,105,33280
v_fma_f32 v229, v204, v204, v229
v_smfmac_f32_16x16x64_bf16 v[200:203], v[124:127], v[152:159], v88
rv 148,106,33280
rv 152,107,33280
ad 225,225,205
rv 156,108,33280
v_fma_f32 v229, v205, v205, v229
aw 82,72
aw 94,73
ad 225,225,206
v_fma_f32 v229, v206, v206, v229
ad 225,225,207
v_fma_f32 v229, v207, v207, v229
cv 72,204,205
cv 73,206,207
wl 14
mvvvz 204,128,196
wl 11
rv 196,109,33280
ad 226,226,208
v_smfmac_f32_16x16x64_bf16 v[204:207], v[120:123], v[160:167], v88
wl 8
rv 160,110,33280
v_fma_f32 v230, v208, v208, v230
v_smfmac_f32_16x16x64_bf16 v[204:207], v[124:127], v[168:175], v88
rv 164,111,33280
rv 168,112,33280
v_lshl_or_b32 v79, v79, 16, v79
rv 172,113,33280
ad 226,226,209
v_fma_f32 v230, v209, v209, v230
v_and_b32 v140, v79, v60
v_and_b32 v141, v79, v61
v_and_b32 v142, v79, v62
v_and_b32 v143, v79, v63
aw 170,74
aw 174,75
ad 226,226,210
v_fma_f32 v230, v210, v210, v230
ad 226,226,211
v_fma_f32 v230, v211, v211, v230
cv 74,208,209
cv 75,210,211
wl 9
mvvvz 208,140,192
rv 192,114,33280
v_and_b32 v132, v77, v90
v_and_b32 v133, v77, v91
v_and_b32 v134, v77, v92
v_and_b32 v135, v77, v93
ad 227,227,212
v_fma_f32 v231, v212, v212, v231
v_smfmac_f32_16x16x64_bf16 v[208:211], v[132:135], v[176:183], v88
rv 176,82,544
rv 180,83,544
ad 227,227,213
v_fma_f32 v231, v213, v213, v231
v_and_b32 v136, v78, v90
v_and_b32 v137, v78, v91
v_and_b32 v138, v78, v92
v_and_b32 v139, v78, v93
aw 75,70
aw 87,71
v_smfmac_f32_16x16x64_bf16 v[208:211], v[136:139], v[184:191], v88
rv 184,84,544
rv 188,85,544
ad 227,227,214
v_fma_f32 v231, v214, v214, v231
ad 227,227,215
v_fma_f32 v231, v215, v215, v231
cv 70,212,213
cv 71,214,215
wl 9
mvvvz 212,140,196
rv 196,86,544
ad 224,224,216
v_smfmac_f32_16x16x64_bf16 v[212:215], v[132:135], v[144:151], v88
v_fma_f32 v228, v216, v216, v228
v_smfmac_f32_16x16x64_bf16 v[212:215], v[136:139], v[152:159], v88
ad 224,224,217
v_fma_f32 v228, v217, v217, v228
aw 79,72
aw 91,73
ad 224,224,218
v_fma_f32 v228, v218, v218, v228
ad 224,224,219
v_fma_f32 v228, v219, v219, v228
cv 72,216,217
cv 73,218,219
wl 5
mvvvz 216,140,192
ad 225,225,220
v_fma_f32 v229, v220, v220, v229
v_smfmac_f32_16x16x64_bf16 v[216:219], v[132:135], v[160:167], v88
ad 225,225,221
v_smfmac_f32_16x16x64_bf16 v[216:219], v[136:139], v[168:175], v88
v_fma_f32 v229, v221, v221, v229
aw 83,74
aw 95,75
ad 225,225,222
v_fma_f32 v229, v222, v222, v229
ad 225,225,223
v_fma_f32 v229, v223, v223, v229
cv 74,220,221
cv 75,222,223
wl 0
mvvvz 220,140,196
ad 226,226,200
v_fma_f32 v230, v200, v200, v230
v_smfmac_f32_16x16x64_bf16 v[220:223], v[132:135], v[176:183], v88
ad 227,227,204
v_smfmac_f32_16x16x64_bf16 v[220:223], v[136:139], v[184:191], v88
v_fma_f32 v231, v204, v204, v231
ad 226,226,201
v_fma_f32 v230, v201, v201, v230
ad 227,227,205
v_fma_f32 v231, v205, v205, v231
ad 226,226,202
v_fma_f32 v230, v202, v202, v230
ad 227,227,206
v_fma_f32 v231, v206, v206, v231
aw 171,70
aw 175,71
aw 96,72
aw 108,73
aw 100,74
aw 112,75
ad 226,226,203
v_fma_f32 v230, v203, v203, v230
ad 227,227,207
v_fma_f32 v231, v207, v207, v231
cv 70,200,201
cv 71,202,203
cv 72,204,205
cv 73,206,207
ad 224,224,208
v_fma_f32 v228, v208, v208, v228
cv 74,208,209
cv 75,210,211
ad 225,225,212
v_fma_f32 v229, v212, v212, v229
ad 226,226,216
v_fma_f32 v230, v216, v216, v230
ad 227,227,220
v_fma_f32 v231, v220, v220, v231
aw 104,70
aw 116,71
aw 176,72
aw 180,73
ad 224,224,209
v_fma_f32 v228, v209, v209, v228
aw 97,74
aw 109,75
ad 225,225,213
v_fma_f32 v229, v213, v213, v229
ad 226,226,217
v_fma_f32 v230, v217, v217, v230
ad 227,227,221
v_fma_f32 v231, v221, v221, v231
ad 224,224,210
v_fma_f32 v228, v210, v210, v228
ad 225,225,214
v_fma_f32 v229, v214, v214, v229
cv 70,212,213
cv 71,214,215
ad 226,226,218
v_fma_f32 v230, v218, v218, v230
cv 72,216,217
cv 73,218,219
ad 227,227,222
v_fma_f32 v231, v222, v222, v231
cv 74,220,221
cv 75,222,223
ad 224,224,211
v_fma_f32 v228, v211, v211, v228
ad 225,225,215
v_fma_f32 v229, v215, v215, v229
aw 101,70
aw 113,71
ad 226,226,219
v_fma_f32 v230, v219, v219, v230
aw 105,72
aw 117,73
ad 227,227,223
v_fma_f32 v231, v223, v223, v231
aw 177,74
aw 181,75
wv 4
v_readfirstlane_b32 s49, v8
s_nop 4
s_cmp_ge_u32 s49, 12
s_cbranch_scc1 L_chk0_ok
s_mov_b32 s62, 0
L_chk0_spin:
v_mov_b32 v8, 0
s_nop 1
buffer_load_dword v8, v8, s[4:7], 0 offen sc1
wv 0
v_readfirstlane_b32 s49, v8
s_add_u32 s62, s62, 1
s_nop 3
s_cmp_ge_u32 s49, 12
s_cbranch_scc1 L_chk0_ok
s_cmp_lt_u32 s62, 0x40000
s_cbranch_scc1 L_chk0_spin
L_chk0_ok:
L_pro_b:
ds_read_u16 v77, v68 offset:6720
ds_read_u16 v80, v89 offset:576
ds_read_u16 v76, v89 offset:3648
ds_read_u16 v78, v89 offset:608
ds_read_u16 v79, v89 offset:3680
s_barrier
rv 192,104,49152
rv 196,109,49152
rv 144,100,49152
rv 148,101,49152
rv 152,102,49152
rv 156,103,49152
rv 160,105,49152
rv 164,106,49152
rv 176,110,49152
rv 180,111,49152
wl 14
v_lshl_or_b32 v77, v77, 16, v77
v_and_b32 v128, v77, v60
v_and_b32 v129, v77, v61
v_and_b32 v130, v77, v62
v_and_b32 v131, v77, v63
wl 13
v_and_b32 v120, v80, v90
v_and_b32 v121, v80, v91
v_and_b32 v122, v80, v92
wl 9
mvvvz 200,128,192
wl 8
rv 192,114,49152
v_and_b32 v123, v80, v93
mvvvz 204,128,196
rv 196,86,576
v_and_b32 v124, v76, v90
v_and_b32 v125, v76, v91
v_and_b32 v126, v76, v92
v_and_b32 v127, v76, v93
v_and_b32 v132, v78, v90
wl 8
v_smfmac_f32_16x16x64_bf16 v[200:203], v[120:123], v[144:151], v88
rv 144,82,576
rv 148,83,576
ds_read_u16 v80, v68 offset:6752
v_and_b32 v133, v78, v91
wl 9
v_smfmac_f32_16x16x64_bf16 v[200:203], v[124:127], v[152:159], v88
rv 168,107,49152
rv 172,108,49152
rv 184,112,49152
rv 188,113,49152
wl 11
v_smfmac_f32_16x16x64_bf16 v[204:207], v[120:123], v[160:167], v88
rv 152,84,576
rv 156,85,576
rv 160,100,49664
rv 164,101,49664
ad 224,224,200
v_fma_f32 v228, v200, v200, v228
wl 12
mvvvz 208,128,192
rv 192,104,49664
v_and_b32 v134, v78, v92
v_smfmac_f32_16x16x64_bf16 v[208:211], v[120:123], v[176:183], v88
wl 12
rv 176,105,49664
v_and_b32 v135, v78, v93
mvvvz 212,128,196
wl 11
rv 196,109,49664
ad 224,224,201
v_smfmac_f32_16x16x64_bf16 v[212:215], v[120:123], v[144:151], v88
wl 11
rv 180,106,49664
v_lshl_or_b32 v80, v80, 16, v80
v_and_b32 v140, v80, v60
v_and_b32 v141, v80, v61
v_and_b32 v142, v80, v62
v_and_b32 v143, v80, v63
v_fma_f32 v228, v201, v201, v228
ad 224,224,202
wl 10
v_smfmac_f32_16x16x64_bf16 v[204:207], v[124:127], v[168:175], v88
rv 168,102,49664
rv 172,103,49664
rv 144,110,49664
v_fma_f32 v228, v202, v202, v228
wl 11
v_smfmac_f32_16x16x64_bf16 v[208:211], v[124:127], v[184:191], v88
rv 184,107,49664
rv 188,108,49664
rv 148,111,49664
ad 224,224,203
wl 12
v_smfmac_f32_16x16x64_bf16 v[212:215], v[124:127], v[152:159], v88
rv 152,112,49664
rv 156,113,49664
v_fma_f32 v228, v203, v203, v228
cv 70,200,201
cv 71,202,203
ds_read_u16 v78, v68 offset:6784
ad 225,225,204
wl 12
mvvvz 216,140,192
rv 192,114,49664
v_fma_f32 v229, v204, v204, v229
v_smfmac_f32_16x16x64_bf16 v[216:219], v[132:135], v[160:167], v88
wl 11
ds_read_u16 v76, v89 offset:640
ad 225,225,205
mvvvz 220,140,196
wl 11
rv 196,86,608
v_fma_f32 v229, v205, v205, v229
v_smfmac_f32_16x16x64_bf16 v[220:223], v[132:135], v[176:183], v88
rv 160,82,608
ad 225,225,206
v_fma_f32 v229, v206, v206, v229
s_add_u32 s22, s28, s23
rv 164,83,608
ad 225,225,207
v_fma_f32 v229, v207, v207, v229
cv 72,204,205
cv 73,206,207
s_mov_b32 s24, s23
ds_read_u16 v77, v89 offset:3712
s_mov_b32 m0, s22
ad 226,226,208
v_fma_f32 v230, v208, v208, v230
ad 226,226,209
v_fma_f32 v230, v209, v209, v230
v_and_b32 v136, v79, v90
v_and_b32 v137, v79, v91
v_and_b32 v138, v79, v92
v_and_b32 v139, v79, v93
ad 226,226,210
v_fma_f32 v230, v210, v210, v230
wl 13
v_smfmac_f32_16x16x64_bf16 v[216:219], v[136:139], v[168:175], v88
wl 10
dm 1,12,24,0
v_smfmac_f32_16x16x64_bf16 v[220:223], v[136:139], v[184:191], v88
rv 168,84,608
ad 226,226,211
v_fma_f32 v230, v211, v211, v230
cv 74,208,209
wl 7
v_lshl_or_b32 v78, v78, 16, v78
v_and_b32 v128, v78, v60
v_and_b32 v129, v78, v61
v_and_b32 v130, v78, v62
wl 6
mvvvz 200,140,192
wv 2
s_barrier
rv 192,244,0
v_and_b32 v131, v78, v63
v_smfmac_f32_16x16x64_bf16 v[200:203], v[132:135], v[144:151], v88
rv 176,240,0
cv 75,210,211
v_smfmac_f32_16x16x64_bf16 v[200:203], v[136:139], v[152:159], v88
wl 6
rv 180,241,0
s_mov_b32 m0, s22
mvvvz 204,140,196
wl 5
rv 196,249,0
ad 227,227,212
v_smfmac_f32_16x16x64_bf16 v[204:207], v[132:135], v[160:167], v88
rv 172,85,608
rv 184,242,0
v_fma_f32 v231, v212, v212, v231
rv 188,243,0
ad 227,227,213
v_fma_f32 v231, v213, v213, v231
aw 98,70
aw 110,71
wl 6
mvvvz 208,128,192
rv 192,254,0
rv 144,245,0
ad 227,227,214
v_fma_f32 v231, v214, v214, v231
ad 227,227,215
v_fma_f32 v231, v215, v215, v231
cv 70,212,213
cv 71,214,215
v_and_b32 v120, v76, v90
wl 5
mvvvz 212,128,196
wl 4
dm 1,12,24,1024
v_smfmac_f32_16x16x64_bf16 v[204:207], v[136:139], v[168:175], v88
s_mov_b32 m0, s22
rv 196,86,640
rv 148,246,0
v_and_b32 v121, v76, v91
rv 160,250,0
v_and_b32 v122, v76, v92
rv 164,251,0
v_and_b32 v123, v76, v93
ad 224,224,216
v_fma_f32 v228, v216, v216, v228
v_smfmac_f32_16x16x64_bf16 v[208:211], v[120:123], v[176:183], v88
rv 176,82,640
rv 180,83,640
ad 224,224,217
ds_read_u16 v76, v68 offset:6816
v_fma_f32 v228, v217, v217, v228
v_and_b32 v124, v77, v90
v_and_b32 v125, v77, v91
v_and_b32 v126, v77, v92
v_and_b32 v127, v77, v93
aw 102,72
aw 114,73
wl 9
v_smfmac_f32_16x16x64_bf16 v[208:211], v[124:127], v[184:191], v88
wl 5
dm 1,12,24,2048
v_smfmac_f32_16x16x64_bf16 v[212:215], v[120:123], v[144:151], v88
s_mov_b32 m0, s22
rv 152,247,0
rv 156,248,0
ad 224,224,218
rv 168,252,0
v_fma_f32 v228, v218, v218, v228
rv 172,253,0
ad 224,224,219
rv 184,84,640
v_fma_f32 v228, v219, v219, v228
rv 188,85,640
cv 72,216,217
ds_read_u16 v79, v89 offset:672
cv 73,218,219
mvvvz 216,128,192
wl 10
rv 192,244,512
ad 225,225,220
v_smfmac_f32_16x16x64_bf16 v[216:219], v[120:123], v[160:167], v88
wl 6
dm 1,12,24,3072
v_smfmac_f32_16x16x64_bf16 v[212:215], v[124:127], v[152:159], v88
rv 144,240,512
v_fma_f32 v229, v220, v220, v229
ad 225,225,221
v_fma_f32 v229, v221, v221, v229
aw 106,74
aw 118,75
wl 5
v_smfmac_f32_16x16x64_bf16 v[216:219], v[124:127], v[168:175], v88
s_add_u32 s25, s24, 0x1000
rv 148,241,512
rv 152,242,512
ad 225,225,222
rv 156,243,512
v_fma_f32 v229, v222, v222, v229
rv 160,245,512
ad 225,225,223
rv 164,246,512
v_fma_f32 v229, v223, v223, v229
rv 168,247,512
cv 74,220,221
rv 172,248,512
cv 75,222,223
mvvvz 220,128,196
rv 196,249,512
ad 226,226,200
v_smfmac_f32_16x16x64_bf16 v[220:223], v[120:123], v[176:183], v88
wl 11
rv 176,250,512
v_fma_f32 v230, v200, v200, v230
v_smfmac_f32_16x16x64_bf16 v[220:223], v[124:127], v[184:191], v88
s_add_u32 m0, s22, 0x1000
rv 180,251,512
v_lshl_or_b32 v76, v76, 16, v76
rv 184,252,512
ad 226,226,201
rv 188,253,512
v_fma_f32 v230, v201, v201, v230
ds_read_u16 v80, v89 offset:3744
ds_read_u16 v77, v89 offset:704
ds_read_u16 v78, v89 offset:3776
v_and_b32 v140, v76, v60
v_and_b32 v141, v76, v61
v_and_b32 v142, v76, v62
v_and_b32 v143, v76, v63
ds_read_u16 v76, v89 offset:3808
aw 178,70
aw 182,71
ad 226,226,202
v_fma_f32 v230, v202, v202, v230
ad 226,226,203
v_fma_f32 v230, v203, v203, v230
cv 70,200,201
cv 71,202,203
wl 15
mvvvz 200,140,192
rv 192,254,512
dm 1,12,25,0
s_add_u32 m0, s22, 0x1000
s_add_u32 s24, s24, 0x6000
ad 227,227,204
v_fma_f32 v231, v204, v204, v231
ad 227,227,205
v_fma_f32 v231, v205, v205, v231
aw 99,72
aw 111,73
ad 227,227,206
v_fma_f32 v231, v206, v206, v231
ad 224,224,208
v_fma_f32 v228, v208, v208, v228
v_and_b32 v132, v79, v90
v_and_b32 v133, v79, v91
v_and_b32 v134, v79, v92
v_and_b32 v135, v79, v93
ad 227,227,207
v_fma_f32 v231, v207, v207, v231
v_smfmac_f32_16x16x64_bf16 v[200:203], v[132:135], v[144:151], v88
s_add_u32 s22, s29, s23
ds_read_u16 v79, v68 offset:6848
rv 144,82,672
rv 148,83,672
cv 72,204,205
cv 73,206,207
wl 12
mvvvz 204,140,196
dm 1,12,25,1024
v_smfmac_f32_16x16x64_bf16 v[204:207], v[132:135], v[160:167], v88
s_waitcnt vmcnt(6) lgkmcnt(3)
s_barrier
rv 196,86,672
rv 160,240,16384
ad 224,224,209
rv 164,241,16384
v_fma_f32 v228, v209, v209, v228
aw 103,74
aw 115,75
ad 224,224,210
v_fma_f32 v228, v210, v210, v228
ad 224,224,211
v_fma_f32 v228, v211, v211, v228
cv 74,208,209
cv 75,210,211
mvvvz 208,140,192
rv 192,244,16384
s_mov_b32 m0, s22
v_smfmac_f32_16x16x64_bf16 v[208:211], v[132:135], v[176:183], v88
s_add_u32 s25, s24, 0x1000
rv 176,245,16384
rv 180,246,16384
ad 225,225,212
v_fma_f32 v229, v212, v212, v229
ad 225,225,213
v_fma_f32 v229, v213, v213, v229
dm 1,12,24,0
s_mov_b32 m0, s22
aw 107,70
aw 119,71
ad 225,225,214
v_fma_f32 v229, v214, v214, v229
ad 226,226,216
v_fma_f32 v230, v216, v216, v230
wl 8
v_lshl_or_b32 v79, v79, 16, v79
ad 225,225,215
v_fma_f32 v229, v215, v215, v229
cv 70,212,213
cv 71,214,215
wl 5
mvvvz 212,140,196
dm 1,12,24,1024
v_smfmac_f32_16x16x64_bf16 v[212:215], v[132:135], v[144:151], v88
s_mov_b32 m0, s22
rv 196,249,16384
rv 144,250,16384
ad 226,226,217
rv 148,251,16384
v_fma_f32 v230, v217, v217, v230
v_and_b32 v136, v80, v90
v_and_b32 v137, v80, v91
v_and_b32 v138, v80, v92
v_and_b32 v139, v80, v93
v_and_b32 v128, v79, v60
v_and_b32 v129, v79, v61
v_smfmac_f32_16x16x64_bf16 v[200:203], v[136:139], v[152:159], v88
rv 152,84,672
v_and_b32 v130, v79, v62
v_smfmac_f32_16x16x64_bf16 v[204:207], v[136:139], v[168:175], v88
rv 156,85,672
v_and_b32 v131, v79, v63
v_smfmac_f32_16x16x64_bf16 v[208:211], v[136:139], v[184:191], v88
rv 184,247,16384
rv 188,248,16384
aw 179,72
rv 168,242,16384
aw 183,73
rv 172,243,16384
ad 226,226,218
ds_read_u16 v80, v89 offset:736
v_fma_f32 v230, v218, v218, v230
ad 226,226,219
v_fma_f32 v230, v219, v219, v230
cv 72,216,217
cv 73,218,219
wl 12
mvvvz 216,128,192
wl 5
rv 192,254,16384
ad 227,227,220
v_smfmac_f32_16x16x64_bf16 v[212:215], v[136:139], v[152:159], v88
rv 152,252,16384
rv 156,253,16384
v_fma_f32 v231, v220, v220, v231
ad 227,227,221
v_fma_f32 v231, v221, v221, v231
aw 120,74
aw 132,75
ad 227,227,222
v_fma_f32 v231, v222, v222, v231
ad 224,224,200
v_fma_f32 v228, v200, v200, v228
v_and_b32 v120, v77, v90
v_and_b32 v121, v77, v91
v_and_b32 v122, v77, v92
v_and_b32 v123, v77, v93
ad 227,227,223
v_fma_f32 v231, v223, v223, v231
v_smfmac_f32_16x16x64_bf16 v[216:219], v[120:123], v[160:167], v88
ds_read_u16 v77, v68 offset:6880
rv 160,82,704
rv 164,83,704
cv 74,220,221
cv 75,222,223
mvvvz 220,128,196
dm 1,12,24,2048
v_smfmac_f32_16x16x64_bf16 v[220:223], v[120:123], v[176:183], v88
s_mov_b32 m0, s22
rv 196,86,704
rv 176,240,16896
ad 224,224,201
rv 180,241,16896
v_fma_f32 v228, v201, v201, v228
aw 124,70
aw 136,71
ad 224,224,202
v_fma_f32 v228, v202, v202, v228
ad 224,224,203
v_fma_f32 v228, v203, v203, v228
cv 70,200,201
cv 71,202,203
wl 8
mvvvz 200,128,192
dm 1,12,24,3072
v_smfmac_f32_16x16x64_bf16 v[200:203], v[120:123], v[144:151], v88
s_add_u32 m0, s22, 0x1000
rv 192,244,16896
rv 144,245,16896
v_and_b32 v124, v78, v90
rv 148,246,16896
v_and_b32 v125, v78, v91
v_and_b32 v126, v78, v92
v_and_b32 v127, v78, v93
ad 225,225,204
v_fma_f32 v229, v204, v204, v229
v_smfmac_f32_16x16x64_bf16 v[216:219], v[124:127], v[168:175], v88
dm 1,12,25,0
v_smfmac_f32_16x16x64_bf16 v[220:223], v[124:127], v[184:191], v88
wl 9
rv 184,242,16896
ad 225,225,205
v_smfmac_f32_16x16x64_bf16 v[200:203], v[124:127], v[152:159], v88
s_add_u32 m0, s22, 0x1000
rv 188,243,16896
rv 168,84,704
v_fma_f32 v229, v205, v205, v229
rv 172,85,704
aw 128,72
rv 152,247,16896
aw 140,73
rv 156,248,16896
ad 225,225,206
v_fma_f32 v229, v206, v206, v229
ad 226,226,208
v_fma_f32 v230, v208, v208, v230
wl 14
v_lshl_or_b32 v77, v77, 16, v77
ad 225,225,207
v_fma_f32 v229, v207, v207, v229
cv 72,204,205
cv 73,206,207
wl 11
mvvvz 204,128,196
rv 196,249,16896
ad 226,226,209
v_smfmac_f32_16x16x64_bf16 v[204:207], v[120:123], v[160:167], v88
dm 1,12,25,1024
v_fma_f32 v230, v209, v209, v230
v_and_b32 v140, v77, v60
v_and_b32 v141, v77, v61
v_and_b32 v142, v77, v62
wl 3
v_smfmac_f32_16x16x64_bf16 v[204:207], v[124:127], v[168:175], v88
s_add_u32 s24, s24, 0x6000
rv 160,250,16896
rv 164,251,16896
v_and_b32 v143, v77, v63
rv 168,252,16896
aw 184,74
rv 172,253,16896
aw 188,75
ad 226,226,210
v_fma_f32 v230, v210, v210, v230
ad 226,226,211
v_fma_f32 v230, v211, v211, v230
cv 74,208,209
cv 75,210,211
mvvvz 208,140,192
s_add_u32 s22, s30, s23
rv 192,254,16896
v_and_b32 v132, v80, v90
v_and_b32 v133, v80, v91
v_and_b32 v134, v80, v92
v_and_b32 v135, v80, v93
v_and_b32 v136, v76, v90
v_and_b32 v137, v76, v91
v_smfmac_f32_16x16x64_bf16 v[208:211], v[132:135], v[176:183], v88
s_mov_b32 m0, s22
rv 176,82,736
rv 180,83,736
v_and_b32 v138, v76, v92
v_and_b32 v139, v76, v93
ad 224,224,216
ad 224,224,217
v_smfmac_f32_16x16x64_bf16 v[208:211], v[136:139], v[184:191], v88
s_add_u32 s25, s24, 0x1000
rv 184,84,736
rv 188,85,736
ad 224,224,218
ad 224,224,219
ad 227,227,212
v_fma_f32 v231, v212, v212, v231
ad 227,227,213
s_nop 0
ad 224,224,208
ad 224,224,209
ad 224,224,210
ad 224,224,211
v_mov_b32 v31, v224
v_fma_f32 v231, v213, v213, v231
aw 121,70
aw 133,71
ad 227,227,214
v_fma_f32 v231, v214, v214, v231
ad 227,227,215
v_fma_f32 v231, v215, v215, v231
cv 70,212,213
cv 71,214,215
wl 9
mvvvz 212,140,196
dm 1,12,24,0
v_smfmac_f32_16x16x64_bf16 v[212:215], v[132:135], v[144:151], v88
rv 196,86,736
v_permlane16_swap_b32 v224, v31
v_smfmac_f32_16x16x64_bf16 v[212:215], v[136:139], v[152:159], v88
s_mov_b32 m0, s22
v_fma_f32 v228, v216, v216, v228
v_fma_f32 v228, v217, v217, v228
ad 224,224,31
v_fma_f32 v228, v218, v218, v228
v_mov_b32 v31, v224
v_fma_f32 v228, v219, v219, v228
v_fma_f32 v228, v208, v208, v228
v_fma_f32 v228, v209, v209, v228
v_permlane32_swap_b32 v224, v31
v_fma_f32 v228, v210, v210, v228
v_fma_f32 v228, v211, v211, v228
ad 224,224,31
v_mov_b32 v31, v228
ad 225,225,220
ad 225,225,221
v_permlane16_swap_b32 v228, v31
ad 228,228,31
v_mov_b32 v31, v228
ad 225,225,222
ad 225,225,223
v_permlane32_swap_b32 v228, v31
ad 225,225,212
ad 225,225,213
ad 228,228,31
ad 225,225,214
v_mul_f32 v31, s75, v224
ad 225,225,215
mu 32,31,31
v_mov_b32 v31, v225
aw 125,72
aw 137,73
dm 1,12,24,1024
s_mov_b32 m0, s22
cv 72,216,217
cv 73,218,219
wl 5
mvvvz 216,140,192
dm 1,12,24,2048
v_smfmac_f32_16x16x64_bf16 v[216:219], v[132:135], v[160:167], v88
s_mov_b32 m0, s22
s_waitcnt vmcnt(9) lgkmcnt(0)
s_barrier
v_permlane16_swap_b32 v225, v31
v_smfmac_f32_16x16x64_bf16 v[216:219], v[136:139], v[168:175], v88
dm 1,12,24,3072
v_fma_f32 v229, v220, v220, v229
v_fma_f32 v229, v221, v221, v229
ad 225,225,31
v_fma_f32 v229, v222, v222, v229
v_mov_b32 v31, v225
v_fma_f32 v229, v223, v223, v229
v_fma_f32 v229, v212, v212, v229
v_fma_f32 v229, v213, v213, v229
v_permlane32_swap_b32 v225, v31
v_fma_f32 v229, v214, v214, v229
v_fma_f32 v229, v215, v215, v229
ad 225,225,31
v_mov_b32 v31, v229
aw 129,74
aw 141,75
v_permlane16_swap_b32 v229, v31
ad 229,229,31
cv 74,220,221
cv 75,222,223
mvvvz 220,140,196
ad 226,226,200
v_mov_b32 v31, v229
v_smfmac_f32_16x16x64_bf16 v[220:223], v[132:135], v[176:183], v88
s_add_u32 m0, s22, 0x1000
ad 226,226,201
v_smfmac_f32_16x16x64_bf16 v[220:223], v[136:139], v[184:191], v88
dm 1,12,25,0
ad 226,226,202
ad 226,226,203
v_fma_f32 v32, v228, s75, -v32
v_permlane32_swap_b32 v229, v31
ad 226,226,216
v_max_f32 v32, 0, v32
ad 226,226,217
v_add_f32 v32, s76, v32
ad 229,229,31
ad 226,226,218
v_rsq_f32 v5, v32
v_mul_f32 v31, s75, v225
ad 226,226,219
mu 32,31,31
v_mov_b32 v31, v226
v_fma_f32 v230, v200, v200, v230
v_fma_f32 v230, v201, v201, v230
v_permlane16_swap_b32 v226, v31
ad 226,226,31
v_fma_f32 v230, v202, v202, v230
v_mov_b32 v31, v226
v_fma_f32 v230, v203, v203, v230
v_fma_f32 v230, v216, v216, v230
v_fma_f32 v230, v217, v217, v230
v_permlane32_swap_b32 v226, v31
v_fma_f32 v230, v218, v218, v230
v_fma_f32 v230, v219, v219, v230
ad 226,226,31
v_mov_b32 v31, v230
ad 227,227,204
ad 227,227,205
v_permlane16_swap_b32 v230, v31
ad 230,230,31
v_mov_b32 v31, v230
s_add_u32 m0, s22, 0x1000
ad 227,227,206
ad 227,227,207
v_fma_f32 v32, v229, s75, -v32
v_permlane32_swap_b32 v230, v31
ad 227,227,220
v_max_f32 v32, 0, v32
ad 227,227,221
v_add_f32 v32, s76, v32
ad 230,230,31
s_add_u32 s24, s24, 0x6000
dm 1,12,25,1024
ad 227,227,222
v_rsq_f32 v6, v32
v_mul_f32 v31, s75, v226
ad 227,227,223
mu 32,31,31
v_mov_b32 v31, v227
v_fma_f32 v231, v204, v204, v231
v_fma_f32 v231, v205, v205, v231
v_permlane16_swap_b32 v227, v31
ad 227,227,31
v_fma_f32 v231, v206, v206, v231
v_mov_b32 v31, v227
v_fma_f32 v231, v207, v207, v231
v_fma_f32 v231, v220, v220, v231
v_fma_f32 v231, v221, v221, v231
v_permlane32_swap_b32 v227, v31
v_fma_f32 v231, v222, v222, v231
v_fma_f32 v231, v223, v223, v231
ad 227,227,31
v_mov_b32 v31, v231
v_fma_f32 v32, v230, s75, -v32
v_max_f32 v32, 0, v32
v_permlane16_swap_b32 v231, v31
ad 231,231,31
v_mov_b32 v31, v231
v_add_f32 v32, s76, v32
v_rsq_f32 v7, v32
v_permlane32_swap_b32 v231, v31
ad 231,231,31
v_mul_f32 v31, s75, v227
aw 185,70
aw 189,71
aw 122,72
aw 134,73
aw 126,74
aw 138,75
mu 32,31,31
cv 70,200,201
cv 71,202,203
cv 72,204,205
cv 73,206,207
cv 74,208,209
cv 75,210,211
v_fma_f32 v32, v231, s75, -v32
aw 130,70
aw 142,71
aw 186,72
aw 190,73
aw 123,74
aw 135,75
v_max_f32 v32, 0, v32
v_lshrrev_b32 v33, 4, v0
cv 70,212,213
cv 71,214,215
cv 72,216,217
cv 73,218,219
cv 74,220,221
cv 75,222,223
v_add_f32 v32, s76, v32
v_lshlrev_b32 v33, 4, v33
v_add_u32 v2, s28, v1
ra 228,2,0
ra 232,2,1024
ra 236,2,2048
aw 127,70
ra 240,2,3072
aw 139,71
aw 131,72
aw 143,73
aw 187,74
aw 191,75
v_rsq_f32 v24, v32
ds_bpermute_b32 v8, v33, v5 offset:0
ds_bpermute_b32 v9, v33, v5 offset:4
ds_bpermute_b32 v10, v33, v5 offset:8
ds_bpermute_b32 v11, v33, v5 offset:12
ds_bpermute_b32 v12, v33, v6 offset:0
ds_bpermute_b32 v13, v33, v6 offset:4
ds_bpermute_b32 v14, v33, v6 offset:8
ds_bpermute_b32 v15, v33, v6 offset:12
ds_bpermute_b32 v16, v33, v7 offset:0
ds_bpermute_b32 v17, v33, v7 offset:4
ds_bpermute_b32 v18, v33, v7 offset:8
ds_bpermute_b32 v19, v33, v7 offset:12
L_b1x_a:
wl 15
mvaaz 36,228,0
wl 14
ra 244,2,4096
s_add_u32 s22, s31, s23
mvaac 36,232,12
ra 248,2,5120
s_mov_b32 m0, s22
mvaaz 40,228,4
v_add_u32 v3, s29, v1
s_cmp_ge_u32 s20, 2
mvaac 40,232,16
s_cselect_b32 s37, s29, s28
s_add_u32 s37, s37, s72
v_add_u32 v25, s37, v1
mvaaz 44,228,8
ra 228,2,6144
s_add_u32 s25, s24, 0x1000
mvaac 44,232,20
wl 14
ra 232,2,7168
s_mov_b32 s71, 0
mvaac 36,236,24
v_add_u32 v4, s30, v1
mvaac 36,240,36
mvaac 40,236,28
mvaac 40,240,40
mvaac 44,236,32
ra 236,2,8192
mvaac 44,240,44
wl 4
ra 240,2,9216
mvaac 36,244,48
wl 4
mvaac 36,248,60
mvaac 40,244,52
mvaac 40,248,64
mvaac 44,244,56
ra 244,2,10240
mvaac 44,248,68
wl 4
ra 248,2,11264
mvaac 36,228,72
wl 4
mvaac 36,232,84
mvaac 40,228,76
mvaac 40,232,88
wv 6
s_barrier
mvaac 44,228,80
ra 228,2,12288
mvaac 44,232,92
wl 4
ra 232,2,13312
mvaac 36,236,96
wl 4
mvaac 36,240,108
mvaac 40,236,100
mvaac 40,240,112
mvaac 44,236,104
ra 236,2,14336
mvaac 44,240,116
wl 4
ra 240,2,15360
mvaac 36,244,120
wl 4
mvaac 36,248,132
mvaac 40,244,124
mvaac 40,248,136
mu 36,5,36
mu 37,5,37
mvaac 44,244,128
ra 244,2,16384
mu 38,5,38
mvaac 44,248,140
wl 4
ra 248,2,17408
mu 39,5,39
mvaaz 48,228,0
wl 4
cv 172,36,37
cv 173,38,39
mvaac 48,232,12
mu 40,6,40
mu 41,6,41
mvaaz 52,228,4
dm 1,12,24,0
mvaac 52,232,16
s_mov_b32 m0, s22
mu 42,6,42
mu 43,6,43
mvaaz 56,228,8
ra 228,2,18432
cv 176,40,41
mvaac 56,232,20
wl 4
ra 232,2,19456
cv 177,42,43
mvaac 48,236,24
wl 4
mu 44,7,44
mu 45,7,45
mvaac 48,240,36
mu 46,7,46
mu 47,7,47
mvaac 52,236,28
cv 180,44,45
cv 181,46,47
mvaac 52,240,40
mvaac 56,236,32
ra 236,2,20480
mvaac 56,240,44
wl 4
ra 240,2,21504
mvaac 48,244,48
wl 4
mvaac 48,248,60
dm 1,12,24,1024
mvaac 52,244,52
s_mov_b32 m0, s22
mvaac 52,248,64
mvaac 56,244,56
ra 244,2,22528
mvaac 56,248,68
wl 4
ra 248,2,23552
v_add_u32 v2, s31, v1
mvaac 48,228,72
wl 4
mvaac 48,232,84
mvaac 52,228,76
mvaac 52,232,88
mvaac 56,228,80
ra 228,3,0
mvaac 56,232,92
wl 4
ra 232,3,1024
mvaac 48,236,96
wl 4
dm 1,12,24,2048
mvaac 48,240,108
s_mov_b32 m0, s22
mvaac 52,236,100
mvaac 52,240,112
mvaac 56,236,104
ra 236,25,0
mvaac 56,240,116
wl 4
ra 240,25,1024
mvaac 48,244,120
wl 4
mvaac 48,248,132
mvaac 52,244,124
mvaac 52,248,136
mu 48,5,48
mu 49,5,49
mvaac 56,244,128
ra 244,3,2048
mu 50,5,50
mvaac 56,248,140
wl 4
ra 248,3,3072
mu 51,5,51
mvaaz 36,228,0
wl 4
dm 1,12,24,3072
mvaac 36,232,12
s_add_u32 m0, s22, 0x1000
cv 174,48,49
cv 175,50,51
mvaaz 40,228,4
mu 52,6,52
mu 53,6,53
mvaac 40,232,16
mu 54,6,54
mu 55,6,55
mvaaz 44,228,8
ra 228,25,2048
cv 178,52,53
mvaac 44,232,20
wl 4
ra 232,25,3072
cv 179,54,55
mvaaz 60,236,144
wl 4
ra 236,3,4096
mu 56,7,56
mvaac 60,240,148
wl 4
ra 240,3,5120
mu 57,7,57
mvaac 36,244,24
wl 4
mu 58,7,58
mu 59,7,59
mvaac 36,248,36
cv 182,56,57
cv 183,58,59
mvaac 40,244,28
mvaac 40,248,40
mvaac 44,244,32
ra 244,25,4096
mvaac 44,248,44
wl 4
ra 248,25,5120
mvaac 60,228,152
wl 4
ra 228,3,6144
mvaac 60,232,156
wl 4
ra 232,3,7168
mvaac 36,236,48
wl 4
dm 1,12,25,0
mvaac 36,240,60
s_add_u32 m0, s22, 0x1000
s_add_u32 s24, s24, 0x6000
s_add_u32 s38, s66, s71
mvaac 40,236,52
s_add_u32 s22, s28, s23
v_add_u32 v33, s38, v22
mvaac 40,240,64
mvaac 44,236,56
ra 236,25,6144
mvaac 44,240,68
wl 4
ra 240,25,7168
mvaac 60,244,160
wl 4
ra 244,3,8192
mvaac 60,248,164
wl 4
ra 248,3,9216
mvaac 36,228,72
wl 4
mvaac 36,232,84
mvaac 40,228,76
mvaac 40,232,88
dm 1,12,25,1024
mvaac 44,228,80
ra 228,25,8192
s_mov_b32 m0, s22
mvaac 44,232,92
wl 4
ra 232,25,9216
s_add_u32 s25, s24, 0x1000
mvaac 60,236,168
wl 4
ra 236,3,10240
mvaac 60,240,172
wl 4
ra 240,3,11264
mvaac 36,244,96
wl 4
mvaac 36,248,108
mvaac 40,244,100
mvaac 40,248,112
mvaac 44,244,104
ra 244,25,10240
mvaac 44,248,116
wl 4
ra 248,25,11264
mvaac 60,228,176
wl 4
ra 228,3,12288
mvaac 60,232,180
wl 4
ra 232,3,13312
mvaac 36,236,120
wl 4
mvaac 36,240,132
mvaac 40,236,124
mvaac 40,240,136
mu 36,5,36
mu 37,5,37
mvaac 44,236,128
ra 236,3,14336
s_waitcnt vmcnt(6) lgkmcnt(3)
s_barrier
mvaac 44,240,140
ra 240,3,15360
mu 38,5,38
mvaac 60,244,184
ra 244,3,16384
mu 39,5,39
mvaac 60,248,188
wl 4
ra 248,3,17408
cv 148,36,37
mvaaz 48,228,0
wl 4
cv 149,38,39
mu 40,6,40
mvaac 48,232,12
mu 41,6,41
mu 42,6,42
mvaaz 52,228,4
dm 1,12,24,0
mvaac 52,232,16
s_mov_b32 m0, s22
mu 43,6,43
cv 152,40,41
mvaaz 56,228,8
ra 228,3,18432
cv 153,42,43
mvaac 56,232,20
wl 4
ra 232,3,19456
mu 44,7,44
mvaac 48,236,24
wl 4
mu 45,7,45
mu 46,7,46
mvaac 48,240,36
mu 47,7,47
cv 156,44,45
mvaac 52,236,28
cv 157,46,47
mu 60,24,60
mvaac 52,240,40
mu 61,24,61
mu 62,24,62
mvaac 56,236,32
ra 236,3,20480
mu 63,24,63
mvaac 56,240,44
wl 4
ra 240,3,21504
cv 34,60,61
mvaac 48,244,48
wl 4
cv 35,62,63
mvaac 48,248,60
dm 1,12,24,1024
mvaac 52,244,52
s_mov_b32 m0, s22
mvaac 52,248,64
s_mov_b64 exec, s[56:57]
ds_write_b64 v33, v[34:35] offset:0
s_mov_b64 exec, -1
mvaac 56,244,56
ra 244,3,22528
mvaac 56,248,68
wl 5
ra 248,3,23552
mvaac 48,228,72
wl 5
mvaac 48,232,84
mvaac 52,228,76
mvaac 52,232,88
mvaac 56,228,80
ra 228,4,0
mvaac 56,232,92
wl 5
ra 232,4,1024
mvaac 48,236,96
wl 5
dm 1,12,24,2048
mvaac 48,240,108
s_mov_b32 m0, s22
mvaac 52,236,100
mvaac 52,240,112
mvaac 56,236,104
ra 236,4,2048
mvaac 56,240,116
wl 4
ra 240,4,3072
mvaac 48,244,120
wl 4
mvaac 48,248,132
mvaac 52,244,124
mvaac 52,248,136
mu 48,5,48
mu 49,5,49
mvaac 56,244,128
ra 244,4,4096
mu 50,5,50
mvaac 56,248,140
wl 4
ra 248,4,5120
mu 51,5,51
mvaaz 36,228,0
wl 4
dm 1,12,24,3072
mvaac 36,232,12
s_add_u32 m0, s22, 0x1000
cv 150,48,49
cv 151,50,51
mvaaz 40,228,4
mu 52,6,52
mu 53,6,53
mvaac 40,232,16
mu 54,6,54
mu 55,6,55
mvaaz 44,228,8
ra 228,4,6144
cv 154,52,53
mvaac 44,232,20
wl 4
ra 232,4,7168
cv 155,54,55
mvaac 36,236,24
wl 4
mu 56,7,56
mu 57,7,57
mvaac 36,240,36
mu 58,7,58
mu 59,7,59
mvaac 40,236,28
cv 158,56,57
cv 159,58,59
mvaac 40,240,40
mvaac 44,236,32
ra 236,4,8192
mvaac 44,240,44
wl 4
ra 240,4,9216
mvaac 36,244,48
wl 4
dm 1,12,25,0
mvaac 36,248,60
s_add_u32 m0, s22, 0x1000
s_add_u32 s24, s24, 0x6000
s_add_u32 s22, s29, s23
mvaac 40,244,52
mvaac 40,248,64
mvaac 44,244,56
ra 244,4,10240
mvaac 44,248,68
wl 4
ra 248,4,11264
mvaac 36,228,72
wl 4
mvaac 36,232,84
mvaac 40,228,76
mvaac 40,232,88
dm 1,12,25,1024
mvaac 44,228,80
ra 228,4,12288
s_mov_b32 m0, s22
mvaac 44,232,92
ra 232,4,13312
wv 6
s_barrier
wl 5
mvaac 36,236,96
wl 4
s_add_u32 s25, s24, 0x1000
mvaac 36,240,108
mvaac 40,236,100
mvaac 40,240,112
mvaac 44,236,104
ra 236,4,14336
mvaac 44,240,116
wl 4
ra 240,4,15360
mvaac 36,244,120
wl 4
mvaac 36,248,132
mvaac 40,244,124
mvaac 40,248,136
mu 36,5,36
mu 37,5,37
mvaac 44,244,128
ra 244,4,16384
mu 38,5,38
mvaac 44,248,140
wl 4
ra 248,4,17408
mu 39,5,39
mvaaz 48,228,0
wl 4
mu 40,6,40
mu 41,6,41
mvaac 48,232,12
mu 42,6,42
mu 43,6,43
mvaaz 52,228,4
dm 1,12,24,0
mvaac 52,232,16
s_mov_b32 m0, s22
mu 44,7,44
mu 45,7,45
mvaaz 56,228,8
ra 228,4,18432
mu 46,7,46
mvaac 56,232,20
wl 4
ra 232,4,19456
mu 47,7,47
mvaac 48,236,24
wl 4
cv 160,36,37
cv 161,38,39
mvaac 48,240,36
cv 164,40,41
cv 165,42,43
mvaac 52,236,28
dm 1,12,24,1024
mvaac 52,240,40
s_mov_b32 m0, s22
cv 168,44,45
cv 169,46,47
mvaac 56,236,32
ra 236,4,20480
mvaac 56,240,44
wl 4
ra 240,4,21504
mvaac 48,244,48
wl 4
mvaac 48,248,60
mvaac 52,244,52
dm 1,12,24,2048
mvaac 52,248,64
s_mov_b32 m0, s22
mvaac 56,244,56
ra 244,4,22528
mvaac 56,248,68
wl 4
ra 248,4,23552
mvaac 48,228,72
wl 4
mvaac 48,232,84
mvaac 52,228,76
dm 1,12,24,3072
mvaac 52,232,88
s_add_u32 m0, s22, 0x1000
mvaac 56,228,80
ra 228,2,0
mvaac 56,232,92
wl 4
ra 232,2,1024
mvaac 48,236,96
wl 4
mvaac 48,240,108
mvaac 52,236,100
dm 1,12,25,0
mvaac 52,240,112
s_add_u32 m0, s22, 0x1000
s_add_u32 s24, s24, 0x6000
mvaac 56,236,104
ra 236,2,2048
mvaac 56,240,116
wl 4
ra 240,2,3072
mvaac 48,244,120
wl 4
mvaac 48,248,132
mvaac 52,244,124
dm 1,12,25,1024
mvaac 52,248,136
mvaac 56,244,128
mvaac 56,248,140
s_branch L_b2x
L_b1x_0:
mvvvz 232,100,172
ds_read_u16 v106, v21 offset:0
ds_read_u16 v114, v21 offset:8
mvvvz 236,108,172
ds_read_u16 v122, v21 offset:64
ds_read_u16 v130, v21 offset:72
mvvvz 240,116,172
ds_read_u16 v138, v21 offset:128
ds_read_u16 v146, v21 offset:136
mvvvz 244,124,172
cv 140,48,49
cv 141,50,51
mvvvz 184,132,172
wl 9
cv 142,52,53
cv 143,54,55
mvaaz 36,228,0
cv 144,56,57
cv 145,58,59
mvvvz 188,140,172
wl 5
ra 244,2,4096
v_max3_f32 v26, v200, v201, v202
mvvvc 232,104,176
wl 5
ra 248,2,5120
v_max3_f32 v26, v26, v203, v204
mvvvc 236,112,176
wl 5
v_max3_f32 v26, v26, v205, v206
v_max3_f32 v26, v26, v207, v208
mvvvc 240,120,176
wl 4
v_max3_f32 v26, v26, v209, v210
v_max3_f32 v26, v26, v211, v212
mvvvc 244,128,176
wl 3
v_mov_b32 v27, v26
s_add_u32 s27, s27, 9
mvvvc 184,136,176
wl 2
v_permlane16_swap_b32 v26, v27
mvvvc 188,144,176
mx 26,26,27
v_mov_b32 v27, v26
mvaac 36,232,12
v_permlane32_swap_b32 v26, v27
mvaaz 40,228,4
mx 26,26,27
v_mul_f32 v28, s61, v26
mvaac 40,232,16
v_fma_f32 v200, v200, s32, v28
v_fma_f32 v201, v201, s32, v28
mvaaz 44,228,8
ra 228,2,6144
v_fma_f32 v202, v202, s32, v28
mvaac 44,232,20
ra 232,2,7168
v_fma_f32 v203, v203, s32, v28
mvaac 36,236,24
ex 200,200
mvaac 36,240,36
ex 201,201
mvaac 40,236,28
ex 202,202
mvaac 40,240,40
ex 203,203
mvaac 44,236,32
ra 236,2,8192
v_fma_f32 v204, v204, s32, v28
mvaac 44,240,44
wl 4
ra 240,2,9216
v_fma_f32 v205, v205, s32, v28
mvaac 36,244,48
wl 4
ex 204,204
mvaac 36,248,60
ad 249,200,201
v_fma_f32 v206, v206, s32, v28
mvaac 40,244,52
ex 205,205
mvaac 40,248,64
ad 249,249,202
v_fma_f32 v207, v207, s32, v28
mvaac 44,244,56
ra 244,2,10240
ad 249,249,203
mvaac 44,248,68
wl 4
ra 248,2,11264
v_fma_f32 v208, v208, s32, v28
mvaac 36,228,72
wl 4
ex 206,206
mvaac 36,232,84
ex 207,207
mvaac 40,228,76
ad 249,249,204
v_fma_f32 v209, v209, s32, v28
mvaac 40,232,88
ex 208,208
mvaac 44,228,80
ra 228,2,12288
ad 249,249,205
mvaac 44,232,92
wl 4
ra 232,2,13312
v_fma_f32 v210, v210, s32, v28
mvaac 36,236,96
wl 4
ex 209,209
mvaac 36,240,108
ad 249,249,206
v_fma_f32 v211, v211, s32, v28
mvaac 40,236,100
ex 210,210
mvaac 40,240,112
v_fma_f32 v212, v212, s32, v28
ad 249,249,207
mvaac 44,236,104
ra 236,2,14336
ad 249,249,208
mvaac 44,240,116
wl 4
ra 240,2,15360
ad 249,249,209
mvaac 36,244,120
wl 4
ex 211,211
mvaac 36,248,132
ex 212,212
mvaac 40,244,124
ad 249,249,210
mu 212,23,212
mvaac 40,248,136
ad 249,249,211
ad 249,249,212
mvaac 44,244,128
ra 244,2,16384
v_mov_b32 v32, v249
mvaac 44,248,140
ra 248,2,17408
mu 200,8,200
mvvvz 192,100,148
v_permlane16_swap_b32 v249, v32
mvvvc 192,104,152
ad 249,249,32
v_mov_b32 v32, v249
mvvvz 196,108,148
v_permlane32_swap_b32 v249, v32
mvvvc 196,112,152
wl 5
ad 249,249,32
v_rcp_f32 v249, v249
mvaaz 48,228,0
wl 4
mu 201,9,201
mu 202,10,202
mvaac 48,232,12
mu 203,11,203
mu 200,249,200
mvaaz 52,228,4
mu 201,249,201
mu 202,249,202
mvaac 52,232,16
mu 203,249,203
cv 156,200,201
mvaaz 56,228,8
ra 228,2,18432
cv 157,202,203
mvvvz 200,116,148
mu 204,12,204
mu 205,13,205
mvvvc 200,120,152
mu 206,14,206
mu 207,15,207
mvaac 56,232,20
wl 4
ra 232,2,19456
mu 204,249,204
mvaac 48,236,24
wl 4
mu 205,249,205
mu 206,249,206
mvaac 48,240,36
mu 207,249,207
cv 158,204,205
mvaac 52,236,28
cv 159,206,207
mu 208,16,208
mvvvz 204,124,148
mu 209,17,209
mu 210,18,210
mvvvc 204,128,152
mu 211,19,211
mu 208,249,208
mvaac 52,240,40
mu 209,249,209
mu 210,249,210
mvaac 56,236,32
ra 236,2,20480
mu 211,249,211
mvaac 56,240,44
wl 4
ra 240,2,21504
cv 160,208,209
mvaac 48,244,48
cv 161,210,211
mu 212,249,212
mvvvz 208,132,148
v_cvt_pk_bf16_f32 v162, v212, 0
s_add_u32 s37, s27, 0
mvvvc 208,136,152
s_and_b32 s37, s37, 3
s_mul_i32 s28, s37, 0x6000
s_add_u32 s37, s27, 1
mvvvz 212,140,148
s_and_b32 s37, s37, 3
s_mul_i32 s29, s37, 0x6000
s_add_u32 s37, s27, 2
mvvvc 212,144,152
wl 4
s_and_b32 s37, s37, 3
s_mul_i32 s30, s37, 0x6000
s_add_u32 s37, s27, 3
mvaac 48,248,60
s_and_b32 s37, s37, 3
s_mul_i32 s31, s37, 0x6000
s_add_u32 s71, s71, 0xc0
mvaac 52,244,52
s_mul_i32 s37, s20, 0x2400
s_add_u32 s37, s37, 0x18000
s_add_u32 s22, s31, s23
mvaac 52,248,64
s_mov_b32 m0, s22
wv 8
s_barrier
cv 34,232,233
mvaac 56,244,56
ra 244,2,22528
dm 1,12,24,0
mvaac 56,248,68
wl 4
ra 248,2,23552
s_mov_b32 m0, s22
mvaac 48,228,72
wl 4
cv 35,234,235
v_mov_b32 v163, 0
mvaac 48,232,84
dm 1,12,24,1024
mvaac 52,228,76
s_mov_b32 m0, s22
v_add_u32 v3, s29, v1
v_add_u32 v254, s37, v1
mvaac 52,232,88
s_mov_b64 exec, s[58:59]
ds_write_b64 v20, v[34:35] offset:0
s_mov_b64 exec, -1
mvaac 56,228,80
ra 228,3,0
cv 34,236,237
mvaac 56,232,92
wl 5
ra 232,3,1024
cv 35,238,239
mvaac 48,236,96
wl 5
dm 1,12,24,2048
mvaac 48,240,108
s_mov_b64 exec, s[58:59]
ds_write_b64 v20, v[34:35] offset:8
s_mov_b64 exec, -1
mvaac 52,236,100
cv 34,240,241
cv 35,242,243
mvaac 52,240,112
s_mov_b64 exec, s[58:59]
ds_write_b64 v20, v[34:35] offset:64
s_mov_b64 exec, -1
mvaac 56,236,104
s_mov_b32 m0, s22
cv 34,244,245
cv 35,246,247
mvaac 56,240,116
wl 6
s_mov_b64 exec, s[58:59]
ds_write_b64 v20, v[34:35] offset:72
s_mov_b64 exec, -1
mvaac 48,244,120
wl 6
cv 34,184,185
cv 35,186,187
mvaac 48,248,132
s_mov_b64 exec, s[58:59]
ds_write_b64 v20, v[34:35] offset:128
s_mov_b64 exec, -1
mvaac 52,244,124
cv 34,188,189
cv 35,190,191
mvaac 52,248,136
s_cmp_ge_u32 s20, 2
s_cselect_b32 s37, s29, s28
s_add_u32 s37, s37, s72
mvaac 56,244,128
ra 244,3,2048
v_add_u32 v25, s37, v1
mvaac 56,248,140
ra 236,25,0
mu 36,5,36
mvvvz 232,100,156
ra 240,25,1024
mu 37,5,37
mvvvc 232,104,160
ra 248,3,3072
mu 38,5,38
mvvvz 236,108,156
dm 1,12,24,3072
mvvvc 236,112,160
mu 39,5,39
cv 172,36,37
mvvvz 240,116,156
cv 173,38,39
mu 40,6,40
mvvvc 240,120,160
mu 41,6,41
mu 42,6,42
mvvvz 244,124,156
mu 43,6,43
cv 176,40,41
mvvvc 244,128,160
cv 177,42,43
mu 44,7,44
mvvvz 184,132,156
mu 45,7,45
mu 46,7,46
mvvvc 184,136,160
mu 47,7,47
cv 180,44,45
mvvvz 188,140,156
cv 181,46,47
s_add_u32 s25, s24, 0x1000
mvvvc 188,144,160
wl 9
s_add_u32 m0, s22, 0x1000
mu 48,5,48
mu 49,5,49
mvaaz 36,228,0
wl 8
mu 50,5,50
mu 51,5,51
mvaac 36,232,12
cv 174,48,49
cv 175,50,51
mvaaz 40,228,4
mu 52,6,52
mu 53,6,53
mvaac 40,232,16
mu 54,6,54
mu 55,6,55
mvaaz 44,228,8
ra 228,25,2048
cv 178,52,53
mvaac 44,232,20
wl 3
ra 232,25,3072
cv 179,54,55
mvaaz 60,236,144
wl 3
ra 236,3,4096
mu 56,7,56
mvaac 60,240,148
ra 240,3,5120
mu 57,7,57
mvaac 36,244,24
wl 4
mu 58,7,58
mu 59,7,59
mvaac 36,248,36
cv 182,56,57
cv 183,58,59
mvaac 40,244,28
v_max3_f32 v29, v216, v217, v218
v_max3_f32 v29, v29, v219, v220
mvaac 40,248,40
v_max3_f32 v29, v29, v221, v222
v_max3_f32 v29, v29, v223, v224
mvaac 44,244,32
ra 244,25,4096
v_max3_f32 v29, v29, v225, v226
mvaac 44,248,44
wl 4
ra 248,25,5120
v_max3_f32 v29, v29, v227, v228
mvaac 60,228,152
wl 4
ra 228,3,6144
v_mov_b32 v30, v29
mvaac 60,232,156
wl 4
ra 232,3,7168
v_mov_b32 v171, 0
mvaac 36,236,48
wl 4
dm 1,12,25,0
mvaac 36,240,60
s_add_u32 m0, s22, 0x1000
s_add_u32 s24, s24, 0x6000
s_add_u32 s38, s66, s71
mvaac 40,236,52
s_add_u32 s22, s28, s23
v_permlane16_swap_b32 v29, v30
mvaac 40,240,64
mx 29,29,30
v_mov_b32 v30, v29
mvaac 44,236,56
ra 236,25,6144
v_add_u32 v4, s30, v1
mvaac 44,240,68
wl 4
ra 240,25,7168
v_add_u32 v33, s38, v22
mvaac 60,244,160
wl 4
ra 244,3,8192
v_add_u32 v2, s31, v1
mvaac 60,248,164
wl 4
ra 248,3,9216
mvaac 36,228,72
wl 4
v_permlane32_swap_b32 v29, v30
mvaac 36,232,84
mx 29,29,30
v_mul_f32 v31, s61, v29
mvaac 40,228,76
v_fma_f32 v216, v216, s32, v31
v_fma_f32 v217, v217, s32, v31
mvaac 40,232,88
dm 1,12,25,1024
mvaac 44,228,80
ra 228,25,8192
s_mov_b32 m0, s22
mvaac 44,232,92
wl 4
ra 232,25,9216
v_fma_f32 v218, v218, s32, v31
mvaac 60,236,168
wl 4
ra 236,3,10240
v_fma_f32 v219, v219, s32, v31
mvaac 60,240,172
wl 4
ra 240,3,11264
v_fma_f32 v220, v220, s32, v31
mvaac 36,244,96
wl 4
ex 216,216
mvaac 36,248,108
ex 217,217
mvaac 40,244,100
ex 218,218
mvaac 40,248,112
ex 219,219
mvaac 44,244,104
ra 244,25,10240
v_fma_f32 v221, v221, s32, v31
mvaac 44,248,116
wl 4
ra 248,25,11264
ad 250,216,217
mvaac 60,228,176
wl 4
ra 228,3,12288
v_fma_f32 v222, v222, s32, v31
mvaac 60,232,180
wl 4
ra 232,3,13312
ad 250,250,218
mvaac 36,236,120
wl 4
ex 220,220
mvaac 36,240,132
ex 221,221
mvaac 40,236,124
ex 222,222
mvaac 40,240,136
v_fma_f32 v223, v223, s32, v31
ad 250,250,219
mvaac 44,236,128
ra 236,3,14336
s_waitcnt vmcnt(7) lgkmcnt(3)
s_barrier
mvaac 44,240,140
ra 240,3,15360
v_fma_f32 v224, v224, s32, v31
mvaac 60,244,184
ra 244,3,16384
ad 250,250,220
mvaac 60,248,188
wl 4
ra 248,3,17408
v_fma_f32 v225, v225, s32, v31
mvaaz 48,228,0
wl 4
ex 223,223
mvaac 48,232,12
ex 224,224
mvaaz 52,228,4
dm 1,12,24,0
mvaac 52,232,16
s_mov_b32 m0, s22
ad 250,250,221
v_fma_f32 v226, v226, s32, v31
mvaaz 56,228,8
ra 228,3,18432
ad 250,250,222
mvaac 56,232,20
wl 4
ra 232,3,19456
v_fma_f32 v227, v227, s32, v31
mvaac 48,236,24
wl 4
ex 225,225
mvaac 48,240,36
ex 226,226
mvaac 52,236,28
v_fma_f32 v228, v228, s32, v31
ad 250,250,223
mvaac 52,240,40
ex 227,227
mvaac 56,236,32
ra 236,3,20480
ad 250,250,224
mvaac 56,240,44
wl 4
ra 240,3,21504
ad 250,250,225
mvaac 48,244,48
wl 4
ex 228,228
mvaac 48,248,60
dm 1,12,24,1024
mvaac 52,244,52
s_mov_b32 m0, s22
ad 250,250,226
mu 228,23,228
mvaac 52,248,64
ad 250,250,227
ad 250,250,228
mvaac 56,244,56
ra 244,3,22528
v_mov_b32 v32, v250
mvaac 56,248,68
wl 4
ra 248,3,23552
mu 216,8,216
mvaac 48,228,72
wl 4
s_mov_b64 exec, s[58:59]
ds_write_b64 v20, v[34:35] offset:136
s_mov_b64 exec, -1
mvaac 48,232,84
v_permlane16_swap_b32 v250, v32
mvaac 52,228,76
ad 250,250,32
v_mov_b32 v32, v250
mvaac 52,232,88
v_permlane32_swap_b32 v250, v32
mvaac 56,228,80
ra 228,4,0
ad 250,250,32
mvaac 56,232,92
wl 5
ra 232,4,1024
mu 217,9,217
mvaac 48,236,96
wl 5
dm 1,12,24,2048
mvaac 48,240,108
v_rcp_f32 v250, v250
mvaac 52,236,100
mu 218,10,218
mu 219,11,219
mvaac 52,240,112
mu 220,12,220
mu 221,13,221
mvaac 56,236,104
ra 236,4,2048
mu 222,14,222
mvaac 56,240,116
wl 5
ra 240,4,3072
mu 223,15,223
mvaac 48,244,120
wl 5
mu 216,250,216
mu 217,250,217
mvaac 48,248,132
mu 218,250,218
mu 219,250,219
mvaac 52,244,124
mu 220,250,220
mu 221,250,221
mvaac 52,248,136
mu 222,250,222
mu 223,250,223
mvaac 56,244,128
ra 244,4,4096
cv 164,216,217
mvaac 56,248,140
s_mov_b32 m0, s22
ra 248,4,5120
cv 165,218,219
cv 166,220,221
cv 167,222,223
mu 224,16,224
mu 225,17,225
mu 226,18,226
mu 227,19,227
cv 34,192,193
cv 35,194,195
mvvvz 192,100,164
s_add_u32 s25, s24, 0x1000
ds_write_b64 v254, v[34:35] offset:0
mu 224,250,224
mu 225,250,225
mu 226,250,226
mu 227,250,227
mu 228,250,228
cv 168,224,225
cv 169,226,227
v_cvt_pk_bf16_f32 v170, v228, 0
cv 34,196,197
cv 35,198,199
mvvvc 192,104,168
ds_write_b64 v254, v[34:35] offset:8
mvvvz 196,108,164
dm 1,12,24,3072
mvvvc 196,112,168
s_add_u32 m0, s22, 0x1000
cv 34,200,201
cv 35,202,203
mvvvz 200,116,164
ds_write_b64 v254, v[34:35] offset:3072
mvvvc 200,120,168
cv 34,204,205
cv 35,206,207
mvvvz 204,124,164
ds_write_b64 v254, v[34:35] offset:3080
mvvvc 204,128,168
cv 34,208,209
cv 35,210,211
mvvvz 208,132,164
ds_write_b64 v254, v[34:35] offset:6144
mvvvc 208,136,168
cv 34,212,213
cv 35,214,215
mvvvz 212,140,164
mu 36,5,36
mu 37,5,37
mvvvc 212,144,168
mu 38,5,38
mu 39,5,39
cv 148,36,37
cv 149,38,39
wl 10
mvaaz 36,228,0
wl 9
mu 40,6,40
mu 41,6,41
mvaac 36,232,12
wl 8
mu 42,6,42
mu 43,6,43
mvaac 36,236,24
cv 152,40,41
cv 153,42,43
mvaaz 40,228,4
mu 44,7,44
mu 45,7,45
mvaac 40,232,16
wl 7
mu 46,7,46
mu 47,7,47
mvaac 36,240,36
cv 156,44,45
cv 157,46,47
mvaaz 44,228,8
ra 228,4,6144
mu 48,5,48
mvaac 44,232,20
ra 232,4,7168
mu 49,5,49
mvaac 40,236,28
mu 50,5,50
mu 51,5,51
mvaac 40,240,40
cv 150,48,49
cv 151,50,51
mvaac 44,236,32
ra 236,4,8192
mu 52,6,52
mvaac 44,240,44
wl 9
ra 240,4,9216
mu 53,6,53
mvaac 36,244,48
wl 9
dm 1,12,25,0
mvaac 36,248,60
s_add_u32 m0, s22, 0x1000
s_add_u32 s24, s24, 0x6000
mu 54,6,54
mvaac 40,244,52
mu 55,6,55
cv 154,52,53
mvaac 40,248,64
cv 155,54,55
mu 56,7,56
mvaac 44,244,56
ra 244,4,10240
mu 57,7,57
mvaac 44,248,68
wl 4
ra 248,4,11264
mu 58,7,58
mvaac 36,228,72
wl 4
mu 59,7,59
cv 158,56,57
mvaac 36,232,84
cv 159,58,59
s_add_u32 s22, s29, s23
mvaac 40,228,76
ds_write_b64 v254, v[34:35] offset:6152
mvaac 40,232,88
dm 1,12,25,1024
mvaac 44,228,80
ra 228,4,12288
s_mov_b32 m0, s22
mvaac 44,232,92
ra 232,4,13312
wv 6
s_barrier
wl 6
mvaac 36,236,96
wl 5
s_add_u32 s25, s24, 0x1000
cv 34,232,233
cv 35,234,235
mvaac 36,240,108
ds_write_b64 v254, v[34:35] offset:1024
mvaac 40,236,100
cv 34,236,237
cv 35,238,239
mvaac 40,240,112
ds_write_b64 v254, v[34:35] offset:1032
mvaac 44,236,104
ra 236,4,14336
cv 34,240,241
mvaac 44,240,116
wl 7
ra 240,4,15360
cv 35,242,243
mvaac 36,244,120
wl 7
ds_write_b64 v254, v[34:35] offset:4096
mvaac 36,248,132
cv 34,244,245
cv 35,246,247
mvaac 40,244,124
ds_write_b64 v254, v[34:35] offset:4104
mvaac 40,248,136
cv 34,184,185
cv 35,186,187
mvaac 44,244,128
ra 244,4,16384
mu 60,24,60
mvaac 44,248,140
wl 8
ra 248,4,17408
mu 61,24,61
mvaaz 48,228,0
wl 8
ds_write_b64 v254, v[34:35] offset:7168
mvaac 48,232,12
cv 34,188,189
cv 35,190,191
mvaaz 52,228,4
dm 1,12,24,0
mvaac 52,232,16
s_mov_b32 m0, s22
mu 62,24,62
mu 63,24,63
mvaaz 56,228,8
ra 228,4,18432
mu 36,5,36
mvaac 56,232,20
wl 7
ra 232,4,19456
mu 37,5,37
mvaac 48,236,24
wl 7
ds_write_b64 v254, v[34:35] offset:7176
mvaac 48,240,36
cv 34,60,61
cv 35,62,63
mvaac 52,236,28
dm 1,12,24,1024
mvaac 52,240,40
s_mov_b32 m0, s22
mu 38,5,38
mu 39,5,39
mvaac 56,236,32
ra 236,4,20480
mu 40,6,40
mvaac 56,240,44
wl 6
ra 240,4,21504
mu 41,6,41
mvaac 48,244,48
wl 6
s_mov_b64 exec, s[56:57]
ds_write_b64 v33, v[34:35] offset:0
s_mov_b64 exec, -1
mvaac 48,248,60
cv 34,192,193
cv 35,194,195
mvaac 52,244,52
dm 1,12,24,2048
mvaac 52,248,64
s_mov_b32 m0, s22
mu 42,6,42
mu 43,6,43
mvaac 56,244,56
ra 244,4,22528
mu 44,7,44
mvaac 56,248,68
wl 6
ra 248,4,23552
mu 45,7,45
mvaac 48,228,72
wl 6
ds_write_b64 v254, v[34:35] offset:2048
mvaac 48,232,84
cv 34,196,197
cv 35,198,199
mvaac 52,228,76
dm 1,12,24,3072
mvaac 52,232,88
s_add_u32 m0, s22, 0x1000
mu 46,7,46
mu 47,7,47
mvaac 56,228,80
ra 228,2,0
cv 160,36,37
mvaac 56,232,92
wl 6
ra 232,2,1024
cv 161,38,39
mvaac 48,236,96
wl 6
ds_write_b64 v254, v[34:35] offset:2056
mvaac 48,240,108
cv 34,200,201
cv 35,202,203
mvaac 52,236,100
dm 1,12,25,0
mvaac 52,240,112
s_add_u32 m0, s22, 0x1000
s_add_u32 s24, s24, 0x6000
cv 164,40,41
mvaac 56,236,104
ra 236,2,2048
cv 165,42,43
mvaac 56,240,116
wl 6
ra 240,2,3072
cv 168,44,45
mvaac 48,244,120
wl 6
ds_write_b64 v254, v[34:35] offset:5120
mvaac 48,248,132
cv 34,204,205
cv 35,206,207
mvaac 52,244,124
dm 1,12,25,1024
mvaac 52,248,136
ds_write_b64 v254, v[34:35] offset:5128
mvaac 56,244,128
cv 34,208,209
cv 35,210,211
mvaac 56,248,140
ds_write_b64 v254, v[34:35] offset:8192
cv 34,212,213
cv 35,214,215
cv 169,46,47
ds_write_b64 v254, v[34:35] offset:8200
s_cmp_ge_u32 s20, 2
s_cbranch_scc1 L_pxe1
s_add_u32 s49, s60, 0
buffer_store_dwordx4 a[144:147], v1, s[12:15], s49 offen
s_add_u32 s49, s60, 1024
buffer_store_dwordx4 a[152:155], v1, s[12:15], s49 offen
s_add_u32 s49, s60, 2048
buffer_store_dwordx4 a[160:163], v1, s[12:15], s49 offen
s_add_u32 s49, s60, 3072
buffer_store_dwordx4 a[168:171], v1, s[12:15], s49 offen
s_add_u32 s49, s60, 4096
buffer_store_dwordx4 a[176:179], v1, s[12:15], s49 offen
s_add_u32 s49, s60, 5120
buffer_store_dwordx4 a[184:187], v1, s[12:15], s49 offen
s_branch L_pxe2
L_pxe1:
s_add_u32 s49, s60, 0
buffer_store_dwordx4 a[148:151], v1, s[12:15], s49 offen
s_add_u32 s49, s60, 1024
buffer_store_dwordx4 a[156:159], v1, s[12:15], s49 offen
s_add_u32 s49, s60, 2048
buffer_store_dwordx4 a[164:167], v1, s[12:15], s49 offen
s_add_u32 s49, s60, 3072
buffer_store_dwordx4 a[172:175], v1, s[12:15], s49 offen
s_add_u32 s49, s60, 4096
buffer_store_dwordx4 a[180:183], v1, s[12:15], s49 offen
s_add_u32 s49, s60, 5120
buffer_store_dwordx4 a[188:191], v1, s[12:15], s49 offen
L_pxe2:
wv 0
wv 0
wv 0
wv 0
wv 0
wv 0
s_branch L_b2x
L_b1x_1:
mvvvz 232,100,172
ds_read_u16 v106, v21 offset:192
ds_read_u16 v114, v21 offset:200
mvvvz 236,108,172
ds_read_u16 v122, v21 offset:256
ds_read_u16 v130, v21 offset:264
mvvvz 240,116,172
ds_read_u16 v138, v21 offset:320
ds_read_u16 v146, v21 offset:328
mvvvz 244,124,172
cv 140,48,49
cv 141,50,51
mvvvz 184,132,172
wl 9
cv 142,52,53
cv 143,54,55
mvaaz 36,228,0
cv 144,56,57
cv 145,58,59
mvvvz 188,140,172
wl 5
ra 244,2,4096
v_max3_f32 v26, v200, v201, v202
mvvvc 232,104,176
wl 5
ra 248,2,5120
v_max3_f32 v26, v26, v203, v204
mvvvc 236,112,176
wl 5
v_max3_f32 v26, v26, v205, v206
v_max3_f32 v26, v26, v207, v208
mvvvc 240,120,176
wl 4
v_max3_f32 v26, v26, v209, v210
v_max3_f32 v26, v26, v211, v212
mvvvc 244,128,176
wl 3
v_mov_b32 v27, v26
s_add_u32 s27, s27, 9
mvvvc 184,136,176
wl 2
v_permlane16_swap_b32 v26, v27
mvvvc 188,144,176
mx 26,26,27
v_mov_b32 v27, v26
mvaac 36,232,12
v_permlane32_swap_b32 v26, v27
mvaaz 40,228,4
mx 26,26,27
v_mul_f32 v28, s61, v26
mvaac 40,232,16
v_fma_f32 v200, v200, s32, v28
v_fma_f32 v201, v201, s32, v28
mvaaz 44,228,8
ra 228,2,6144
v_fma_f32 v202, v202, s32, v28
mvaac 44,232,20
ra 232,2,7168
v_fma_f32 v203, v203, s32, v28
mvaac 36,236,24
ex 200,200
mvaac 36,240,36
ex 201,201
mvaac 40,236,28
ex 202,202
mvaac 40,240,40
ex 203,203
mvaac 44,236,32
ra 236,2,8192
v_fma_f32 v204, v204, s32, v28
mvaac 44,240,44
wl 4
ra 240,2,9216
v_fma_f32 v205, v205, s32, v28
mvaac 36,244,48
wl 4
ex 204,204
mvaac 36,248,60
ad 249,200,201
v_fma_f32 v206, v206, s32, v28
mvaac 40,244,52
ex 205,205
mvaac 40,248,64
ad 249,249,202
v_fma_f32 v207, v207, s32, v28
mvaac 44,244,56
ra 244,2,10240
ad 249,249,203
mvaac 44,248,68
wl 4
ra 248,2,11264
v_fma_f32 v208, v208, s32, v28
mvaac 36,228,72
wl 4
ex 206,206
mvaac 36,232,84
ex 207,207
mvaac 40,228,76
ad 249,249,204
v_fma_f32 v209, v209, s32, v28
mvaac 40,232,88
ex 208,208
mvaac 44,228,80
ra 228,2,12288
ad 249,249,205
mvaac 44,232,92
wl 4
ra 232,2,13312
v_fma_f32 v210, v210, s32, v28
mvaac 36,236,96
wl 4
ex 209,209
mvaac 36,240,108
ad 249,249,206
v_fma_f32 v211, v211, s32, v28
mvaac 40,236,100
ex 210,210
mvaac 40,240,112
v_fma_f32 v212, v212, s32, v28
ad 249,249,207
mvaac 44,236,104
ra 236,2,14336
ad 249,249,208
mvaac 44,240,116
wl 4
ra 240,2,15360
ad 249,249,209
mvaac 36,244,120
wl 4
ex 211,211
mvaac 36,248,132
ex 212,212
mvaac 40,244,124
ad 249,249,210
mu 212,23,212
mvaac 40,248,136
ad 249,249,211
ad 249,249,212
mvaac 44,244,128
ra 244,2,16384
v_mov_b32 v32, v249
mvaac 44,248,140
ra 248,2,17408
mu 200,8,200
mvvvz 192,100,148
v_permlane16_swap_b32 v249, v32
mvvvc 192,104,152
ad 249,249,32
v_mov_b32 v32, v249
mvvvz 196,108,148
v_permlane32_swap_b32 v249, v32
mvvvc 196,112,152
wl 5
ad 249,249,32
v_rcp_f32 v249, v249
mvaaz 48,228,0
wl 4
mu 201,9,201
mu 202,10,202
mvaac 48,232,12
mu 203,11,203
mu 200,249,200
mvaaz 52,228,4
mu 201,249,201
mu 202,249,202
mvaac 52,232,16
mu 203,249,203
cv 156,200,201
mvaaz 56,228,8
ra 228,2,18432
cv 157,202,203
mvvvz 200,116,148
mu 204,12,204
mu 205,13,205
mvvvc 200,120,152
mu 206,14,206
mu 207,15,207
mvaac 56,232,20
wl 4
ra 232,2,19456
mu 204,249,204
mvaac 48,236,24
wl 4
mu 205,249,205
mu 206,249,206
mvaac 48,240,36
mu 207,249,207
cv 158,204,205
mvaac 52,236,28
cv 159,206,207
mu 208,16,208
mvvvz 204,124,148
mu 209,17,209
mu 210,18,210
mvvvc 204,128,152
mu 211,19,211
mu 208,249,208
mvaac 52,240,40
mu 209,249,209
mu 210,249,210
mvaac 56,236,32
ra 236,2,20480
mu 211,249,211
mvaac 56,240,44
wl 4
ra 240,2,21504
cv 160,208,209
mvaac 48,244,48
cv 161,210,211
mu 212,249,212
mvvvz 208,132,148
v_cvt_pk_bf16_f32 v162, v212, 0
s_add_u32 s37, s27, 0
mvvvc 208,136,152
s_and_b32 s37, s37, 3
s_mul_i32 s28, s37, 0x6000
s_add_u32 s37, s27, 1
mvvvz 212,140,148
s_and_b32 s37, s37, 3
s_mul_i32 s29, s37, 0x6000
s_add_u32 s37, s27, 2
mvvvc 212,144,152
wl 4
s_and_b32 s37, s37, 3
s_mul_i32 s30, s37, 0x6000
s_add_u32 s37, s27, 3
mvaac 48,248,60
s_and_b32 s37, s37, 3
s_mul_i32 s31, s37, 0x6000
s_add_u32 s71, s71, 0xc0
mvaac 52,244,52
s_add_u32 s22, s31, s23
s_mov_b32 m0, s22
v_mov_b32 v253, 4
mvaac 52,248,64
buffer_load_dword v255, v253, s[4:7], 0 offen offset:0 sc1
mvaac 56,244,56
ra 244,2,22528
wv 9
s_barrier
mvaac 56,248,68
wl 4
ra 248,2,23552
dm 1,12,24,0
mvaac 48,228,72
wl 4
s_mov_b32 m0, s22
cv 34,232,233
cv 35,234,235
mvaac 48,232,84
dm 1,12,24,1024
mvaac 52,228,76
s_mov_b32 m0, s22
v_mov_b32 v163, 0
v_add_u32 v3, s29, v1
mvaac 52,232,88
s_mov_b64 exec, s[58:59]
ds_write_b64 v20, v[34:35] offset:192
s_mov_b64 exec, -1
mvaac 56,228,80
ra 228,3,0
cv 34,236,237
mvaac 56,232,92
wl 5
ra 232,3,1024
cv 35,238,239
mvaac 48,236,96
wl 5
dm 1,12,24,2048
mvaac 48,240,108
s_mov_b64 exec, s[58:59]
ds_write_b64 v20, v[34:35] offset:200
s_mov_b64 exec, -1
mvaac 52,236,100
cv 34,240,241
cv 35,242,243
mvaac 52,240,112
s_mov_b64 exec, s[58:59]
ds_write_b64 v20, v[34:35] offset:256
s_mov_b64 exec, -1
mvaac 56,236,104
s_mov_b32 m0, s22
cv 34,244,245
cv 35,246,247
mvaac 56,240,116
wl 6
s_mov_b64 exec, s[58:59]
ds_write_b64 v20, v[34:35] offset:264
s_mov_b64 exec, -1
mvaac 48,244,120
wl 6
cv 34,184,185
cv 35,186,187
mvaac 48,248,132
s_mov_b64 exec, s[58:59]
ds_write_b64 v20, v[34:35] offset:320
s_mov_b64 exec, -1
mvaac 52,244,124
cv 34,188,189
cv 35,190,191
mvaac 52,248,136
s_cmp_ge_u32 s20, 2
s_cselect_b32 s37, s29, s28
s_add_u32 s37, s37, s72
mvaac 56,244,128
ra 244,3,2048
v_add_u32 v25, s37, v1
mvaac 56,248,140
ra 236,25,0
mu 36,5,36
mvvvz 232,100,156
ra 240,25,1024
mu 37,5,37
mvvvc 232,104,160
ra 248,3,3072
mu 38,5,38
mvvvz 236,108,156
dm 1,12,24,3072
mvvvc 236,112,160
mu 39,5,39
cv 172,36,37
mvvvz 240,116,156
cv 173,38,39
mu 40,6,40
mvvvc 240,120,160
mu 41,6,41
mu 42,6,42
mvvvz 244,124,156
mu 43,6,43
cv 176,40,41
mvvvc 244,128,160
cv 177,42,43
mu 44,7,44
mvvvz 184,132,156
mu 45,7,45
mu 46,7,46
mvvvc 184,136,160
mu 47,7,47
cv 180,44,45
mvvvz 188,140,156
cv 181,46,47
s_add_u32 s25, s24, 0x1000
mvvvc 188,144,160
wl 9
s_add_u32 m0, s22, 0x1000
mu 48,5,48
mu 49,5,49
mvaaz 36,228,0
wl 8
mu 50,5,50
mu 51,5,51
mvaac 36,232,12
cv 174,48,49
cv 175,50,51
mvaaz 40,228,4
mu 52,6,52
mu 53,6,53
mvaac 40,232,16
mu 54,6,54
mu 55,6,55
mvaaz 44,228,8
ra 228,25,2048
cv 178,52,53
mvaac 44,232,20
wl 3
ra 232,25,3072
cv 179,54,55
mvaaz 60,236,144
wl 3
ra 236,3,4096
mu 56,7,56
mvaac 60,240,148
ra 240,3,5120
mu 57,7,57
mvaac 36,244,24
wl 4
mu 58,7,58
mu 59,7,59
mvaac 36,248,36
cv 182,56,57
cv 183,58,59
mvaac 40,244,28
v_max3_f32 v29, v216, v217, v218
v_max3_f32 v29, v29, v219, v220
mvaac 40,248,40
v_max3_f32 v29, v29, v221, v222
v_max3_f32 v29, v29, v223, v224
mvaac 44,244,32
ra 244,25,4096
v_max3_f32 v29, v29, v225, v226
mvaac 44,248,44
wl 4
ra 248,25,5120
v_max3_f32 v29, v29, v227, v228
mvaac 60,228,152
wl 4
ra 228,3,6144
v_mov_b32 v30, v29
mvaac 60,232,156
wl 4
ra 232,3,7168
v_mov_b32 v171, 0
mvaac 36,236,48
wl 4
dm 1,12,25,0
mvaac 36,240,60
s_add_u32 m0, s22, 0x1000
s_add_u32 s24, s24, 0x6000
s_add_u32 s38, s66, s71
mvaac 40,236,52
s_add_u32 s22, s28, s23
v_permlane16_swap_b32 v29, v30
mvaac 40,240,64
mx 29,29,30
v_mov_b32 v30, v29
mvaac 44,236,56
ra 236,25,6144
v_add_u32 v4, s30, v1
mvaac 44,240,68
wl 4
ra 240,25,7168
v_add_u32 v33, s38, v22
mvaac 60,244,160
wl 4
ra 244,3,8192
v_add_u32 v2, s31, v1
mvaac 60,248,164
wl 4
ra 248,3,9216
mvaac 36,228,72
wl 4
v_permlane32_swap_b32 v29, v30
mvaac 36,232,84
mx 29,29,30
v_mul_f32 v31, s61, v29
mvaac 40,228,76
v_fma_f32 v216, v216, s32, v31
v_fma_f32 v217, v217, s32, v31
mvaac 40,232,88
dm 1,12,25,1024
mvaac 44,228,80
ra 228,25,8192
s_mov_b32 m0, s22
mvaac 44,232,92
wl 4
ra 232,25,9216
v_fma_f32 v218, v218, s32, v31
mvaac 60,236,168
wl 4
ra 236,3,10240
v_fma_f32 v219, v219, s32, v31
mvaac 60,240,172
wl 4
ra 240,3,11264
v_fma_f32 v220, v220, s32, v31
mvaac 36,244,96
wl 4
ex 216,216
mvaac 36,248,108
ex 217,217
mvaac 40,244,100
ex 218,218
mvaac 40,248,112
ex 219,219
mvaac 44,244,104
ra 244,25,10240
v_fma_f32 v221, v221, s32, v31
mvaac 44,248,116
wl 4
ra 248,25,11264
ad 250,216,217
mvaac 60,228,176
wl 4
ra 228,3,12288
v_fma_f32 v222, v222, s32, v31
mvaac 60,232,180
wl 4
ra 232,3,13312
ad 250,250,218
mvaac 36,236,120
wl 4
ex 220,220
mvaac 36,240,132
ex 221,221
mvaac 40,236,124
ex 222,222
mvaac 40,240,136
v_fma_f32 v223, v223, s32, v31
ad 250,250,219
mvaac 44,236,128
ra 236,3,14336
s_waitcnt vmcnt(8) lgkmcnt(3)
s_barrier
mvaac 44,240,140
ra 240,3,15360
v_fma_f32 v224, v224, s32, v31
mvaac 60,244,184
ra 244,3,16384
ad 250,250,220
mvaac 60,248,188
wl 4
ra 248,3,17408
v_fma_f32 v225, v225, s32, v31
mvaaz 48,228,0
wl 4
ex 223,223
mvaac 48,232,12
ex 224,224
mvaaz 52,228,4
dm 1,12,24,0
mvaac 52,232,16
s_mov_b32 m0, s22
ad 250,250,221
v_fma_f32 v226, v226, s32, v31
mvaaz 56,228,8
ra 228,3,18432
ad 250,250,222
mvaac 56,232,20
wl 4
ra 232,3,19456
v_fma_f32 v227, v227, s32, v31
mvaac 48,236,24
wl 4
ex 225,225
mvaac 48,240,36
ex 226,226
mvaac 52,236,28
v_fma_f32 v228, v228, s32, v31
ad 250,250,223
mvaac 52,240,40
ex 227,227
mvaac 56,236,32
ra 236,3,20480
ad 250,250,224
mvaac 56,240,44
wl 4
ra 240,3,21504
ad 250,250,225
mvaac 48,244,48
wl 4
ex 228,228
mvaac 48,248,60
dm 1,12,24,1024
mvaac 52,244,52
s_mov_b32 m0, s22
ad 250,250,226
mu 228,23,228
mvaac 52,248,64
ad 250,250,227
ad 250,250,228
mvaac 56,244,56
ra 244,3,22528
v_mov_b32 v32, v250
mvaac 56,248,68
wl 4
ra 248,3,23552
mu 216,8,216
mvaac 48,228,72
wl 4
s_mov_b64 exec, s[58:59]
ds_write_b64 v20, v[34:35] offset:328
s_mov_b64 exec, -1
mvaac 48,232,84
v_permlane16_swap_b32 v250, v32
mvaac 52,228,76
ad 250,250,32
v_mov_b32 v32, v250
mvaac 52,232,88
v_permlane32_swap_b32 v250, v32
mvaac 56,228,80
ra 228,4,0
ad 250,250,32
mvaac 56,232,92
wl 5
ra 232,4,1024
mu 217,9,217
mvaac 48,236,96
wl 5
dm 1,12,24,2048
mvaac 48,240,108
v_rcp_f32 v250, v250
mvaac 52,236,100
mu 218,10,218
mu 219,11,219
mvaac 52,240,112
mu 220,12,220
mu 221,13,221
mvaac 56,236,104
ra 236,4,2048
mu 222,14,222
mvaac 56,240,116
wl 5
ra 240,4,3072
mu 223,15,223
mvaac 48,244,120
wl 5
mu 216,250,216
mu 217,250,217
mvaac 48,248,132
mu 218,250,218
mu 219,250,219
mvaac 52,244,124
mu 220,250,220
mu 221,250,221
mvaac 52,248,136
mu 222,250,222
mu 223,250,223
mvaac 56,244,128
ra 244,4,4096
cv 164,216,217
mvaac 56,248,140
s_mov_b32 m0, s22
ra 248,4,5120
cv 165,218,219
cv 166,220,221
cv 167,222,223
mu 224,16,224
mu 225,17,225
mu 226,18,226
mu 227,19,227
cv 34,192,193
cv 35,194,195
mvvvz 192,100,164
s_add_u32 s25, s24, 0x1000
mu 224,250,224
mu 225,250,225
mu 226,250,226
mu 227,250,227
mu 228,250,228
cv 168,224,225
cv 169,226,227
v_cvt_pk_bf16_f32 v170, v228, 0
aw 192,34
aw 193,35
mvvvc 192,104,168
cv 34,196,197
cv 35,198,199
mvvvz 196,108,164
dm 1,12,24,3072
mvvvc 196,112,168
s_add_u32 m0, s22, 0x1000
aw 194,34
aw 195,35
cv 34,200,201
cv 35,202,203
mvvvz 200,116,164
aw 204,34
aw 205,35
mvvvc 200,120,168
cv 34,204,205
cv 35,206,207
mvvvz 204,124,164
aw 206,34
aw 207,35
mvvvc 204,128,168
cv 34,208,209
cv 35,210,211
mvvvz 208,132,164
aw 216,34
aw 217,35
mvvvc 208,136,168
cv 34,212,213
cv 35,214,215
mvvvz 212,140,164
mu 36,5,36
mu 37,5,37
mvvvc 212,144,168
mu 38,5,38
mu 39,5,39
cv 148,36,37
cv 149,38,39
wl 5
mvaaz 36,228,0
wl 4
mu 40,6,40
mu 41,6,41
mvaac 36,232,12
wl 3
mu 42,6,42
mu 43,6,43
mvaac 36,236,24
cv 152,40,41
cv 153,42,43
mvaaz 40,228,4
mu 44,7,44
mu 45,7,45
mvaac 40,232,16
wl 2
mu 46,7,46
mu 47,7,47
mvaac 36,240,36
cv 156,44,45
cv 157,46,47
mvaaz 44,228,8
ra 228,4,6144
mu 48,5,48
mvaac 44,232,20
ra 232,4,7168
mu 49,5,49
mvaac 40,236,28
mu 50,5,50
mu 51,5,51
mvaac 40,240,40
cv 150,48,49
cv 151,50,51
mvaac 44,236,32
ra 236,4,8192
mu 52,6,52
mvaac 44,240,44
wl 4
ra 240,4,9216
mu 53,6,53
mvaac 36,244,48
wl 4
dm 1,12,25,0
mvaac 36,248,60
s_add_u32 m0, s22, 0x1000
s_add_u32 s24, s24, 0x6000
mu 54,6,54
mvaac 40,244,52
mu 55,6,55
cv 154,52,53
mvaac 40,248,64
cv 155,54,55
mu 56,7,56
mvaac 44,244,56
ra 244,4,10240
mu 57,7,57
mvaac 44,248,68
wl 4
ra 248,4,11264
mu 58,7,58
mvaac 36,228,72
wl 4
mu 59,7,59
cv 158,56,57
mvaac 36,232,84
cv 159,58,59
s_add_u32 s22, s29, s23
mvaac 40,228,76
aw 218,34
aw 219,35
mvaac 40,232,88
dm 1,12,25,1024
mvaac 44,228,80
ra 228,4,12288
s_mov_b32 m0, s22
mvaac 44,232,92
ra 232,4,13312
wv 6
s_barrier
wl 5
mvaac 36,236,96
wl 4
s_add_u32 s25, s24, 0x1000
cv 34,232,233
cv 35,234,235
mvaac 36,240,108
aw 196,34
aw 197,35
mvaac 40,236,100
cv 34,236,237
cv 35,238,239
mvaac 40,240,112
aw 198,34
aw 199,35
mvaac 44,236,104
ra 236,4,14336
cv 34,240,241
mvaac 44,240,116
wl 4
ra 240,4,15360
cv 35,242,243
mvaac 36,244,120
wl 4
aw 208,34
aw 209,35
mvaac 36,248,132
cv 34,244,245
cv 35,246,247
mvaac 40,244,124
aw 210,34
aw 211,35
mvaac 40,248,136
cv 34,184,185
cv 35,186,187
mvaac 44,244,128
ra 244,4,16384
aw 220,34
mvaac 44,248,140
wl 4
ra 248,4,17408
aw 221,35
mvaaz 48,228,0
wl 4
cv 34,188,189
cv 35,190,191
mvaac 48,232,12
aw 222,34
aw 223,35
mvaaz 52,228,4
dm 1,12,24,0
mvaac 52,232,16
s_mov_b32 m0, s22
mu 60,24,60
mu 61,24,61
mvaaz 56,228,8
ra 228,4,18432
mu 62,24,62
mvaac 56,232,20
wl 4
ra 232,4,19456
mu 63,24,63
mvaac 48,236,24
wl 4
cv 34,60,61
cv 35,62,63
mvaac 48,240,36
s_mov_b64 exec, s[56:57]
ds_write_b64 v33, v[34:35] offset:0
s_mov_b64 exec, -1
mvaac 52,236,28
dm 1,12,24,1024
mvaac 52,240,40
s_mov_b32 m0, s22
cv 34,192,193
cv 35,194,195
mvaac 56,236,32
ra 236,4,20480
aw 200,34
mvaac 56,240,44
wl 5
ra 240,4,21504
aw 201,35
mvaac 48,244,48
wl 5
cv 34,196,197
cv 35,198,199
mvaac 48,248,60
aw 202,34
aw 203,35
mvaac 52,244,52
dm 1,12,24,2048
mvaac 52,248,64
s_mov_b32 m0, s22
cv 34,200,201
cv 35,202,203
mvaac 56,244,56
ra 244,4,22528
aw 212,34
mvaac 56,248,68
wl 5
ra 248,4,23552
aw 213,35
mvaac 48,228,72
wl 5
cv 34,204,205
cv 35,206,207
mvaac 48,232,84
aw 214,34
aw 215,35
mvaac 52,228,76
dm 1,12,24,3072
mvaac 52,232,88
s_add_u32 m0, s22, 0x1000
cv 34,208,209
cv 35,210,211
mvaac 56,228,80
ra 228,2,0
aw 224,34
mvaac 56,232,92
wl 4
ra 232,2,1024
aw 225,35
mvaac 48,236,96
wl 4
cv 34,212,213
cv 35,214,215
mvaac 48,240,108
mu 36,5,36
mu 37,5,37
mvaac 52,236,100
dm 1,12,25,0
mvaac 52,240,112
s_add_u32 m0, s22, 0x1000
s_add_u32 s24, s24, 0x6000
mu 38,5,38
mvaac 56,236,104
ra 236,2,2048
mu 39,5,39
mvaac 56,240,116
wl 4
ra 240,2,3072
mu 40,6,40
mvaac 48,244,120
wl 4
mu 41,6,41
mu 42,6,42
mvaac 48,248,132
mu 43,6,43
mu 44,7,44
mvaac 52,244,124
dm 1,12,25,1024
mvaac 52,248,136
mu 45,7,45
mu 46,7,46
mvaac 56,244,128
mu 47,7,47
aw 226,34
mvaac 56,248,140
aw 227,35
cv 160,36,37
cv 161,38,39
cv 164,40,41
cv 165,42,43
cv 168,44,45
cv 169,46,47
v_readfirstlane_b32 s49, v255
s_nop 4
s_cmp_ge_u32 s49, 12
s_cbranch_scc1 L_chk1_ok
s_mov_b32 s62, 0
L_chk1_spin:
v_mov_b32 v255, 4
s_nop 1
buffer_load_dword v255, v255, s[4:7], 0 offen sc1
wv 0
v_readfirstlane_b32 s49, v255
s_add_u32 s62, s62, 1
s_nop 3
s_cmp_ge_u32 s49, 12
s_cbranch_scc1 L_chk1_ok
s_cmp_lt_u32 s62, 0x40000
s_cbranch_scc1 L_chk1_spin
L_chk1_ok:
s_branch L_b2x
L_b1x_2:
mvvvz 232,100,172
ds_read_u16 v106, v21 offset:384
ds_read_u16 v114, v21 offset:392
mvvvz 236,108,172
ds_read_u16 v122, v21 offset:448
ds_read_u16 v130, v21 offset:456
mvvvz 240,116,172
ds_read_u16 v138, v21 offset:512
ds_read_u16 v146, v21 offset:520
mvvvz 244,124,172
cv 140,48,49
cv 141,50,51
mvvvz 184,132,172
wl 9
cv 142,52,53
cv 143,54,55
mvaaz 36,228,0
cv 144,56,57
cv 145,58,59
mvvvz 188,140,172
wl 5
ra 244,2,4096
v_max3_f32 v26, v200, v201, v202
mvvvc 232,104,176
wl 5
ra 248,2,5120
v_max3_f32 v26, v26, v203, v204
mvvvc 236,112,176
wl 5
v_max3_f32 v26, v26, v205, v206
v_max3_f32 v26, v26, v207, v208
mvvvc 240,120,176
wl 4
v_max3_f32 v26, v26, v209, v210
v_max3_f32 v26, v26, v211, v212
mvvvc 244,128,176
wl 3
v_mov_b32 v27, v26
s_add_u32 s27, s27, 9
mvvvc 184,136,176
wl 2
v_permlane16_swap_b32 v26, v27
mvvvc 188,144,176
mx 26,26,27
v_mov_b32 v27, v26
mvaac 36,232,12
v_permlane32_swap_b32 v26, v27
mvaaz 40,228,4
mx 26,26,27
v_mul_f32 v28, s61, v26
mvaac 40,232,16
v_fma_f32 v200, v200, s32, v28
v_fma_f32 v201, v201, s32, v28
mvaaz 44,228,8
ra 228,2,6144
v_fma_f32 v202, v202, s32, v28
mvaac 44,232,20
ra 232,2,7168
v_fma_f32 v203, v203, s32, v28
mvaac 36,236,24
ex 200,200
mvaac 36,240,36
ex 201,201
mvaac 40,236,28
ex 202,202
mvaac 40,240,40
ex 203,203
mvaac 44,236,32
ra 236,2,8192
v_fma_f32 v204, v204, s32, v28
mvaac 44,240,44
wl 4
ra 240,2,9216
v_fma_f32 v205, v205, s32, v28
mvaac 36,244,48
wl 4
ex 204,204
mvaac 36,248,60
ad 249,200,201
v_fma_f32 v206, v206, s32, v28
mvaac 40,244,52
ex 205,205
mvaac 40,248,64
ad 249,249,202
v_fma_f32 v207, v207, s32, v28
mvaac 44,244,56
ra 244,2,10240
ad 249,249,203
mvaac 44,248,68
wl 4
ra 248,2,11264
v_fma_f32 v208, v208, s32, v28
mvaac 36,228,72
wl 4
ex 206,206
mvaac 36,232,84
ex 207,207
mvaac 40,228,76
ad 249,249,204
v_fma_f32 v209, v209, s32, v28
mvaac 40,232,88
ex 208,208
mvaac 44,228,80
ra 228,2,12288
ad 249,249,205
mvaac 44,232,92
wl 4
ra 232,2,13312
v_fma_f32 v210, v210, s32, v28
mvaac 36,236,96
wl 4
ex 209,209
mvaac 36,240,108
ad 249,249,206
v_fma_f32 v211, v211, s32, v28
mvaac 40,236,100
ex 210,210
mvaac 40,240,112
v_fma_f32 v212, v212, s32, v28
ad 249,249,207
mvaac 44,236,104
ra 236,2,14336
ad 249,249,208
mvaac 44,240,116
wl 4
ra 240,2,15360
ad 249,249,209
mvaac 36,244,120
wl 4
ex 211,211
mvaac 36,248,132
ex 212,212
mvaac 40,244,124
ad 249,249,210
mu 212,23,212
mvaac 40,248,136
ad 249,249,211
ad 249,249,212
mvaac 44,244,128
ra 244,2,16384
v_mov_b32 v32, v249
mvaac 44,248,140
ra 248,2,17408
mu 200,8,200
mvvvz 192,100,148
v_permlane16_swap_b32 v249, v32
mvvvc 192,104,152
ad 249,249,32
v_mov_b32 v32, v249
mvvvz 196,108,148
v_permlane32_swap_b32 v249, v32
mvvvc 196,112,152
wl 5
ad 249,249,32
v_rcp_f32 v249, v249
mvaaz 48,228,0
wl 4
mu 201,9,201
mu 202,10,202
mvaac 48,232,12
mu 203,11,203
mu 200,249,200
mvaaz 52,228,4
mu 201,249,201
mu 202,249,202
mvaac 52,232,16
mu 203,249,203
cv 156,200,201
mvaaz 56,228,8
ra 228,2,18432
cv 157,202,203
mvvvz 200,116,148
mu 204,12,204
mu 205,13,205
mvvvc 200,120,152
mu 206,14,206
mu 207,15,207
mvaac 56,232,20
wl 4
ra 232,2,19456
mu 204,249,204
mvaac 48,236,24
wl 4
mu 205,249,205
mu 206,249,206
mvaac 48,240,36
mu 207,249,207
cv 158,204,205
mvaac 52,236,28
cv 159,206,207
mu 208,16,208
mvvvz 204,124,148
mu 209,17,209
mu 210,18,210
mvvvc 204,128,152
mu 211,19,211
mu 208,249,208
mvaac 52,240,40
mu 209,249,209
mu 210,249,210
mvaac 56,236,32
ra 236,2,20480
mu 211,249,211
mvaac 56,240,44
wl 4
ra 240,2,21504
cv 160,208,209
mvaac 48,244,48
cv 161,210,211
mu 212,249,212
mvvvz 208,132,148
v_cvt_pk_bf16_f32 v162, v212, 0
s_add_u32 s37, s27, 0
mvvvc 208,136,152
s_and_b32 s37, s37, 3
s_mul_i32 s28, s37, 0x6000
s_add_u32 s37, s27, 1
mvvvz 212,140,148
s_and_b32 s37, s37, 3
s_mul_i32 s29, s37, 0x6000
s_add_u32 s37, s27, 2
mvvvc 212,144,152
wl 4
s_and_b32 s37, s37, 3
s_mul_i32 s30, s37, 0x6000
s_add_u32 s37, s27, 3
mvaac 48,248,60
s_and_b32 s37, s37, 3
s_mul_i32 s31, s37, 0x6000
s_add_u32 s71, s71, 0xc0
mvaac 52,244,52
s_add_u32 s22, s31, s23
s_mov_b32 m0, s22
wv 8
s_barrier
mvaac 52,248,64
cv 34,232,233
dm 1,12,24,0
mvaac 56,244,56
ra 244,2,22528
s_mov_b32 m0, s22
mvaac 56,248,68
wl 4
ra 248,2,23552
cv 35,234,235
mvaac 48,228,72
wl 4
dm 1,12,24,1024
mvaac 48,232,84
s_mov_b32 m0, s22
v_mov_b32 v163, 0
v_add_u32 v3, s29, v1
mvaac 52,228,76
s_mov_b64 exec, s[58:59]
ds_write_b64 v20, v[34:35] offset:384
s_mov_b64 exec, -1
mvaac 52,232,88
cv 34,236,237
cv 35,238,239
mvaac 56,228,80
ra 228,3,0
s_cmp_ge_u32 s20, 2
mvaac 56,232,92
wl 5
ra 232,3,1024
s_cselect_b32 s37, s29, s28
mvaac 48,236,96
wl 5
dm 1,12,24,2048
mvaac 48,240,108
s_mov_b64 exec, s[58:59]
ds_write_b64 v20, v[34:35] offset:392
s_mov_b64 exec, -1
mvaac 52,236,100
cv 34,240,241
cv 35,242,243
mvaac 52,240,112
s_mov_b64 exec, s[58:59]
ds_write_b64 v20, v[34:35] offset:448
s_mov_b64 exec, -1
mvaac 56,236,104
s_mov_b32 m0, s22
cv 34,244,245
cv 35,246,247
mvaac 56,240,116
wl 6
s_mov_b64 exec, s[58:59]
ds_write_b64 v20, v[34:35] offset:456
s_mov_b64 exec, -1
mvaac 48,244,120
wl 6
cv 34,184,185
cv 35,186,187
mvaac 48,248,132
s_mov_b64 exec, s[58:59]
ds_write_b64 v20, v[34:35] offset:512
s_mov_b64 exec, -1
mvaac 52,244,124
cv 34,188,189
cv 35,190,191
mvaac 52,248,136
s_add_u32 s37, s37, s72
v_add_u32 v25, s37, v1
mu 36,5,36
mvaac 56,244,128
ra 236,25,0
mu 37,5,37
mvaac 56,248,140
ra 240,25,1024
mu 38,5,38
mvvvz 232,100,156
ra 244,3,2048
mu 39,5,39
mvvvc 232,104,160
ra 248,3,3072
cv 172,36,37
mvvvz 236,108,156
dm 1,12,24,3072
mvvvc 236,112,160
cv 173,38,39
mu 40,6,40
mvvvz 240,116,156
mu 41,6,41
mu 42,6,42
mvvvc 240,120,160
mu 43,6,43
cv 176,40,41
mvvvz 244,124,156
cv 177,42,43
mu 44,7,44
mvvvc 244,128,160
mu 45,7,45
mu 46,7,46
mvvvz 184,132,156
mu 47,7,47
cv 180,44,45
mvvvc 184,136,160
cv 181,46,47
s_add_u32 s25, s24, 0x1000
mvvvz 188,140,156
s_add_u32 m0, s22, 0x1000
mu 48,5,48
mu 49,5,49
mvvvc 188,144,160
wl 9
mu 50,5,50
mu 51,5,51
mvaaz 36,228,0
wl 8
cv 174,48,49
cv 175,50,51
mvaac 36,232,12
mu 52,6,52
mu 53,6,53
mvaaz 40,228,4
mu 54,6,54
mu 55,6,55
mvaac 40,232,16
cv 178,52,53
cv 179,54,55
mvaaz 44,228,8
ra 228,25,2048
mu 56,7,56
mvaac 44,232,20
wl 4
ra 232,25,3072
mu 57,7,57
mvaaz 60,236,144
wl 4
ra 236,3,4096
mu 58,7,58
mvaac 60,240,148
wl 4
ra 240,3,5120
mu 59,7,59
mvaac 36,244,24
wl 4
cv 182,56,57
cv 183,58,59
mvaac 36,248,36
v_max3_f32 v29, v216, v217, v218
v_max3_f32 v29, v29, v219, v220
mvaac 40,244,28
v_max3_f32 v29, v29, v221, v222
v_max3_f32 v29, v29, v223, v224
mvaac 40,248,40
v_max3_f32 v29, v29, v225, v226
v_max3_f32 v29, v29, v227, v228
mvaac 44,244,32
ra 244,25,4096
v_mov_b32 v30, v29
mvaac 44,248,44
wl 4
ra 248,25,5120
cv 64,192,193
mvaac 60,228,152
wl 4
ra 228,3,6144
cv 65,194,195
mvaac 60,232,156
wl 4
ra 232,3,7168
v_mov_b32 v171, 0
mvaac 36,236,48
wl 4
dm 1,12,25,0
mvaac 36,240,60
s_add_u32 m0, s22, 0x1000
s_add_u32 s24, s24, 0x6000
s_add_u32 s38, s66, s71
mvaac 40,236,52
s_add_u32 s22, s28, s23
v_permlane16_swap_b32 v29, v30
mvaac 40,240,64
mx 29,29,30
v_mov_b32 v30, v29
mvaac 44,236,56
ra 236,25,6144
cv 66,196,197
mvaac 44,240,68
wl 4
ra 240,25,7168
cv 67,198,199
mvaac 60,244,160
wl 4
ra 244,3,8192
cv 76,200,201
mvaac 60,248,164
wl 4
ra 248,3,9216
cv 77,202,203
mvaac 36,228,72
wl 4
v_permlane32_swap_b32 v29, v30
mvaac 36,232,84
mx 29,29,30
v_mul_f32 v31, s61, v29
mvaac 40,228,76
v_fma_f32 v216, v216, s32, v31
v_fma_f32 v217, v217, s32, v31
mvaac 40,232,88
dm 1,12,25,1024
mvaac 44,228,80
ra 228,25,8192
s_mov_b32 m0, s22
mvaac 44,232,92
wl 4
ra 232,25,9216
v_fma_f32 v218, v218, s32, v31
mvaac 60,236,168
wl 4
ra 236,3,10240
v_fma_f32 v219, v219, s32, v31
mvaac 60,240,172
wl 4
ra 240,3,11264
v_fma_f32 v220, v220, s32, v31
mvaac 36,244,96
wl 4
ex 216,216
mvaac 36,248,108
ex 217,217
mvaac 40,244,100
ex 218,218
mvaac 40,248,112
ex 219,219
mvaac 44,244,104
ra 244,25,10240
v_fma_f32 v221, v221, s32, v31
mvaac 44,248,116
wl 4
ra 248,25,11264
ad 250,216,217
mvaac 60,228,176
wl 4
ra 228,3,12288
v_fma_f32 v222, v222, s32, v31
mvaac 60,232,180
wl 4
ra 232,3,13312
ad 250,250,218
mvaac 36,236,120
wl 4
ex 220,220
mvaac 36,240,132
ex 221,221
mvaac 40,236,124
ex 222,222
mvaac 40,240,136
v_fma_f32 v223, v223, s32, v31
ad 250,250,219
mvaac 44,236,128
ra 236,3,14336
s_waitcnt vmcnt(7) lgkmcnt(3)
s_barrier
mvaac 44,240,140
ra 240,3,15360
v_fma_f32 v224, v224, s32, v31
mvaac 60,244,184
ra 244,3,16384
ad 250,250,220
mvaac 60,248,188
wl 4
ra 248,3,17408
v_fma_f32 v225, v225, s32, v31
mvaaz 48,228,0
wl 4
ex 223,223
mvaac 48,232,12
ex 224,224
mvaaz 52,228,4
dm 1,12,24,0
mvaac 52,232,16
s_mov_b32 m0, s22
ad 250,250,221
v_fma_f32 v226, v226, s32, v31
mvaaz 56,228,8
ra 228,3,18432
ad 250,250,222
mvaac 56,232,20
wl 4
ra 232,3,19456
v_fma_f32 v227, v227, s32, v31
mvaac 48,236,24
wl 4
ex 225,225
mvaac 48,240,36
ex 226,226
mvaac 52,236,28
v_fma_f32 v228, v228, s32, v31
ad 250,250,223
mvaac 52,240,40
ex 227,227
mvaac 56,236,32
ra 236,3,20480
ad 250,250,224
mvaac 56,240,44
wl 4
ra 240,3,21504
ad 250,250,225
mvaac 48,244,48
wl 4
ex 228,228
mvaac 48,248,60
dm 1,12,24,1024
mvaac 52,244,52
s_mov_b32 m0, s22
ad 250,250,226
mu 228,23,228
mvaac 52,248,64
ad 250,250,227
ad 250,250,228
mvaac 56,244,56
ra 244,3,22528
v_mov_b32 v32, v250
mvaac 56,248,68
wl 4
ra 248,3,23552
mu 216,8,216
mvaac 48,228,72
wl 4
v_permlane16_swap_b32 v250, v32
mvaac 48,232,84
ad 250,250,32
v_mov_b32 v32, v250
mvaac 52,228,76
v_permlane32_swap_b32 v250, v32
mvaac 52,232,88
ad 250,250,32
mu 217,9,217
mvaac 56,228,80
v_rcp_f32 v250, v250
mvaac 56,232,92
wl 3
mu 218,10,218
mu 219,11,219
mvaac 48,236,96
wl 2
dm 1,12,24,2048
mvaac 48,240,108
mu 220,12,220
mu 221,13,221
mvaac 52,236,100
mu 222,14,222
mu 223,15,223
mvaac 52,240,112
mu 216,250,216
mu 217,250,217
mvaac 56,236,104
mu 218,250,218
mu 219,250,219
mvaac 56,240,116
wl 1
mu 220,250,220
mu 221,250,221
mvaac 48,244,120
wl 0
mu 222,250,222
mu 223,250,223
mvaac 48,248,132
cv 164,216,217
cv 165,218,219
mvaac 52,244,124
cv 166,220,221
cv 167,222,223
mvaac 52,248,136
mu 224,16,224
mu 225,17,225
mvaac 56,244,128
mu 226,18,226
mu 227,19,227
mvaac 56,248,140
mu 224,250,224
mu 225,250,225
mvvvz 192,100,164
mu 226,250,226
mu 227,250,227
mvvvz 196,108,164
mu 228,250,228
cv 168,224,225
mvvvz 200,116,164
s_mov_b32 m0, s22
cv 169,226,227
v_cvt_pk_bf16_f32 v170, v228, 0
v_add_u32 v4, s30, v1
cv 78,204,205
mvvvc 192,104,168
ra 228,4,0
cv 79,206,207
mvvvc 196,112,168
ra 232,4,1024
cv 88,208,209
mvvvc 200,120,168
ra 236,4,2048
cv 89,210,211
mvvvz 204,124,164
ra 240,4,3072
cv 90,212,213
mvvvc 204,128,168
ra 244,4,4096
cv 91,214,215
mvvvz 208,132,164
ra 248,4,5120
dm 1,12,24,3072
mvvvc 208,136,168
mu 36,5,36
mu 37,5,37
mvvvz 212,140,164
mu 38,5,38
mu 39,5,39
mvvvc 212,144,168
wl 5
s_add_u32 s25, s24, 0x1000
cv 148,36,37
cv 149,38,39
mvaaz 36,228,0
wl 4
mu 40,6,40
mu 41,6,41
mvaac 36,232,12
wl 3
mu 42,6,42
mu 43,6,43
mvaac 36,236,24
cv 152,40,41
cv 153,42,43
mvaaz 40,228,4
mu 44,7,44
mu 45,7,45
mvaac 40,232,16
wl 2
mu 46,7,46
mu 47,7,47
mvaac 36,240,36
cv 156,44,45
cv 157,46,47
mvaaz 44,228,8
ra 228,4,6144
s_add_u32 m0, s22, 0x1000
mvaac 44,232,20
ra 232,4,7168
mu 48,5,48
mvaac 40,236,28
mu 49,5,49
mu 50,5,50
mvaac 40,240,40
mu 51,5,51
cv 150,48,49
mvaac 44,236,32
ra 236,4,8192
cv 151,50,51
mvaac 44,240,44
wl 4
ra 240,4,9216
mu 52,6,52
mvaac 36,244,48
wl 4
dm 1,12,25,0
mvaac 36,248,60
s_add_u32 m0, s22, 0x1000
s_add_u32 s24, s24, 0x6000
mu 53,6,53
mvaac 40,244,52
mu 54,6,54
mu 55,6,55
mvaac 40,248,64
cv 154,52,53
cv 155,54,55
mvaac 44,244,56
ra 244,4,10240
mu 56,7,56
mvaac 44,248,68
wl 4
ra 248,4,11264
mu 57,7,57
mvaac 36,228,72
wl 4
mu 58,7,58
mu 59,7,59
mvaac 36,232,84
cv 158,56,57
cv 159,58,59
mvaac 40,228,76
s_add_u32 s22, s29, s23
mu 60,24,60
mu 61,24,61
mvaac 40,232,88
dm 1,12,25,1024
mvaac 44,228,80
ra 228,4,12288
s_mov_b32 m0, s22
mvaac 44,232,92
ra 232,4,13312
wv 6
s_barrier
wl 5
mvaac 36,236,96
wl 4
s_add_u32 s25, s24, 0x1000
mu 62,24,62
mu 63,24,63
mvaac 36,240,108
s_mov_b64 exec, s[58:59]
ds_write_b64 v20, v[34:35] offset:520
s_mov_b64 exec, -1
mvaac 40,236,100
cv 34,60,61
cv 35,62,63
mvaac 40,240,112
v_add_u32 v33, s38, v22
v_add_u32 v2, s31, v1
mvaac 44,236,104
ra 236,4,14336
cv 68,232,233
mvaac 44,240,116
wl 5
ra 240,4,15360
cv 69,234,235
mvaac 36,244,120
wl 5
s_mov_b64 exec, s[56:57]
ds_write_b64 v33, v[34:35] offset:0
s_mov_b64 exec, -1
mvaac 36,248,132
cv 70,236,237
cv 71,238,239
mvaac 40,244,124
cv 80,240,241
cv 81,242,243
mvaac 40,248,136
mu 36,5,36
mu 37,5,37
mvaac 44,244,128
ra 244,4,16384
mu 38,5,38
mvaac 44,248,140
wl 6
ra 248,4,17408
mu 39,5,39
mvaaz 48,228,0
wl 6
mu 40,6,40
mu 41,6,41
mvaac 48,232,12
mu 42,6,42
mu 43,6,43
mvaaz 52,228,4
dm 1,12,24,0
mvaac 52,232,16
s_mov_b32 m0, s22
mu 44,7,44
mu 45,7,45
mvaaz 56,228,8
ra 228,4,18432
mu 46,7,46
mvaac 56,232,20
wl 5
ra 232,4,19456
mu 47,7,47
mvaac 48,236,24
wl 5
cv 82,244,245
cv 83,246,247
mvaac 48,240,36
cv 92,184,185
cv 93,186,187
mvaac 52,236,28
dm 1,12,24,1024
mvaac 52,240,40
s_mov_b32 m0, s22
cv 94,188,189
cv 95,190,191
mvaac 56,236,32
ra 236,4,20480
cv 72,192,193
mvaac 56,240,44
wl 4
ra 240,4,21504
cv 73,194,195
mvaac 48,244,48
wl 4
cv 74,196,197
cv 75,198,199
mvaac 48,248,60
cv 84,200,201
cv 85,202,203
mvaac 52,244,52
dm 1,12,24,2048
mvaac 52,248,64
s_mov_b32 m0, s22
cv 86,204,205
cv 87,206,207
mvaac 56,244,56
ra 244,4,22528
cv 96,208,209
mvaac 56,248,68
wl 4
ra 248,4,23552
cv 97,210,211
mvaac 48,228,72
wl 4
cv 98,212,213
cv 99,214,215
mvaac 48,232,84
cv 160,36,37
cv 161,38,39
mvaac 52,228,76
dm 1,12,24,3072
mvaac 52,232,88
s_add_u32 m0, s22, 0x1000
cv 164,40,41
cv 165,42,43
mvaac 56,228,80
ra 228,2,0
cv 168,44,45
mvaac 56,232,92
wl 4
ra 232,2,1024
cv 169,46,47
mvaac 48,236,96
wl 4
mvaac 48,240,108
mvaac 52,236,100
dm 1,12,25,0
mvaac 52,240,112
s_add_u32 m0, s22, 0x1000
s_add_u32 s24, s24, 0x6000
mvaac 56,236,104
ra 236,2,2048
mvaac 56,240,116
wl 4
ra 240,2,3072
mvaac 48,244,120
wl 4
mvaac 48,248,132
mvaac 52,244,124
dm 1,12,25,1024
mvaac 52,248,136
mvaac 56,244,128
mvaac 56,248,140
L_b2x:
wl 3
mvaaz 36,228,0
wl 2
ra 244,2,4096
s_cmp_ge_u32 s20, 2
mvaac 36,232,12
ra 248,2,5120
s_cselect_b32 s37, s31, s30
mvaaz 40,228,4
s_add_u32 s37, s37, s72
v_add_u32 v25, s37, v1
mu 48,5,48
mvaac 40,232,16
mu 49,5,49
mu 50,5,50
mvaaz 44,228,8
ra 228,25,0
mu 51,5,51
mvaac 44,232,20
wl 4
ra 232,25,1024
cv 162,48,49
mvaac 36,236,24
wl 4
cv 163,50,51
s_add_u32 s38, s67, s71
mvaac 36,240,36
s_mov_b32 s98, L_b1x_a-L_cp2
s_mov_b32 s99, L_b2x-L_b1x_a
s_mov_b32 s100, L_out-L_cp2
mvaac 40,236,28
s_mov_b32 s101, L_outl-L_out
s_cmp_eq_u32 s71, 0x240
s_cselect_b32 s98, s100, s98
mvaac 40,240,40
s_cselect_b32 s99, s101, s99
s_getpc_b64 s[96:97]
L_cp2:
s_ashr_i32 s100, s98, 31
mvaac 44,236,32
ra 236,2,6144
s_add_u32 s96, s96, s98
mvaac 44,240,44
wl 4
ra 240,2,7168
mu 52,6,52
mvaac 36,244,48
wl 4
mu 53,6,53
mu 54,6,54
mvaac 36,248,60
mu 55,6,55
s_addc_u32 s97, s97, s100
mvaac 40,244,52
cv 166,52,53
cv 167,54,55
mvaac 40,248,64
s_lshr_b32 s100, s2, 3
s_and_b32 s100, s100, 31
s_lshl_b32 s100, s100, 13
mvaac 44,244,56
ra 244,25,2048
s_add_u32 s101, s99, 0x1fff
mvaac 44,248,68
wl 4
ra 248,25,3072
s_and_b32 s101, s101, 0xffffe000
mvaaz 60,228,144
wl 4
ra 228,2,8192
s_lshl_b32 s98, s101, 3
mvaac 60,232,148
wl 4
ra 232,2,9216
s_cmp_ge_u32 s100, s98
mvaac 36,236,72
wl 4
mu 56,7,56
mu 57,7,57
mvaac 36,240,84
mu 58,7,58
mu 59,7,59
mvaac 40,236,76
s_cselect_b32 s98, s98, 0
cv 170,56,57
cv 171,58,59
mvaac 40,240,88
s_sub_u32 s100, s100, s98
s_lshl_b32 s98, s101, 2
s_cmp_ge_u32 s100, s98
mvaac 44,236,80
ra 236,25,4096
s_cselect_b32 s98, s98, 0
mvaac 44,240,92
wl 4
ra 240,25,5120
s_sub_u32 s100, s100, s98
mvaac 60,244,152
wl 4
ra 244,2,10240
s_lshl_b32 s98, s101, 1
mvaac 60,248,156
wl 4
ra 248,2,11264
s_cmp_ge_u32 s100, s98
mvaac 36,228,96
wl 4
s_cselect_b32 s98, s98, 0
s_sub_u32 s100, s100, s98
s_lshl_b32 s98, s101, 0
mvaac 36,232,108
s_cmp_ge_u32 s100, s98
s_cselect_b32 s98, s98, 0
s_sub_u32 s100, s100, s98
mvaac 40,228,100
s_sub_u32 s99, s99, 4
s_add_u32 s22, s30, s23
s_mov_b32 m0, s22
mvaac 40,232,112
v_add_u32 v3, s28, v1
s_add_u32 s25, s24, 0x1000
mvaac 44,228,104
ra 228,25,6144
v_add_u32 v33, s38, v22
mvaac 44,232,116
wl 4
ra 232,25,7168
s_mul_i32 s86, s34, 0x300
mvaac 60,236,160
wl 4
ra 236,25,8192
v_mov_b32 v253, 0x80000000
mvaac 60,240,164
wl 4
ra 240,25,9216
v_add_u32 v4, s29, v1
mvaac 36,244,120
wl 4
v_add_u32 v252, s71, v20
v_mov_b32 v139, 0
mvaac 36,248,132
v_mov_b32 v147, 0
mvaac 40,244,124
mvaac 40,248,136
mu 36,5,36
mu 37,5,37
mvaac 44,244,128
ra 244,25,10240
mu 38,5,38
mvaac 44,248,140
wl 4
ra 248,25,11264
mu 39,5,39
mvaac 60,228,168
wl 4
ra 228,2,12288
cv 100,36,37
mvaac 60,232,172
wl 4
ra 232,2,13312
cv 101,38,39
mvaac 60,236,176
wl 4
ra 236,2,14336
mu 40,6,40
mvaac 60,240,180
ra 240,2,15360
mu 41,6,41
mu 42,6,42
mu 43,6,43
cv 112,40,41
cv 113,42,43
mu 44,7,44
wl 5
mvaac 60,244,184
wl 4
ra 244,2,16384
mu 45,7,45
mvaac 60,248,188
ra 248,2,17408
wv 6
s_barrier
wl 5
mvaaz 48,228,0
wl 4
mu 46,7,46
mu 47,7,47
mvaac 48,232,12
mu 60,24,60
mu 61,24,61
mvaaz 52,228,4
cv 34,60,61
v_lshlrev_b32 v61, 7, v0
mvaac 52,232,16
mu 62,24,62
mu 63,24,63
mvaaz 56,228,8
ra 228,2,18432
v_add_u32 v61, s100, v61
mvaac 56,232,20
wl 4
ra 232,2,19456
cv 35,62,63
mvaac 48,236,24
wl 4
v_min_u32 v61, s99, v61
v_add_co_u32 v62, vcc, s96, v61
mvaac 48,240,36
v_mov_b32 v63, s97
v_addc_co_u32 v63, vcc, 0, v63, vcc
mvaac 52,236,28
global_load_dword a254, v[62:63], off
mvaac 52,240,40
dm 1,12,24,0
mvaac 56,236,32
ra 236,2,20480
s_mov_b32 m0, s22
mvaac 56,240,44
wl 4
ra 240,2,21504
cv 124,44,45
mvaac 48,244,48
wl 4
cv 125,46,47
mvaac 48,248,60
dm 1,12,24,1024
mvaac 52,244,52
s_mov_b32 m0, s22
mvaac 52,248,64
s_mov_b64 exec, s[56:57]
ds_write_b64 v33, v[34:35] offset:0
s_mov_b64 exec, -1
mvaac 56,244,56
ra 244,2,22528
mvaac 56,248,68
wl 5
ra 248,2,23552
v_add_u32 v2, s30, v1
mvaac 48,228,72
wl 5
mvaac 48,232,84
mvaac 52,228,76
mvaac 52,232,88
mvaac 56,228,80
ra 228,3,0
mvaac 56,232,92
wl 5
ra 232,3,1024
mvaac 48,236,96
wl 5
dm 1,12,24,2048
mvaac 48,240,108
s_mov_b32 m0, s22
mvaac 52,236,100
mvaac 52,240,112
mvaac 56,236,104
ra 236,3,2048
mvaac 56,240,116
wl 4
ra 240,3,3072
mvaac 48,244,120
wl 4
mvaac 48,248,132
mvaac 52,244,124
mvaac 52,248,136
mu 48,5,48
mu 49,5,49
mvaac 56,244,128
ra 244,3,4096
mu 50,5,50
mvaac 56,248,140
wl 4
ra 248,3,5120
mu 51,5,51
mvaaz 36,228,0
wl 4
dm 1,12,24,3072
mvaac 36,232,12
s_add_u32 m0, s22, 0x1000
cv 102,48,49
cv 103,50,51
mvaaz 40,228,4
mu 52,6,52
mu 53,6,53
mvaac 40,232,16
mu 54,6,54
mu 55,6,55
mvaaz 44,228,8
ra 228,3,6144
cv 114,52,53
mvaac 44,232,20
wl 4
ra 232,3,7168
cv 115,54,55
mvaac 36,236,24
wl 4
mu 56,7,56
mu 57,7,57
mvaac 36,240,36
mu 58,7,58
mu 59,7,59
mvaac 40,236,28
cv 126,56,57
cv 127,58,59
mvaac 40,240,40
mvaac 44,236,32
ra 236,3,8192
mvaac 44,240,44
wl 4
ra 240,3,9216
mvaac 36,244,48
wl 4
dm 1,12,25,0
mvaac 36,248,60
s_add_u32 m0, s22, 0x1000
s_add_u32 s24, s24, 0x6000
s_lshr_b32 s83, s71, 6
mvaac 40,244,52
s_mul_i32 s83, s83, 0x56
s_lshr_b32 s83, s83, 8
s_add_u32 s84, s33, 13
mvaac 40,248,64
s_mul_i32 s85, s84, 0x46e00
s_add_u32 s85, s85, s86
s_mul_i32 s79, s83, 6
mvaac 44,244,56
ra 244,3,10240
s_sub_u32 s87, s85, 0x300
mvaac 44,248,68
wl 4
ra 248,3,11264
s_add_u32 s83, s79, 0
mvaac 36,228,72
wl 4
s_and_b32 s84, s83, 3
s_lshl_b32 s83, s83, 6
v_add_u32 v33, s83, v0
mvaac 36,232,84
s_cmp_eq_u32 s84, s20
v_mul_u32_u24 v34, 0x2ab, v33
s_cselect_b32 s85, 0x17a, 0
mvaac 40,228,76
v_lshrrev_b32 v34, 16, v34
s_cmp_eq_u32 s21, 2
mvaac 40,232,88
dm 1,12,25,1024
mvaac 44,228,80
ra 228,3,12288
v_mul_u32_u24 v35, 0x60, v34
mvaac 44,232,92
wl 4
ra 232,3,13312
s_cselect_b32 s85, 0, s85
mvaac 36,236,96
wl 4
v_sub_u32 v35, v33, v35
s_mov_b32 s86, 0x46e00
mvaac 36,240,108
v_mul_lo_u32 v33, v34, s86
s_add_u32 s84, s33, 13
mvaac 40,236,100
v_add_u32 v34, s84, v34
v_cmp_gt_u32 vcc, s85, v34
mvaac 40,240,112
v_lshl_add_u32 v33, v35, 7, v33
v_add_u32 v33, s87, v33
mvaac 44,236,104
ra 236,3,14336
v_cndmask_b32 v33, v253, v33, vcc
mvaac 44,240,116
wl 4
ra 240,3,15360
s_add_u32 s22, s31, s23
mvaac 36,244,120
wl 4
buffer_load_dword a252, v33, s[8:11], 0 offen offset:0
mvaac 36,248,132
s_mov_b32 m0, s22
wv 8
s_barrier
s_cmp_ge_u32 s20, 2
mvaac 40,244,124
s_cselect_b32 s37, s29, s28
s_add_u32 s37, s37, s72
v_add_u32 v25, s37, v1
mvaac 40,248,136
mu 36,5,36
mu 37,5,37
mvaac 44,244,128
ra 244,3,16384
mu 38,5,38
mvaac 44,248,140
wl 4
ra 248,3,17408
mu 39,5,39
mvaaz 48,228,0
wl 4
cv 104,36,37
cv 105,38,39
mvaac 48,232,12
mu 40,6,40
mu 41,6,41
mvaaz 52,228,4
dm 1,12,24,0
mvaac 52,232,16
s_mov_b32 m0, s22
mu 42,6,42
mu 43,6,43
mvaaz 56,228,8
ra 228,3,18432
cv 116,40,41
mvaac 56,232,20
wl 4
ra 232,3,19456
cv 117,42,43
mvaac 48,236,24
wl 4
mu 44,7,44
mu 45,7,45
mvaac 48,240,36
mu 46,7,46
mu 47,7,47
mvaac 52,236,28
cv 128,44,45
cv 129,46,47
mvaac 52,240,40
s_add_u32 s25, s24, 0x1000
s_mov_b32 s86, 0x46e00
v_mov_b32 v253, 0x80000000
mvaac 56,236,32
ra 236,3,20480
mvaac 56,240,44
wl 4
ra 240,3,21504
mvaac 48,244,48
wl 4
mvaac 48,248,60
dm 1,12,24,1024
mvaac 52,244,52
s_mov_b32 m0, s22
mvaac 52,248,64
mvaac 56,244,56
ra 244,3,22528
mvaac 56,248,68
wl 4
ra 248,3,23552
v_add_u32 v3, s31, v1
mvaac 48,228,72
wl 4
mvaac 48,232,84
mvaac 52,228,76
mvaac 52,232,88
mvaac 56,228,80
ra 228,4,0
mvaac 56,232,92
wl 4
ra 232,4,1024
mvaac 48,236,96
wl 4
dm 1,12,24,2048
mvaac 48,240,108
s_mov_b32 m0, s22
mvaac 52,236,100
mvaac 52,240,112
mvaac 56,236,104
ra 236,25,0
mvaac 56,240,116
wl 4
ra 240,25,1024
mvaac 48,244,120
wl 4
mvaac 48,248,132
mvaac 52,244,124
mvaac 52,248,136
mu 48,5,48
mu 49,5,49
mvaac 56,244,128
ra 244,4,2048
mu 50,5,50
mvaac 56,248,140
wl 4
ra 248,4,3072
mu 51,5,51
mvaaz 36,228,0
wl 4
dm 1,12,24,3072
mvaac 36,232,12
s_add_u32 m0, s22, 0x1000
cv 106,48,49
cv 107,50,51
mvaaz 40,228,4
mu 52,6,52
mu 53,6,53
mvaac 40,232,16
mu 54,6,54
mu 55,6,55
mvaaz 44,228,8
ra 228,25,2048
cv 118,52,53
mvaac 44,232,20
wl 4
ra 232,25,3072
cv 119,54,55
mvaaz 60,236,144
wl 4
ra 236,4,4096
mu 56,7,56
mvaac 60,240,148
wl 4
ra 240,4,5120
mu 57,7,57
mvaac 36,244,24
wl 4
mu 58,7,58
mu 59,7,59
mvaac 36,248,36
cv 130,56,57
cv 131,58,59
mvaac 40,244,28
mvaac 40,248,40
mvaac 44,244,32
ra 244,25,4096
mvaac 44,248,44
wl 4
ra 248,25,5120
mvaac 60,228,152
wl 4
ra 228,4,6144
mvaac 60,232,156
wl 4
ra 232,4,7168
mvaac 36,236,48
wl 4
dm 1,12,25,0
mvaac 36,240,60
s_add_u32 m0, s22, 0x1000
s_add_u32 s24, s24, 0x6000
s_add_u32 s83, s79, 1
mvaac 40,236,52
s_and_b32 s84, s83, 3
s_lshl_b32 s83, s83, 6
v_add_u32 v33, s83, v0
mvaac 40,240,64
s_cmp_eq_u32 s84, s20
v_mul_u32_u24 v34, 0x2ab, v33
s_cselect_b32 s85, 0x17a, 0
mvaac 44,236,56
ra 236,25,6144
v_lshrrev_b32 v34, 16, v34
mvaac 44,240,68
wl 4
ra 240,25,7168
s_cmp_eq_u32 s21, 2
mvaac 60,244,160
wl 4
ra 244,4,8192
v_mul_u32_u24 v35, 0x60, v34
mvaac 60,248,164
wl 4
ra 248,4,9216
s_cselect_b32 s85, 0, s85
mvaac 36,228,72
wl 4
v_sub_u32 v35, v33, v35
v_mul_lo_u32 v33, v34, s86
mvaac 36,232,84
s_add_u32 s84, s33, 13
v_add_u32 v34, s84, v34
v_cmp_gt_u32 vcc, s85, v34
mvaac 40,228,76
v_lshl_add_u32 v33, v35, 7, v33
v_add_u32 v33, s87, v33
mvaac 40,232,88
dm 1,12,25,1024
mvaac 44,228,80
ra 228,25,8192
v_cndmask_b32 v33, v253, v33, vcc
mvaac 44,232,92
wl 4
ra 232,25,9216
s_add_u32 s38, s68, s71
mvaac 60,236,168
wl 4
ra 236,4,10240
s_add_u32 s22, s28, s23
mvaac 60,240,172
wl 4
ra 240,4,11264
s_mov_b32 m0, s22
mvaac 36,244,96
wl 4
buffer_load_dword a253, v33, s[8:11], 0 offen offset:0
mvaac 36,248,108
v_add_u32 v33, s38, v22
s_add_u32 s25, s24, 0x1000
mvaac 40,244,100
s_mov_b32 s86, 0x46e00
v_mov_b32 v253, 0x80000000
mvaac 40,248,112
mvaac 44,244,104
ra 244,25,10240
mvaac 44,248,116
wl 4
ra 248,25,11264
mvaac 60,228,176
wl 4
ra 228,4,12288
mvaac 60,232,180
wl 4
ra 232,4,13312
mvaac 36,236,120
wl 4
mvaac 36,240,132
mvaac 40,236,124
mvaac 40,240,136
mu 36,5,36
mu 37,5,37
mvaac 44,236,128
ra 236,4,14336
mu 38,5,38
mvaac 44,240,140
wl 4
ra 240,4,15360
mu 39,5,39
mvaac 60,244,184
wl 4
ra 244,4,16384
cv 108,36,37
mvaac 60,248,188
wl 4
ra 248,4,17408
mu 44,7,44
mvaaz 48,228,0
wl 4
mu 45,7,45
mu 46,7,46
mvaac 48,232,12
mu 60,24,60
mu 61,24,61
mvaaz 52,228,4
mu 62,24,62
mu 63,24,63
mvaac 52,232,16
cv 34,60,61
cv 35,62,63
mvaaz 56,228,8
ra 228,4,18432
mu 47,7,47
mvaac 56,232,20
wl 4
ra 232,4,19456
cv 132,44,45
mvaac 48,236,24
wl 4
s_mov_b64 exec, s[56:57]
ds_write_b64 v33, v[34:35] offset:0
s_mov_b64 exec, -1
mvaac 48,240,36
cv 133,46,47
cv 109,38,39
mvaac 52,236,28
s_waitcnt vmcnt(8) lgkmcnt(0)
s_barrier
dm 1,12,24,0
mvaac 52,240,40
s_mov_b32 m0, s22
rv 184,252,768
mu 40,6,40
mvaac 56,236,32
ra 236,4,20480
mu 41,6,41
mvaac 56,240,44
ra 240,4,21504
mu 42,6,42
mvaac 48,244,48
rv 200,252,0
mu 43,6,43
mvaac 48,248,60
dm 1,12,24,1024
mvaac 52,244,52
rv 188,252,832
s_mov_b32 m0, s22
mvaac 52,248,64
rv 204,252,64
cv 120,40,41
mvaac 56,244,56
ra 244,4,22528
cv 121,42,43
mvaac 56,248,68
ra 248,4,23552
v_add_u32 v4, s28, v1
mvaac 48,228,72
rv 192,252,896
mvaac 48,232,84
rv 208,252,128
mvaac 52,228,76
mvaac 52,232,88
mvaac 56,228,80
ra 228,2,0
mvaac 56,232,92
wl 9
ra 232,2,1024
mvaac 48,236,96
wl 9
dm 1,12,24,2048
mvaac 48,240,108
s_mov_b32 m0, s22
mvaac 52,236,100
mvaac 52,240,112
mvaac 56,236,104
ra 236,2,2048
mvaac 56,240,116
wl 6
ra 240,2,3072
mvaac 48,244,120
wl 6
mvaac 48,248,132
mvaac 52,244,124
mvaac 52,248,136
mu 48,5,48
mu 49,5,49
mvaac 56,244,128
ra 244,2,4096
mu 50,5,50
mvaac 56,248,140
ra 248,2,5120
mu 51,5,51
mvvvz 244,184,200
dm 1,12,24,3072
mvvvc 244,188,204
wl 6
mu 56,7,56
mu 57,7,57
mvvvc 244,192,208
mu 58,7,58
mu 59,7,59
mvvvz 228,184,124
cv 134,56,57
cv 135,58,59
mvvvc 228,188,128
cv 110,48,49
cv 111,50,51
mvvvc 228,192,132
mu 52,6,52
mu 53,6,53
mvvvz 232,172,200
mu 54,6,54
mu 55,6,55
mvvvc 232,148,204
cv 122,52,53
cv 123,54,55
mvvvc 232,160,208
s_add_u32 m0, s22, 0x1000
mvvvz 236,176,200
mvvvc 236,152,204
v_max3_f32 v26, v232, v233, v234
mvvvc 236,164,208
mvvvz 240,180,200
mvvvc 240,156,204
v_max3_f32 v26, v26, v235, v236
v_max3_f32 v26, v26, v237, v238
mvvvc 240,168,208
mvvvz 196,184,100
mvvvc 196,188,104
v_max3_f32 v26, v26, v239, v240
v_max3_f32 v26, v26, v241, v242
mvvvc 196,192,108
v_max3_f32 v26, v26, v243, v244
v_mov_b32 v27, v26
mvvvz 212,184,112
v_permlane16_swap_b32 v26, v27
mvvvc 212,188,116
mx 26,26,27
v_mov_b32 v27, v26
mvvvc 212,192,120
v_permlane32_swap_b32 v26, v27
mvvvz 216,172,124
mx 26,26,27
v_mul_f32 v28, s61, v26
mvvvc 216,148,128
v_fma_f32 v232, v232, s32, v28
v_fma_f32 v233, v233, s32, v28
mvvvc 216,160,132
ex 232,232
mvvvz 220,176,124
ex 233,233
mvvvc 220,152,128
v_fma_f32 v234, v234, s32, v28
v_fma_f32 v235, v235, s32, v28
mvvvc 220,164,132
ex 234,234
mvvvz 224,180,124
ex 235,235
mvvvc 224,156,128
v_fma_f32 v236, v236, s32, v28
v_fma_f32 v237, v237, s32, v28
mvvvc 224,168,132
ex 236,236
mvvvz 184,172,100
ad 251,232,233
v_fma_f32 v238, v238, s32, v28
mvvvc 184,148,104
ex 237,237
mvvvc 184,160,108
ad 251,251,234
v_fma_f32 v239, v239, s32, v28
mvvvz 188,176,100
ex 238,238
mvvvc 188,152,104
v_max3_f32 v29, v184, v185, v186
ad 251,251,235
mvvvc 188,164,108
ex 239,239
mvvvz 192,180,100
v_fma_f32 v240, v240, s32, v28
ad 251,251,236
mvvvc 192,156,104
v_max3_f32 v29, v29, v187, v188
v_max3_f32 v29, v29, v189, v190
mvvvc 192,168,108
ex 240,240
mvvvz 200,172,112
v_fma_f32 v241, v241, s32, v28
ad 251,251,237
mvvvc 200,148,116
v_max3_f32 v29, v29, v191, v192
v_max3_f32 v29, v29, v193, v194
mvvvc 200,160,120
v_max3_f32 v29, v29, v195, v196
v_mov_b32 v30, v29
mvvvz 204,176,112
v_permlane16_swap_b32 v29, v30
mvvvc 204,152,116
mx 29,29,30
v_mov_b32 v30, v29
mvvvc 204,164,120
v_permlane32_swap_b32 v29, v30
mvvvz 208,180,112
ex 241,241
mvvvc 208,156,116
v_fma_f32 v242, v242, s32, v28
ad 251,251,238
mvvvc 208,168,120
wl 5
ex 242,242
mvaaz 36,0,228
wl 4
v_fma_f32 v243, v243, s32, v28
v_fma_f32 v244, v244, s32, v28
mvaac 36,12,232
ad 251,251,239
mx 29,29,30
mvaaz 40,4,228
ex 243,243
mvaac 40,16,232
ex 244,244
mvaaz 44,8,228
ra 228,2,6144
ad 251,251,240
mvaac 44,20,232
wl 4
ra 232,2,7168
v_mul_f32 v31, s61, v29
mvaac 36,24,236
wl 4
ad 251,251,241
v_fma_f32 v184, v184, s32, v31
mvaac 36,36,240
v_fma_f32 v185, v185, s32, v31
ad 251,251,242
mvaac 40,28,236
ex 184,184
mvaac 40,40,240
ex 185,185
mvaac 44,32,236
ra 236,2,8192
v_fma_f32 v186, v186, s32, v31
mvaac 44,44,240
wl 4
ra 240,2,9216
mu 244,23,244
mvaac 36,48,244
wl 4
dm 1,12,25,0
mvaac 36,60,248
s_add_u32 m0, s22, 0x1000
s_add_u32 s24, s24, 0x6000
s_add_u32 s83, s79, 2
mvaac 40,52,244
s_and_b32 s84, s83, 3
s_lshl_b32 s83, s83, 6
v_add_u32 v33, s83, v0
mvaac 40,64,248
s_cmp_eq_u32 s84, s20
v_mul_u32_u24 v34, 0x2ab, v33
s_cselect_b32 s85, 0x17a, 0
mvaac 44,56,244
ra 244,2,10240
v_lshrrev_b32 v34, 16, v34
mvaac 44,68,248
wl 4
ra 248,2,11264
s_cmp_eq_u32 s21, 2
mvaac 36,72,228
wl 4
v_mul_u32_u24 v35, 0x60, v34
s_cselect_b32 s85, 0, s85
mvaac 36,84,232
v_sub_u32 v35, v33, v35
v_mul_lo_u32 v33, v34, s86
mvaac 40,76,228
s_add_u32 s84, s33, 13
v_add_u32 v34, s84, v34
v_cmp_gt_u32 vcc, s85, v34
mvaac 40,88,232
dm 1,12,25,1024
mvaac 44,80,228
ra 228,2,12288
v_lshl_add_u32 v33, v35, 7, v33
mvaac 44,92,232
wl 4
ra 232,2,13312
v_add_u32 v33, s87, v33
mvaac 36,96,236
wl 4
v_cndmask_b32 v33, v253, v33, vcc
s_add_u32 s22, s29, s23
mvaac 36,108,240
wv 13
buffer_load_dword a252, v33, s[8:11], 0 offen offset:0
mvaac 40,100,236
s_mov_b32 m0, s22
wv 8
s_barrier
s_cmp_ge_u32 s20, 2
mvaac 40,112,240
s_cselect_b32 s37, s31, s30
s_add_u32 s37, s37, s72
v_add_u32 v25, s37, v1
mvaac 44,104,236
ra 236,2,14336
s_add_u32 s25, s24, 0x1000
mvaac 44,116,240
wl 4
ra 240,2,15360
s_mov_b32 s86, 0x46e00
mvaac 36,120,244
wl 4
v_mov_b32 v253, 0x80000000
ad 251,251,243
mvaac 36,132,248
ex 186,186
mvaac 40,124,244
v_fma_f32 v187, v187, s32, v31
ad 251,251,244
mvaac 40,136,248
cv 100,36,37
cv 101,38,39
mvaac 44,128,244
ra 244,2,16384
v_fma_f32 v188, v188, s32, v31
mvaac 44,140,248
wl 4
ra 248,2,17408
cv 102,40,41
mvaaz 48,0,228
wl 4
cv 103,42,43
v_mov_b32 v32, v251
mvaac 48,12,232
cv 104,44,45
cv 105,46,47
mvaaz 52,4,228
dm 1,12,24,0
mvaac 52,16,232
s_mov_b32 m0, s22
ex 187,187
mvaaz 56,8,228
ra 228,2,18432
v_fma_f32 v189, v189, s32, v31
mvaac 56,20,232
wl 4
ra 232,2,19456
ad 248,184,185
mvaac 48,24,236
wl 4
ex 188,188
mvaac 48,36,240
ex 189,189
mvaac 52,28,236
v_fma_f32 v190, v190, s32, v31
ad 248,248,186
mvaac 52,40,240
ex 190,190
mvaac 56,32,236
ra 236,2,20480
v_fma_f32 v191, v191, s32, v31
mvaac 56,44,240
wl 4
ra 240,2,21504
ad 248,248,187
mvaac 48,48,244
wl 4
v_permlane16_swap_b32 v251, v32
mvaac 48,60,248
dm 1,12,24,1024
mvaac 52,52,244
s_mov_b32 m0, s22
ex 191,191
mvaac 52,64,248
v_fma_f32 v192, v192, s32, v31
ad 248,248,188
mvaac 56,56,244
ra 244,2,22528
v_fma_f32 v193, v193, s32, v31
mvaac 56,68,248
wl 4
ra 248,2,23552
ad 248,248,189
mvaac 48,72,228
wl 4
ex 192,192
mvaac 48,84,232
ad 251,251,32
v_fma_f32 v194, v194, s32, v31
mvaac 52,76,228
ex 193,193
mvaac 52,88,232
ad 248,248,190
v_mov_b32 v32, v251
mvaac 56,80,228
ra 228,3,0
v_fma_f32 v195, v195, s32, v31
mvaac 56,92,232
wl 4
ra 232,3,1024
v_fma_f32 v196, v196, s32, v31
mvaac 48,96,236
wl 4
dm 1,12,24,2048
mvaac 48,108,240
s_mov_b32 m0, s22
ex 194,194
mvaac 52,100,236
ad 248,248,191
ad 248,248,192
mvaac 52,112,240
ex 195,195
mvaac 56,104,236
ra 236,25,0
ad 248,248,193
mvaac 56,116,240
wl 4
ra 240,25,1024
ad 248,248,194
mvaac 48,120,244
wl 4
ex 196,196
mvaac 48,132,248
v_permlane32_swap_b32 v251, v32
mvaac 52,124,244
mu 196,23,196
ad 248,248,195
mvaac 52,136,248
cv 108,48,49
cv 109,50,51
mvaac 56,128,244
ra 244,3,2048
ad 251,251,32
mvaac 56,140,248
wl 4
ra 248,3,3072
cv 110,52,53
mvaaz 36,0,228
wl 4
dm 1,12,24,3072
mvaac 36,12,232
s_add_u32 m0, s22, 0x1000
cv 111,54,55
cv 112,56,57
mvaaz 40,4,228
cv 113,58,59
ad 248,248,196
mvaac 40,16,232
v_mov_b32 v32, v248
mu 232,8,232
mvaaz 44,8,228
ra 228,25,2048
mu 233,9,233
mvaac 44,20,232
wl 4
ra 232,25,3072
mu 234,10,234
mvaaz 60,236,144
wl 4
ra 236,3,4096
mu 235,11,235
mvaac 60,240,148
wl 4
ra 240,3,5120
mu 236,12,236
mvaac 36,24,244
wl 4
v_permlane16_swap_b32 v248, v32
mvaac 36,36,248
ad 248,248,32
v_mov_b32 v32, v248
mvaac 40,28,244
v_permlane32_swap_b32 v248, v32
mvaac 40,40,248
ad 248,248,32
mu 237,13,237
mvaac 44,32,244
ra 244,25,4096
mu 238,14,238
mvaac 44,44,248
wl 4
ra 248,25,5120
mu 239,15,239
mvaac 60,228,152
wl 4
ra 228,3,6144
mu 240,16,240
mvaac 60,232,156
wl 4
ra 232,3,7168
mu 241,17,241
mvaac 36,48,236
wl 4
dm 1,12,25,0
mvaac 36,60,240
s_add_u32 m0, s22, 0x1000
s_add_u32 s24, s24, 0x6000
s_add_u32 s83, s79, 3
mvaac 40,52,236
s_and_b32 s84, s83, 3
s_lshl_b32 s83, s83, 6
v_add_u32 v33, s83, v0
mvaac 40,64,240
s_cmp_eq_u32 s84, s20
v_mul_u32_u24 v34, 0x2ab, v33
s_cselect_b32 s85, 0x17a, 0
mvaac 44,56,236
ra 236,25,6144
v_lshrrev_b32 v34, 16, v34
mvaac 44,68,240
wl 4
ra 240,25,7168
s_cmp_eq_u32 s21, 2
mvaac 60,244,160
wl 4
ra 244,3,8192
v_mul_u32_u24 v35, 0x60, v34
mvaac 60,248,164
wl 4
ra 248,3,9216
s_cselect_b32 s85, 0, s85
mvaac 36,72,228
wl 4
v_sub_u32 v35, v33, v35
v_mul_lo_u32 v33, v34, s86
mvaac 36,84,232
s_add_u32 s84, s33, 13
v_add_u32 v34, s84, v34
v_cmp_gt_u32 vcc, s85, v34
mvaac 40,76,228
v_lshl_add_u32 v33, v35, 7, v33
v_add_u32 v33, s87, v33
mvaac 40,88,232
dm 1,12,25,1024
mvaac 44,80,228
ra 228,25,8192
v_cndmask_b32 v33, v253, v33, vcc
mvaac 44,92,232
wl 4
ra 232,25,9216
s_add_u32 s38, s69, s71
mvaac 60,236,168
wl 4
ra 236,3,10240
s_add_u32 s22, s30, s23
mvaac 60,240,172
wl 4
ra 240,3,11264
s_mov_b32 m0, s22
mvaac 36,96,244
s_waitcnt vmcnt(13) lgkmcnt(4)
buffer_load_dword a253, v33, s[8:11], 0 offen offset:0
mvaac 36,108,248
s_add_u32 s37, s28, s72
s_add_u32 s25, s24, 0x1000
v_add_u32 v33, s38, v22
mvaac 40,100,244
s_mov_b32 s86, 0x46e00
v_mov_b32 v253, 0x80000000
mu 242,18,242
mvaac 40,112,248
v_rcp_f32 v251, v251
mvaac 44,104,244
ra 244,25,10240
mu 243,19,243
mvaac 44,116,248
wl 4
ra 248,25,11264
v_add_u32 v25, s37, v1
mvaac 60,228,176
wl 4
ra 228,3,12288
mu 184,8,184
mvaac 60,232,180
wl 4
ra 232,3,13312
mu 185,9,185
mvaac 36,120,236
wl 4
v_rcp_f32 v248, v248
mvaac 36,132,240
mu 186,10,186
mu 187,11,187
mvaac 40,124,236
mu 188,12,188
mu 189,13,189
mvaac 40,136,240
cv 116,36,37
cv 117,38,39
mvaac 44,128,236
ra 236,3,14336
s_waitcnt vmcnt(8) lgkmcnt(3)
s_barrier
mvaac 44,140,240
ra 240,3,15360
cv 118,40,41
mvaac 60,244,184
ra 244,3,16384
cv 119,42,43
mvaac 60,248,188
wl 4
ra 248,3,17408
cv 120,44,45
mvaaz 48,0,228
wl 4
cv 121,46,47
mu 190,14,190
mvaac 48,12,232
mu 60,24,60
mu 61,24,61
mvaaz 52,4,228
dm 1,12,24,0
mvaac 52,16,232
s_mov_b32 m0, s22
mu 62,24,62
mu 63,24,63
mvaaz 56,8,228
ra 228,3,18432
cv 34,60,61
mvaac 56,20,232
wl 4
ra 232,3,19456
cv 35,62,63
mvaac 48,24,236
wl 4
s_mov_b64 exec, s[56:57]
ds_write_b64 v33, v[34:35] offset:0
s_mov_b64 exec, -1
mvaac 48,36,240
mu 191,15,191
mu 192,16,192
mvaac 52,28,236
mu 193,17,193
mu 194,18,194
mvaac 52,40,240
mu 195,19,195
mu 232,251,232
mvaac 56,32,236
ra 236,3,20480
mu 233,251,233
mvaac 56,44,240
wl 5
ra 240,3,21504
mu 234,251,234
mvaac 48,48,244
wl 5
mu 235,251,235
mu 236,251,236
mvaac 48,60,248
dm 1,12,24,1024
mvaac 52,52,244
s_mov_b32 m0, s22
mu 237,251,237
mu 238,251,238
mvaac 52,64,248
mu 239,251,239
mu 240,251,240
mvaac 56,56,244
ra 244,3,22528
mu 241,251,241
mvaac 56,68,248
wl 5
ra 248,3,23552
mu 242,251,242
mvaac 48,72,228
wl 5
mu 243,251,243
mu 244,251,244
mvaac 48,84,232
mu 184,248,184
mu 185,248,185
mvaac 52,76,228
mu 186,248,186
mu 187,248,187
mvaac 52,88,232
mu 188,248,188
mu 189,248,189
mvaac 56,80,228
ra 228,4,0
mu 190,248,190
mvaac 56,92,232
wl 4
ra 232,4,1024
mu 191,248,191
mvaac 48,96,236
wl 4
dm 1,12,24,2048
mvaac 48,108,240
s_mov_b32 m0, s22
mu 192,248,192
mu 193,248,193
mvaac 52,100,236
mu 194,248,194
mu 195,248,195
mvaac 52,112,240
mu 196,248,196
v_add_u32 v2, s29, v1
mvaac 56,104,236
ra 236,25,0
cv 172,232,233
mvaac 56,116,240
wl 4
ra 240,25,1024
cv 173,234,235
mvaac 48,120,244
wl 4
cv 174,236,237
cv 175,238,239
mvaac 48,132,248
cv 176,240,241
cv 177,242,243
mvaac 52,124,244
v_cvt_pk_bf16_f32 v178, v244, 0
v_mov_b32 v179, 0
mvaac 52,136,248
cv 124,48,49
cv 125,50,51
mvaac 56,128,244
ra 244,4,2048
cv 148,184,185
mvaac 56,140,248
wl 4
ra 248,4,3072
cv 126,52,53
mvaaz 36,0,228
wl 4
dm 1,12,24,3072
mvaac 36,12,232
s_add_u32 m0, s22, 0x1000
cv 127,54,55
cv 128,56,57
mvaaz 40,4,228
cv 129,58,59
cv 149,186,187
mvaac 40,16,232
cv 150,188,189
cv 151,190,191
mvaaz 44,8,228
ra 228,25,2048
cv 152,192,193
mvaac 44,20,232
wl 4
ra 232,25,3072
cv 153,194,195
mvaaz 60,236,144
wl 4
ra 236,4,4096
v_cvt_pk_bf16_f32 v154, v196, 0
mvaac 60,240,148
wl 4
ra 240,4,5120
v_mov_b32 v155, 0
mvaac 36,24,244
wl 4
mvaac 36,36,248
mvaac 40,28,244
mvaac 40,40,248
mvaac 44,32,244
ra 244,25,4096
mvaac 44,44,248
wl 4
ra 248,25,5120
mvaac 60,228,152
wl 4
ra 228,4,6144
mvaac 60,232,156
wl 4
ra 232,4,7168
mvaac 36,48,236
wl 4
dm 1,12,25,0
mvaac 36,60,240
s_add_u32 m0, s22, 0x1000
s_add_u32 s24, s24, 0x6000
s_add_u32 s83, s79, 4
mvaac 40,52,236
s_and_b32 s84, s83, 3
s_lshl_b32 s83, s83, 6
v_add_u32 v33, s83, v0
mvaac 40,64,240
s_cmp_eq_u32 s84, s20
v_mul_u32_u24 v34, 0x2ab, v33
s_cselect_b32 s85, 0x17a, 0
mvaac 44,56,236
ra 236,25,6144
v_lshrrev_b32 v34, 16, v34
mvaac 44,68,240
wl 4
ra 240,25,7168
s_cmp_eq_u32 s21, 2
mvaac 60,244,160
wl 4
ra 244,4,8192
v_mul_u32_u24 v35, 0x60, v34
mvaac 60,248,164
wl 4
ra 248,4,9216
s_cselect_b32 s85, 0, s85
mvaac 36,72,228
wl 4
v_sub_u32 v35, v33, v35
v_mul_lo_u32 v33, v34, s86
mvaac 36,84,232
s_add_u32 s84, s33, 13
v_add_u32 v34, s84, v34
v_cmp_gt_u32 vcc, s85, v34
mvaac 40,76,228
v_lshl_add_u32 v33, v35, 7, v33
v_add_u32 v33, s87, v33
mvaac 40,88,232
dm 1,12,25,1024
mvaac 44,80,228
ra 228,25,8192
v_cndmask_b32 v33, v253, v33, vcc
mvaac 44,92,232
wl 4
ra 232,25,9216
s_add_u32 s38, s70, s71
mvaac 60,236,168
wl 4
ra 236,4,10240
s_add_u32 s22, s31, s23
mvaac 60,240,172
wl 4
ra 240,4,11264
s_mov_b32 m0, s22
mvaac 36,96,244
s_waitcnt vmcnt(13) lgkmcnt(4)
buffer_load_dword a252, v33, s[8:11], 0 offen offset:0
mvaac 36,108,248
v_add_u32 v33, s38, v22
s_add_u32 s25, s24, 0x1000
mvaac 40,100,244
s_mov_b32 s86, 0x46e00
v_mov_b32 v253, 0x80000000
mvaac 40,112,248
mvaac 44,104,244
ra 244,25,10240
mvaac 44,116,248
wl 4
ra 248,25,11264
mvaac 60,228,176
wl 4
ra 228,4,12288
mvaac 60,232,180
wl 4
ra 232,4,13312
mvaac 36,120,236
wl 4
mvaac 36,132,240
mvaac 40,124,236
mvaac 40,136,240
cv 132,36,37
cv 133,38,39
mvaac 44,128,236
ra 236,4,14336
mvaac 44,140,240
wl 4
ra 240,4,15360
cv 134,40,41
mvaac 60,244,184
wl 4
ra 244,4,16384
cv 135,42,43
mvaac 60,248,188
wl 4
ra 248,4,17408
cv 136,44,45
mvaaz 48,0,228
wl 4
cv 137,46,47
mvaac 48,12,232
mu 60,24,60
mu 61,24,61
mvaaz 52,4,228
mu 62,24,62
mu 63,24,63
mvaac 52,16,232
cv 34,60,61
cv 35,62,63
mvaaz 56,8,228
ra 228,4,18432
mvaac 56,20,232
wl 4
ra 232,4,19456
mvaac 48,24,236
wl 4
s_mov_b64 exec, s[56:57]
ds_write_b64 v33, v[34:35] offset:0
s_mov_b64 exec, -1
mvaac 48,36,240
mvaac 52,28,236
s_waitcnt vmcnt(8) lgkmcnt(0)
s_barrier
dm 1,12,24,0
mvaac 52,40,240
s_mov_b32 m0, s22
mvaac 56,32,236
ra 236,4,20480
mvaac 56,44,240
ra 240,4,21504
mvaac 48,48,244
dm 1,12,24,1024
mvaac 48,60,248
s_mov_b32 m0, s22
mvaac 52,52,244
dm 1,12,24,2048
mvaac 52,64,248
s_mov_b32 m0, s22
mvaac 56,56,244
ra 244,4,22528
mvaac 56,68,248
ra 248,4,23552
mvaac 48,72,228
mvaac 48,84,232
mvaac 52,76,228
dm 1,12,24,3072
mvaac 52,88,232
s_add_u32 m0, s22, 0x1000
mvaac 56,80,228
ra 228,2,0
mvaac 56,92,232
wl 4
ra 232,2,1024
mvaac 48,96,236
wl 4
mvaac 48,108,240
mvaac 52,100,236
dm 1,12,25,0
mvaac 52,112,240
s_add_u32 m0, s22, 0x1000
s_add_u32 s24, s24, 0x6000
s_add_u32 s83, s79, 5
mvaac 56,104,236
ra 236,2,2048
s_and_b32 s84, s83, 3
mvaac 56,116,240
wl 4
ra 240,2,3072
s_lshl_b32 s83, s83, 6
mvaac 48,120,244
wl 4
v_add_u32 v33, s83, v0
s_cmp_eq_u32 s84, s20
mvaac 48,132,248
v_mul_u32_u24 v34, 0x2ab, v33
s_cselect_b32 s85, 0x17a, 0
mvaac 52,124,244
dm 1,12,25,1024
mvaac 52,136,248
v_lshrrev_b32 v34, 16, v34
s_cmp_eq_u32 s21, 2
mvaac 56,128,244
v_mul_u32_u24 v35, 0x60, v34
s_cselect_b32 s85, 0, s85
mvaac 56,140,248
s_add_u32 s84, s33, 13
v_sub_u32 v35, v33, v35
v_mul_lo_u32 v33, v34, s86
v_add_u32 v34, s84, v34
v_cmp_gt_u32 vcc, s85, v34
v_lshl_add_u32 v33, v35, 7, v33
v_add_u32 v33, s87, v33
v_cndmask_b32 v33, v253, v33, vcc
wv 13
buffer_load_dword a253, v33, s[8:11], 0 offen offset:0
s_cmp_eq_u32 s71, 0
s_cbranch_scc1 L_b1x_0
s_cmp_eq_u32 s71, 192
s_cbranch_scc1 L_b1x_1
s_cmp_eq_u32 s71, 384
s_cbranch_scc1 L_b1x_2
ra 144,254,0
ra 148,254,1024
ra 152,254,2048
ra 156,254,3072
ra 160,254,4096
ra 164,254,5120
ra 168,254,6144
ra 172,254,7168
ra 176,254,8192
s_branch L_out
L_round:
L_b1_a:
wl 3
mvaaz 36,228,0
wl 2
ra 244,2,4096
v_add_u32 v5, 0x12000, v1
mvaac 36,232,12
ra 248,2,5120
rv 136,5,2048
mvaaz 40,228,4
rv 200,116,16384
rv 128,5,0
mvaac 40,232,16
rv 184,112,16384
rv 188,113,16384
mvaaz 44,228,8
rv 132,5,1024
rv 192,114,16384
mvaac 44,232,20
wl 10
rv 196,115,16384
rv 176,121,16384
mvaac 36,236,24
wl 11
rv 140,117,16384
rv 144,118,16384
mvaac 36,240,36
s_mov_b32 s27, 0
s_add_u32 s37, s27, 0
s_and_b32 s37, s37, 3
mvaac 40,236,28
wl 9
s_mul_i32 s28, s37, 0x6000
s_add_u32 s37, s27, 1
s_and_b32 s37, s37, 3
mvvvz 232,136,200
rv 200,126,16384
s_mul_i32 s29, s37, 0x6000
mvaac 40,240,40
s_add_u32 s37, s27, 2
s_and_b32 s37, s37, 3
s_mul_i32 s30, s37, 0x6000
mvaac 44,236,32
wl 7
s_add_u32 s37, s27, 3
s_and_b32 s37, s37, 3
s_add_u32 s22, s30, s23
v_smfmac_f32_16x16x64_bf16 v[232:235], v[128:131], v[184:191], v6
ra 228,2,6144
rv 184,119,16384
mvaac 44,240,44
rv 188,120,16384
s_mov_b32 m0, s22
mvaac 36,244,48
wl 7
s_add_u32 s25, s24, 0x1000
v_add_u32 v3, s29, v1
s_mul_i32 s31, s37, 0x6000
v_smfmac_f32_16x16x64_bf16 v[232:235], v[132:135], v[192:199], v6
wl 6
ra 232,2,7168
rv 192,122,16384
mvvvz 236,136,176
rv 196,123,16384
rv 176,116,16896
mvaac 36,248,60
wl 8
ra 236,2,8192
ad 12,12,232
v_smfmac_f32_16x16x64_bf16 v[236:239], v[128:131], v[140:147], v6
wl 8
ra 240,2,9216
rv 140,124,16384
mvvvz 240,136,200
rv 144,125,16384
rv 136,5,5120
mvaac 40,244,52
wl 9
rv 200,121,16896
v_fma_f32 v15, v232, v232, v15
v_smfmac_f32_16x16x64_bf16 v[236:239], v[132:135], v[184:191], v6
rv 184,112,16896
rv 188,113,16896
mvaac 40,248,64
ad 12,12,233
v_fma_f32 v15, v233, v233, v15
mvaac 44,244,56
wl 9
ad 12,12,234
v_fma_f32 v15, v234, v234, v15
v_smfmac_f32_16x16x64_bf16 v[240:243], v[128:131], v[192:199], v6
rv 128,5,3072
ad 12,12,235
mvaac 44,248,68
rv 192,114,16896
v_fma_f32 v15, v235, v235, v15
mvaac 36,228,72
rv 196,115,16896
cv 212,232,233
mvaac 36,232,84
cv 213,234,235
ad 13,13,236
mvaac 40,228,76
wl 7
v_fma_f32 v16, v236, v236, v16
ad 13,13,237
v_smfmac_f32_16x16x64_bf16 v[240:243], v[132:135], v[140:147], v6
wl 6
ra 244,2,12288
rv 132,5,4096
mvvvz 232,136,176
ra 248,2,13312
rv 140,117,16896
mvaac 40,232,88
rv 144,118,16896
v_fma_f32 v16, v237, v237, v16
mvaac 44,228,80
wl 7
rv 176,126,16896
ad 13,13,238
v_smfmac_f32_16x16x64_bf16 v[232:235], v[128:131], v[184:191], v6
rv 184,119,16896
v_fma_f32 v16, v238, v238, v16
mvaac 44,232,92
rv 188,120,16896
ad 13,13,239
mvaac 36,236,96
v_fma_f32 v16, v239, v239, v16
cv 214,236,237
mvaac 36,240,108
wl 6
ra 228,2,14336
cv 215,238,239
v_smfmac_f32_16x16x64_bf16 v[232:235], v[132:135], v[192:199], v6
ra 232,2,15360
ad 14,14,240
mvvvz 236,136,200
rv 192,122,16896
rv 196,123,16896
mvaac 40,236,100
wl 7
v_fma_f32 v17, v240, v240, v17
ad 14,14,241
v_smfmac_f32_16x16x64_bf16 v[236:239], v[128:131], v[140:147], v6
rv 140,124,16896
rv 144,125,16896
mvaac 40,240,112
v_fma_f32 v17, v241, v241, v17
aw 120,212
mvaac 44,236,104
wl 6
ra 236,2,16384
aw 132,213
v_smfmac_f32_16x16x64_bf16 v[236:239], v[132:135], v[184:191], v6
wv 10
s_barrier
rv 200,116,32768
ad 14,14,242
mvaac 44,240,116
ra 240,2,17408
v_fma_f32 v17, v242, v242, v17
mvaaz 48,244,0
ad 14,14,243
v_fma_f32 v17, v243, v243, v17
mvaac 48,248,12
cv 212,240,241
cv 213,242,243
mvvvz 240,136,176
wl 5
rv 136,5,8192
ad 12,12,232
v_smfmac_f32_16x16x64_bf16 v[240:243], v[128:131], v[192:199], v6
wl 4
rv 128,5,6144
v_fma_f32 v15, v232, v232, v15
v_smfmac_f32_16x16x64_bf16 v[240:243], v[132:135], v[140:147], v6
rv 184,112,32768
rv 188,113,32768
mvaaz 52,244,4
rv 132,5,7168
rv 192,114,32768
mvaac 52,248,16
rv 196,115,32768
ad 12,12,233
mvaaz 56,244,8
rv 176,121,32768
v_fma_f32 v15, v233, v233, v15
mvaac 56,248,20
rv 140,117,32768
aw 124,214
mvaac 48,228,24
rv 144,118,32768
aw 136,215
mvaac 48,232,36
ad 12,12,234
v_fma_f32 v15, v234, v234, v15
mvaac 52,228,28
ra 244,2,18432
ad 12,12,235
mvaac 52,232,40
ra 248,2,19456
v_fma_f32 v15, v235, v235, v15
mvaac 56,228,32
ra 228,2,20480
cv 214,232,233
mvaac 56,232,44
wl 12
ra 232,2,21504
cv 215,234,235
mvvvz 232,136,200
wl 10
rv 200,126,32768
ad 13,13,236
v_smfmac_f32_16x16x64_bf16 v[232:235], v[128:131], v[184:191], v6
wl 8
rv 184,119,32768
v_fma_f32 v16, v236, v236, v16
v_smfmac_f32_16x16x64_bf16 v[232:235], v[132:135], v[192:199], v6
rv 188,120,32768
ad 13,13,237
mvaac 48,236,48
rv 192,122,32768
v_fma_f32 v16, v237, v237, v16
mvaac 48,240,60
rv 196,123,32768
aw 128,212
mvaac 52,236,52
aw 140,213
ad 13,13,238
mvaac 52,240,64
v_fma_f32 v16, v238, v238, v16
ad 13,13,239
mvaac 56,236,56
ra 236,2,10240
v_fma_f32 v16, v239, v239, v16
mvaac 56,240,68
wl 9
ra 240,2,11264
cv 212,236,237
mvaac 48,244,72
cv 213,238,239
ad 14,14,240
mvvvz 236,136,176
rv 176,116,33280
v_fma_f32 v17, v240, v240, v17
v_smfmac_f32_16x16x64_bf16 v[236:239], v[128:131], v[140:147], v6
wl 5
rv 140,124,32768
ad 14,14,241
v_smfmac_f32_16x16x64_bf16 v[236:239], v[132:135], v[184:191], v6
rv 144,125,32768
v_fma_f32 v17, v241, v241, v17
mvaac 48,248,84
rv 184,112,33280
aw 121,214
mvaac 52,244,76
rv 188,113,33280
aw 133,215
mvaac 52,248,88
ad 14,14,242
v_fma_f32 v17, v242, v242, v17
mvaac 56,244,80
ra 244,2,22528
ad 14,14,243
mvaac 56,248,92
ra 248,2,23552
v_fma_f32 v17, v243, v243, v17
mvaac 48,228,96
cv 214,240,241
cv 215,242,243
mvvvz 240,136,200
wl 9
rv 136,5,11264
ad 12,12,232
v_smfmac_f32_16x16x64_bf16 v[240:243], v[128:131], v[192:199], v6
wl 5
rv 128,5,9216
v_fma_f32 v15, v232, v232, v15
v_smfmac_f32_16x16x64_bf16 v[240:243], v[132:135], v[140:147], v6
rv 132,5,10240
ad 12,12,233
mvaac 48,232,108
rv 192,114,33280
v_fma_f32 v15, v233, v233, v15
mvaac 52,228,100
rv 196,115,33280
aw 125,212
mvaac 52,232,112
rv 200,121,33280
aw 137,213
mvaac 56,228,104
ra 228,3,0
ad 12,12,234
mvaac 56,232,116
s_mov_b32 s71, 0
rv 140,117,33280
rv 144,118,33280
v_fma_f32 v15, v234, v234, v15
ra 232,3,1024
ad 12,12,235
v_fma_f32 v15, v235, v235, v15
cv 212,232,233
cv 213,234,235
wl 9
mvvvz 232,136,176
wl 8
rv 176,126,33280
ad 13,13,236
v_smfmac_f32_16x16x64_bf16 v[232:235], v[128:131], v[184:191], v6
wl 6
rv 184,119,33280
v_fma_f32 v16, v236, v236, v16
v_smfmac_f32_16x16x64_bf16 v[232:235], v[132:135], v[192:199], v6
rv 188,120,33280
rv 192,122,33280
ad 13,13,237
rv 196,123,33280
v_fma_f32 v16, v237, v237, v16
aw 129,214
aw 141,215
ad 13,13,238
v_fma_f32 v16, v238, v238, v16
ad 13,13,239
v_fma_f32 v16, v239, v239, v16
cv 214,236,237
cv 215,238,239
wl 9
mvvvz 236,136,200
wl 6
ad 14,14,240
v_fma_f32 v17, v240, v240, v17
v_smfmac_f32_16x16x64_bf16 v[236:239], v[128:131], v[140:147], v6
rv 140,124,33280
rv 144,125,33280
ad 14,14,241
v_fma_f32 v17, v241, v241, v17
wl 4
v_smfmac_f32_16x16x64_bf16 v[236:239], v[132:135], v[184:191], v6
dm 1,12,24,0
aw 122,212
aw 134,213
ad 14,14,242
v_fma_f32 v17, v242, v242, v17
ad 14,14,243
v_fma_f32 v17, v243, v243, v17
cv 212,240,241
cv 213,242,243
mvvvz 240,136,176
wl 2
s_mov_b32 m0, s22
ad 12,12,232
ad 12,12,233
v_smfmac_f32_16x16x64_bf16 v[240:243], v[128:131], v[192:199], v6
dm 1,12,24,1024
s_mov_b32 m0, s22
ad 12,12,234
ad 12,12,235
v_mov_b32 v26, v12
v_fma_f32 v15, v232, v232, v15
v_fma_f32 v15, v233, v233, v15
wl 0
v_smfmac_f32_16x16x64_bf16 v[240:243], v[132:135], v[140:147], v6
s_barrier
dm 1,12,24,2048
s_mov_b32 m0, s22
v_permlane16_swap_b32 v12, v26
ad 12,12,26
v_mov_b32 v26, v12
v_fma_f32 v15, v234, v234, v15
v_fma_f32 v15, v235, v235, v15
v_permlane32_swap_b32 v12, v26
ad 12,12,26
v_mov_b32 v26, v15
dm 1,12,24,3072
s_add_u32 m0, s22, 0x1000
v_permlane16_swap_b32 v15, v26
aw 126,214
ad 15,15,26
cv 214,232,233
v_mov_b32 v26, v15
aw 123,214
aw 138,215
v_permlane32_swap_b32 v15, v26
mvaac 36,236,120
dm 1,12,25,0
mvaac 48,244,120
s_add_u32 m0, s22, 0x1000
cv 215,234,235
ad 13,13,236
aw 135,215
ad 13,13,237
ad 15,15,26
mvaac 36,240,132
ad 13,13,238
v_mul_f32 v26, s75, v12
mvaac 48,248,132
s_add_u32 s24, s24, 0x6000
aw 130,212
ad 13,13,239
mu 27,26,26
cv 212,236,237
v_mov_b32 v26, v13
aw 127,212
aw 142,213
v_permlane16_swap_b32 v13, v26
mvaac 40,236,124
dm 1,12,25,1024
mvaac 52,244,124
s_add_u32 s22, s31, s23
cv 213,238,239
aw 139,213
ad 13,13,26
v_mov_b32 v26, v13
mvaac 40,240,136
v_fma_f32 v16, v236, v236, v16
cv 214,240,241
mvaac 52,248,136
s_mov_b32 m0, s22
v_fma_f32 v16, v237, v237, v16
aw 131,214
v_permlane32_swap_b32 v13, v26
s_nop 0
mvaac 44,236,128
ra 236,3,2048
v_fma_f32 v16, v238, v238, v16
mvaac 56,244,128
s_add_u32 s25, s24, 0x1000
ra 244,3,4096
v_fma_f32 v16, v239, v239, v16
ad 13,13,26
cv 215,242,243
v_mov_b32 v26, v16
aw 143,215
v_fma_f32 v27, v15, s75, -v27
v_permlane16_swap_b32 v16, v26
mvaac 44,240,140
ra 240,3,3072
ad 16,16,26
mvaac 56,248,140
ra 248,3,5120
v_mov_b32 v26, v16
ad 14,14,240
v_max_f32 v27, 0, v27
v_permlane32_swap_b32 v16, v26
ad 14,14,241
v_add_f32 v27, s76, v27
ad 16,16,26
ad 14,14,242
v_rsq_f32 v5, v27
v_mul_f32 v26, s75, v13
ad 14,14,243
mu 27,26,26
v_mov_b32 v26, v14
v_fma_f32 v17, v240, v240, v17
v_fma_f32 v17, v241, v241, v17
v_permlane16_swap_b32 v14, v26
ad 14,14,26
v_mov_b32 v26, v14
v_fma_f32 v17, v242, v242, v17
v_fma_f32 v17, v243, v243, v17
v_permlane32_swap_b32 v14, v26
ad 14,14,26
v_mov_b32 v26, v17
mu 36,5,36
mu 37,5,37
v_permlane16_swap_b32 v17, v26
mu 38,5,38
mu 39,5,39
ad 17,17,26
cv 172,36,37
cv 173,38,39
mvaaz 36,228,0
dm 1,12,24,0
mvaac 36,232,12
wl 3
v_fma_f32 v27, v16, s75, -v27
v_mov_b32 v26, v17
mvaac 36,236,24
wl 1
v_max_f32 v27, 0, v27
v_add_f32 v27, s76, v27
mvaac 36,240,36
v_rsq_f32 v6, v27
mvaac 36,244,48
wl 0
v_permlane32_swap_b32 v17, v26
mvaac 36,248,60
s_mov_b32 m0, s22
ad 17,17,26
v_mul_f32 v26, s75, v14
mu 40,6,40
mu 41,6,41
mu 42,6,42
mu 43,6,43
mu 27,26,26
cv 176,40,41
cv 177,42,43
mvaaz 40,228,4
dm 1,12,24,1024
mvaac 40,232,16
v_fma_f32 v27, v17, s75, -v27
v_max_f32 v27, 0, v27
mvaac 40,236,28
v_add_f32 v27, s76, v27
v_rsq_f32 v7, v27
mvaac 40,240,40
mu 44,7,44
mu 45,7,45
mvaac 40,244,52
mu 46,7,46
mu 47,7,47
mvaac 40,248,64
s_mov_b32 m0, s22
cv 180,44,45
cv 181,46,47
mvaaz 44,228,8
ra 228,3,6144
mu 48,5,48
mvaac 44,232,20
ra 232,3,7168
mu 49,5,49
mvaac 44,236,32
ra 236,3,8192
mu 50,5,50
mvaac 44,240,44
ra 240,3,9216
dm 1,12,24,2048
mvaac 44,244,56
ra 244,3,10240
s_mov_b32 m0, s22
mvaac 44,248,68
ra 248,3,11264
mu 51,5,51
cv 174,48,49
cv 175,50,51
mu 52,6,52
wl 5
mvaac 36,228,72
wl 4
dm 1,12,24,3072
mvaac 36,232,84
s_add_u32 m0, s22, 0x1000
mu 53,6,53
mu 54,6,54
mvaac 40,228,76
mu 55,6,55
cv 178,52,53
mvaac 40,232,88
cv 179,54,55
mu 56,7,56
mvaac 44,228,80
ra 228,3,12288
mu 57,7,57
mvaac 44,232,92
wl 4
ra 232,3,13312
mu 58,7,58
mvaac 36,236,96
wl 4
dm 1,12,25,0
mvaac 36,240,108
s_add_u32 m0, s22, 0x1000
s_add_u32 s24, s24, 0x6000
mu 59,7,59
mvaac 40,236,100
cv 182,56,57
cv 183,58,59
mvaac 40,240,112
s_add_u32 s22, s28, s23
wv 5
s_barrier
v_add_u32 v4, s30, v1
mvaac 44,236,104
ra 236,3,14336
v_lshrrev_b32 v28, 4, v0
mvaac 44,240,116
wl 4
ra 240,3,15360
v_lshlrev_b32 v28, 4, v28
mvaac 36,244,120
wl 4
dm 1,12,25,1024
mvaac 36,248,132
s_mov_b32 m0, s22
s_add_u32 s25, s24, 0x1000
v_add_u32 v2, s31, v1
mvaac 40,244,124
ds_bpermute_b32 v8, v28, v5 offset:0
mvaac 40,248,136
mu 36,5,36
mu 37,5,37
mvaac 44,244,128
ra 244,3,16384
mu 38,5,38
mvaac 44,248,140
wl 5
ra 248,3,17408
mu 39,5,39
mvaaz 48,228,0
wl 5
cv 148,36,37
cv 149,38,39
mvaac 48,232,12
mu 40,6,40
mu 41,6,41
mvaaz 52,228,4
dm 1,12,24,0
mvaac 52,232,16
s_mov_b32 m0, s22
mu 42,6,42
mu 43,6,43
mvaaz 56,228,8
ra 228,3,18432
cv 152,40,41
mvaac 56,232,20
wl 5
ra 232,3,19456
cv 153,42,43
mvaac 48,236,24
wl 5
mu 44,7,44
mu 45,7,45
mvaac 48,240,36
mu 46,7,46
mu 47,7,47
mvaac 52,236,28
cv 156,44,45
cv 157,46,47
mvaac 52,240,40
ds_bpermute_b32 v9, v28, v5 offset:4
mvaac 56,236,32
ra 236,3,20480
mvaac 56,240,44
wl 5
ra 240,3,21504
mvaac 48,244,48
wl 5
ds_bpermute_b32 v10, v28, v5 offset:8
mvaac 48,248,60
dm 1,12,24,1024
mvaac 52,244,52
s_mov_b32 m0, s22
ds_bpermute_b32 v11, v28, v5 offset:12
mvaac 52,248,64
ds_bpermute_b32 v12, v28, v6 offset:0
mvaac 56,244,56
ra 244,3,22528
mvaac 56,248,68
wl 8
ra 248,3,23552
mvaac 48,228,72
wl 8
ds_bpermute_b32 v13, v28, v6 offset:4
mvaac 48,232,84
ds_bpermute_b32 v14, v28, v6 offset:8
mvaac 52,228,76
ds_bpermute_b32 v15, v28, v6 offset:12
mvaac 52,232,88
ds_bpermute_b32 v16, v28, v7 offset:0
mvaac 56,228,80
ra 228,4,0
mvaac 56,232,92
wl 11
ra 232,4,1024
mvaac 48,236,96
wl 11
dm 1,12,24,2048
mvaac 48,240,108
s_mov_b32 m0, s22
ds_bpermute_b32 v17, v28, v7 offset:4
mvaac 52,236,100
ds_bpermute_b32 v18, v28, v7 offset:8
mvaac 52,240,112
ds_bpermute_b32 v19, v28, v7 offset:12
mvaac 56,236,104
ra 236,4,2048
mvaac 56,240,116
wl 11
ra 240,4,3072
mvaac 48,244,120
wl 11
mvaac 48,248,132
mvaac 52,244,124
mvaac 52,248,136
mu 48,5,48
mu 49,5,49
mvaac 56,244,128
ra 244,4,4096
mu 50,5,50
mvaac 56,248,140
wl 7
ra 248,4,5120
mu 51,5,51
mvaaz 36,228,0
wl 7
dm 1,12,24,3072
mvaac 36,232,12
s_add_u32 m0, s22, 0x1000
cv 150,48,49
cv 151,50,51
mvaaz 40,228,4
mu 52,6,52
mu 53,6,53
mvaac 40,232,16
mu 54,6,54
mu 55,6,55
mvaaz 44,228,8
ra 228,4,6144
cv 154,52,53
mvaac 44,232,20
wl 4
ra 232,4,7168
cv 155,54,55
mvaac 36,236,24
wl 4
mu 56,7,56
mu 57,7,57
mvaac 36,240,36
mu 58,7,58
mu 59,7,59
mvaac 40,236,28
cv 158,56,57
cv 159,58,59
mvaac 40,240,40
mvaac 44,236,32
ra 236,4,8192
mvaac 44,240,44
wl 4
ra 240,4,9216
mvaac 36,244,48
wl 4
dm 1,12,25,0
mvaac 36,248,60
s_add_u32 m0, s22, 0x1000
s_add_u32 s24, s24, 0x6000
s_add_u32 s22, s29, s23
mvaac 40,244,52
mvaac 40,248,64
mvaac 44,244,56
ra 244,4,10240
mvaac 44,248,68
wl 4
ra 248,4,11264
mvaac 36,228,72
wl 4
mvaac 36,232,84
mvaac 40,228,76
mvaac 40,232,88
dm 1,12,25,1024
mvaac 44,228,80
ra 228,4,12288
s_mov_b32 m0, s22
mvaac 44,232,92
ra 232,4,13312
wv 6
s_barrier
wl 5
mvaac 36,236,96
wl 4
s_add_u32 s25, s24, 0x1000
mvaac 36,240,108
mvaac 40,236,100
mvaac 40,240,112
mvaac 44,236,104
ra 236,4,14336
mvaac 44,240,116
wl 4
ra 240,4,15360
mvaac 36,244,120
wl 4
mvaac 36,248,132
mvaac 40,244,124
mvaac 40,248,136
mu 36,5,36
mu 37,5,37
mvaac 44,244,128
ra 244,4,16384
mu 38,5,38
mvaac 44,248,140
wl 4
ra 248,4,17408
mu 39,5,39
mvaaz 48,228,0
wl 4
mu 40,6,40
mu 41,6,41
mvaac 48,232,12
mu 42,6,42
mu 43,6,43
mvaaz 52,228,4
dm 1,12,24,0
mvaac 52,232,16
s_mov_b32 m0, s22
mu 44,7,44
mu 45,7,45
mvaaz 56,228,8
ra 228,4,18432
mu 46,7,46
mvaac 56,232,20
wl 4
ra 232,4,19456
mu 47,7,47
mvaac 48,236,24
wl 4
cv 160,36,37
cv 161,38,39
mvaac 48,240,36
cv 164,40,41
cv 165,42,43
mvaac 52,236,28
dm 1,12,24,1024
mvaac 52,240,40
s_mov_b32 m0, s22
cv 168,44,45
cv 169,46,47
mvaac 56,236,32
ra 236,4,20480
mvaac 56,240,44
wl 4
ra 240,4,21504
mvaac 48,244,48
wl 4
mvaac 48,248,60
mvaac 52,244,52
dm 1,12,24,2048
mvaac 52,248,64
s_mov_b32 m0, s22
mvaac 56,244,56
ra 244,4,22528
mvaac 56,248,68
wl 4
ra 248,4,23552
mvaac 48,228,72
wl 4
mvaac 48,232,84
mvaac 52,228,76
dm 1,12,24,3072
mvaac 52,232,88
s_add_u32 m0, s22, 0x1000
mvaac 56,228,80
ra 228,2,0
mvaac 56,232,92
wl 4
ra 232,2,1024
mvaac 48,236,96
wl 4
mvaac 48,240,108
mvaac 52,236,100
dm 1,12,25,0
mvaac 52,240,112
s_add_u32 m0, s22, 0x1000
s_add_u32 s24, s24, 0x6000
mvaac 56,236,104
ra 236,2,2048
mvaac 56,240,116
wl 4
ra 240,2,3072
mvaac 48,244,120
wl 4
mvaac 48,248,132
mvaac 52,244,124
dm 1,12,25,1024
mvaac 52,248,136
mvaac 56,244,128
mvaac 56,248,140
s_branch L_b2
L_b1_0:
mvvvz 232,100,172
ds_read_u16 v106, v21 offset:0
ds_read_u16 v114, v21 offset:8
mvvvz 236,108,172
ds_read_u16 v122, v21 offset:64
ds_read_u16 v130, v21 offset:72
mvvvz 240,116,172
ds_read_u16 v138, v21 offset:128
ds_read_u16 v146, v21 offset:136
mvvvz 244,124,172
cv 140,48,49
cv 141,50,51
mvvvz 184,132,172
wl 9
cv 142,52,53
cv 143,54,55
mvaaz 36,228,0
cv 144,56,57
cv 145,58,59
mvvvz 188,140,172
wl 5
ra 244,2,4096
v_max3_f32 v26, v200, v201, v202
mvvvc 232,104,176
wl 5
ra 248,2,5120
v_max3_f32 v26, v26, v203, v204
mvvvc 236,112,176
wl 5
v_max3_f32 v26, v26, v205, v206
v_max3_f32 v26, v26, v207, v208
mvvvc 240,120,176
wl 4
v_max3_f32 v26, v26, v209, v210
v_max3_f32 v26, v26, v211, v212
mvvvc 244,128,176
wl 3
v_mov_b32 v27, v26
s_add_u32 s27, s27, 9
mvvvc 184,136,176
wl 2
v_permlane16_swap_b32 v26, v27
mvvvc 188,144,176
mx 26,26,27
v_mov_b32 v27, v26
mvaac 36,232,12
v_permlane32_swap_b32 v26, v27
mvaaz 40,228,4
mx 26,26,27
v_mul_f32 v28, s61, v26
mvaac 40,232,16
v_fma_f32 v200, v200, s32, v28
v_fma_f32 v201, v201, s32, v28
mvaaz 44,228,8
ra 228,2,6144
v_fma_f32 v202, v202, s32, v28
mvaac 44,232,20
ra 232,2,7168
v_fma_f32 v203, v203, s32, v28
mvaac 36,236,24
ex 200,200
mvaac 36,240,36
ex 201,201
mvaac 40,236,28
ex 202,202
mvaac 40,240,40
ex 203,203
mvaac 44,236,32
ra 236,2,8192
v_fma_f32 v204, v204, s32, v28
mvaac 44,240,44
wl 4
ra 240,2,9216
v_fma_f32 v205, v205, s32, v28
mvaac 36,244,48
wl 4
ex 204,204
mvaac 36,248,60
ad 249,200,201
v_fma_f32 v206, v206, s32, v28
mvaac 40,244,52
ex 205,205
mvaac 40,248,64
ad 249,249,202
v_fma_f32 v207, v207, s32, v28
mvaac 44,244,56
ra 244,2,10240
ad 249,249,203
mvaac 44,248,68
wl 4
ra 248,2,11264
v_fma_f32 v208, v208, s32, v28
mvaac 36,228,72
wl 4
ex 206,206
mvaac 36,232,84
ex 207,207
mvaac 40,228,76
ad 249,249,204
v_fma_f32 v209, v209, s32, v28
mvaac 40,232,88
ex 208,208
mvaac 44,228,80
ra 228,2,12288
ad 249,249,205
mvaac 44,232,92
wl 4
ra 232,2,13312
v_fma_f32 v210, v210, s32, v28
mvaac 36,236,96
wl 4
ex 209,209
mvaac 36,240,108
ad 249,249,206
v_fma_f32 v211, v211, s32, v28
mvaac 40,236,100
ex 210,210
mvaac 40,240,112
v_fma_f32 v212, v212, s32, v28
ad 249,249,207
mvaac 44,236,104
ra 236,2,14336
ad 249,249,208
mvaac 44,240,116
wl 4
ra 240,2,15360
ad 249,249,209
mvaac 36,244,120
wl 4
ex 211,211
mvaac 36,248,132
ex 212,212
mvaac 40,244,124
ad 249,249,210
mu 212,23,212
mvaac 40,248,136
ad 249,249,211
ad 249,249,212
mvaac 44,244,128
ra 244,2,16384
v_mov_b32 v32, v249
mvaac 44,248,140
ra 248,2,17408
mu 200,8,200
mvvvz 192,100,148
v_permlane16_swap_b32 v249, v32
mvvvc 192,104,152
ad 249,249,32
v_mov_b32 v32, v249
mvvvz 196,108,148
v_permlane32_swap_b32 v249, v32
mvvvc 196,112,152
wl 5
ad 249,249,32
v_rcp_f32 v249, v249
mvaaz 48,228,0
wl 4
mu 201,9,201
mu 202,10,202
mvaac 48,232,12
mu 203,11,203
mu 200,249,200
mvaaz 52,228,4
mu 201,249,201
mu 202,249,202
mvaac 52,232,16
mu 203,249,203
cv 156,200,201
mvaaz 56,228,8
ra 228,2,18432
cv 157,202,203
mvvvz 200,116,148
mu 204,12,204
mu 205,13,205
mvvvc 200,120,152
mu 206,14,206
mu 207,15,207
mvaac 56,232,20
wl 4
ra 232,2,19456
mu 204,249,204
mvaac 48,236,24
wl 4
mu 205,249,205
mu 206,249,206
mvaac 48,240,36
mu 207,249,207
cv 158,204,205
mvaac 52,236,28
cv 159,206,207
mu 208,16,208
mvvvz 204,124,148
mu 209,17,209
mu 210,18,210
mvvvc 204,128,152
mu 211,19,211
mu 208,249,208
mvaac 52,240,40
mu 209,249,209
mu 210,249,210
mvaac 56,236,32
ra 236,2,20480
mu 211,249,211
mvaac 56,240,44
wl 4
ra 240,2,21504
cv 160,208,209
mvaac 48,244,48
cv 161,210,211
mu 212,249,212
mvvvz 208,132,148
v_cvt_pk_bf16_f32 v162, v212, 0
s_add_u32 s37, s27, 0
mvvvc 208,136,152
s_and_b32 s37, s37, 3
s_mul_i32 s28, s37, 0x6000
s_add_u32 s37, s27, 1
mvvvz 212,140,148
s_and_b32 s37, s37, 3
s_mul_i32 s29, s37, 0x6000
s_add_u32 s37, s27, 2
mvvvc 212,144,152
wl 4
s_and_b32 s37, s37, 3
s_mul_i32 s30, s37, 0x6000
s_add_u32 s37, s27, 3
mvaac 48,248,60
s_and_b32 s37, s37, 3
s_mul_i32 s31, s37, 0x6000
s_add_u32 s71, s71, 0xc0
mvaac 52,244,52
s_add_u32 s22, s31, s23
s_mov_b32 m0, s22
wv 8
s_barrier
mvaac 52,248,64
cv 34,232,233
dm 1,12,24,0
mvaac 56,244,56
ra 244,2,22528
s_mov_b32 m0, s22
mvaac 56,248,68
wl 4
ra 248,2,23552
cv 35,234,235
mvaac 48,228,72
wl 4
dm 1,12,24,1024
mvaac 48,232,84
s_mov_b32 m0, s22
v_mov_b32 v163, 0
v_add_u32 v3, s29, v1
mvaac 52,228,76
s_mov_b64 exec, s[58:59]
ds_write_b64 v20, v[34:35] offset:0
s_mov_b64 exec, -1
mvaac 52,232,88
cv 34,236,237
cv 35,238,239
mvaac 56,228,80
ra 228,3,0
mu 36,5,36
mvaac 56,232,92
wl 5
ra 232,3,1024
mu 37,5,37
mvaac 48,236,96
wl 5
dm 1,12,24,2048
mvaac 48,240,108
s_mov_b64 exec, s[58:59]
ds_write_b64 v20, v[34:35] offset:8
s_mov_b64 exec, -1
mvaac 52,236,100
cv 34,240,241
cv 35,242,243
mvaac 52,240,112
s_mov_b64 exec, s[58:59]
ds_write_b64 v20, v[34:35] offset:64
s_mov_b64 exec, -1
mvaac 56,236,104
ra 236,3,2048
s_mov_b32 m0, s22
mvaac 56,240,116
wl 7
ra 240,3,3072
cv 34,244,245
mvaac 48,244,120
wl 7
cv 35,246,247
mu 38,5,38
mvaac 48,248,132
s_mov_b64 exec, s[58:59]
ds_write_b64 v20, v[34:35] offset:72
s_mov_b64 exec, -1
mvaac 52,244,124
cv 34,184,185
cv 35,186,187
mvaac 52,248,136
s_mov_b64 exec, s[58:59]
ds_write_b64 v20, v[34:35] offset:128
s_mov_b64 exec, -1
mvaac 56,244,128
ra 244,3,4096
cv 34,188,189
mvaac 56,248,140
ra 248,3,5120
cv 35,190,191
mvvvz 232,100,156
dm 1,12,24,3072
mvvvc 232,104,160
mu 39,5,39
cv 172,36,37
mvvvz 236,108,156
cv 173,38,39
mu 40,6,40
mvvvc 236,112,160
mu 41,6,41
mu 42,6,42
mvvvz 240,116,156
mu 43,6,43
cv 176,40,41
mvvvc 240,120,160
cv 177,42,43
mu 44,7,44
mvvvz 244,124,156
mu 45,7,45
mu 46,7,46
mvvvc 244,128,160
mu 47,7,47
cv 180,44,45
mvvvz 184,132,156
cv 181,46,47
s_add_u32 s25, s24, 0x1000
mvvvc 184,136,160
s_add_u32 m0, s22, 0x1000
mu 48,5,48
mu 49,5,49
mvvvz 188,140,156
mu 50,5,50
mu 51,5,51
mvvvc 188,144,160
wl 9
cv 174,48,49
cv 175,50,51
mvaaz 36,228,0
wl 8
mu 52,6,52
mu 53,6,53
mvaac 36,232,12
mu 54,6,54
mu 55,6,55
mvaaz 40,228,4
cv 178,52,53
cv 179,54,55
mvaac 40,232,16
mu 56,7,56
mu 57,7,57
mvaaz 44,228,8
ra 228,3,6144
mu 58,7,58
mvaac 44,232,20
wl 6
ra 232,3,7168
mu 59,7,59
mvaac 36,236,24
wl 6
cv 182,56,57
cv 183,58,59
mvaac 36,240,36
v_max3_f32 v29, v216, v217, v218
v_max3_f32 v29, v29, v219, v220
mvaac 40,236,28
v_max3_f32 v29, v29, v221, v222
v_max3_f32 v29, v29, v223, v224
mvaac 40,240,40
v_max3_f32 v29, v29, v225, v226
v_max3_f32 v29, v29, v227, v228
mvaac 44,236,32
ra 236,3,8192
v_mov_b32 v30, v29
mvaac 44,240,44
wl 4
ra 240,3,9216
v_mov_b32 v171, 0
mvaac 36,244,48
wl 4
dm 1,12,25,0
mvaac 36,248,60
s_add_u32 m0, s22, 0x1000
s_add_u32 s24, s24, 0x6000
s_add_u32 s22, s28, s23
mvaac 40,244,52
v_permlane16_swap_b32 v29, v30
mvaac 40,248,64
mx 29,29,30
v_mov_b32 v30, v29
mvaac 44,244,56
ra 244,3,10240
v_add_u32 v4, s30, v1
mvaac 44,248,68
wl 4
ra 248,3,11264
v_add_u32 v2, s31, v1
mvaac 36,228,72
wl 4
v_permlane32_swap_b32 v29, v30
mvaac 36,232,84
mx 29,29,30
v_mul_f32 v31, s61, v29
mvaac 40,228,76
v_fma_f32 v216, v216, s32, v31
v_fma_f32 v217, v217, s32, v31
mvaac 40,232,88
dm 1,12,25,1024
mvaac 44,228,80
ra 228,3,12288
s_mov_b32 m0, s22
mvaac 44,232,92
ra 232,3,13312
wv 7
s_barrier
wl 5
mvaac 36,236,96
wl 4
ex 216,216
mvaac 36,240,108
ex 217,217
mvaac 40,236,100
v_fma_f32 v218, v218, s32, v31
v_fma_f32 v219, v219, s32, v31
mvaac 40,240,112
ex 218,218
mvaac 44,236,104
ra 236,3,14336
v_fma_f32 v220, v220, s32, v31
mvaac 44,240,116
wl 4
ra 240,3,15360
v_fma_f32 v221, v221, s32, v31
mvaac 36,244,120
wl 4
ex 219,219
mvaac 36,248,132
ex 220,220
mvaac 40,244,124
ad 250,216,217
v_fma_f32 v222, v222, s32, v31
mvaac 40,248,136
ex 221,221
mvaac 44,244,128
ra 244,3,16384
ad 250,250,218
mvaac 44,248,140
wl 4
ra 248,3,17408
v_fma_f32 v223, v223, s32, v31
mvaaz 48,228,0
wl 4
ex 222,222
mvaac 48,232,12
ad 250,250,219
v_fma_f32 v224, v224, s32, v31
mvaaz 52,228,4
dm 1,12,24,0
mvaac 52,232,16
s_mov_b32 m0, s22
ex 223,223
mvaaz 56,228,8
ra 228,3,18432
ad 250,250,220
mvaac 56,232,20
wl 4
ra 232,3,19456
v_fma_f32 v225, v225, s32, v31
mvaac 48,236,24
wl 4
ex 224,224
mvaac 48,240,36
ad 250,250,221
v_fma_f32 v226, v226, s32, v31
mvaac 52,236,28
ex 225,225
mvaac 52,240,40
ad 250,250,222
v_fma_f32 v227, v227, s32, v31
mvaac 56,236,32
ra 236,3,20480
v_fma_f32 v228, v228, s32, v31
mvaac 56,240,44
wl 4
ra 240,3,21504
ad 250,250,223
mvaac 48,244,48
wl 4
ex 226,226
mvaac 48,248,60
dm 1,12,24,1024
mvaac 52,244,52
s_mov_b32 m0, s22
ex 227,227
mvaac 52,248,64
ex 228,228
mvaac 56,244,56
ra 244,3,22528
ad 250,250,224
mvaac 56,248,68
wl 4
ra 248,3,23552
ad 250,250,225
mvaac 48,228,72
wl 4
ad 250,250,226
mu 228,23,228
mvaac 48,232,84
ad 250,250,227
ad 250,250,228
mvaac 52,228,76
v_mov_b32 v32, v250
mu 216,8,216
mvaac 52,232,88
s_mov_b64 exec, s[58:59]
ds_write_b64 v20, v[34:35] offset:136
s_mov_b64 exec, -1
mvaac 56,228,80
ra 228,4,0
mu 217,9,217
mvaac 56,232,92
wl 5
ra 232,4,1024
mu 218,10,218
mvaac 48,236,96
wl 5
dm 1,12,24,2048
mvaac 48,240,108
v_permlane16_swap_b32 v250, v32
mvaac 52,236,100
ad 250,250,32
v_mov_b32 v32, v250
mvaac 52,240,112
v_permlane32_swap_b32 v250, v32
mvaac 56,236,104
ra 236,4,2048
ad 250,250,32
mvaac 56,240,116
wl 5
ra 240,4,3072
mu 219,11,219
mvaac 48,244,120
wl 5
v_rcp_f32 v250, v250
mvaac 48,248,132
mu 220,12,220
mu 221,13,221
mvaac 52,244,124
mu 222,14,222
mu 223,15,223
mvaac 52,248,136
mu 216,250,216
mu 217,250,217
mvaac 56,244,128
ra 244,4,4096
mu 218,250,218
mvaac 56,248,140
s_mov_b32 m0, s22
ra 248,4,5120
mu 219,250,219
mu 220,250,220
mu 221,250,221
mu 222,250,222
mu 223,250,223
cv 164,216,217
cv 165,218,219
cv 166,220,221
cv 167,222,223
mu 224,16,224
mu 225,17,225
mu 226,18,226
mu 227,19,227
cv 34,192,193
cv 35,194,195
mvvvz 192,100,164
s_add_u32 s25, s24, 0x1000
mu 224,250,224
mu 225,250,225
mu 226,250,226
mu 227,250,227
mu 228,250,228
cv 168,224,225
cv 169,226,227
v_cvt_pk_bf16_f32 v170, v228, 0
aw 144,34
aw 145,35
mvvvc 192,104,168
cv 34,196,197
cv 35,198,199
mvvvz 196,108,164
dm 1,12,24,3072
mvvvc 196,112,168
s_add_u32 m0, s22, 0x1000
aw 146,34
aw 147,35
cv 34,200,201
cv 35,202,203
mvvvz 200,116,164
aw 156,34
aw 157,35
mvvvc 200,120,168
cv 34,204,205
cv 35,206,207
mvvvz 204,124,164
aw 158,34
aw 159,35
mvvvc 204,128,168
cv 34,208,209
cv 35,210,211
mvvvz 208,132,164
aw 168,34
aw 169,35
mvvvc 208,136,168
cv 34,212,213
cv 35,214,215
mvvvz 212,140,164
mu 36,5,36
mu 37,5,37
mvvvc 212,144,168
mu 38,5,38
mu 39,5,39
cv 148,36,37
cv 149,38,39
wl 5
mvaaz 36,228,0
wl 4
mu 40,6,40
mu 41,6,41
mvaac 36,232,12
wl 3
mu 42,6,42
mu 43,6,43
mvaac 36,236,24
cv 152,40,41
cv 153,42,43
mvaaz 40,228,4
mu 44,7,44
mu 45,7,45
mvaac 40,232,16
wl 2
mu 46,7,46
mu 47,7,47
mvaac 36,240,36
cv 156,44,45
cv 157,46,47
mvaaz 44,228,8
ra 228,4,6144
mu 48,5,48
mvaac 44,232,20
ra 232,4,7168
mu 49,5,49
mvaac 40,236,28
mu 50,5,50
mu 51,5,51
mvaac 40,240,40
cv 150,48,49
cv 151,50,51
mvaac 44,236,32
ra 236,4,8192
mu 52,6,52
mvaac 44,240,44
wl 4
ra 240,4,9216
mu 53,6,53
mvaac 36,244,48
wl 4
dm 1,12,25,0
mvaac 36,248,60
s_add_u32 m0, s22, 0x1000
s_add_u32 s24, s24, 0x6000
mu 54,6,54
mvaac 40,244,52
mu 55,6,55
cv 154,52,53
mvaac 40,248,64
cv 155,54,55
mu 56,7,56
mvaac 44,244,56
ra 244,4,10240
mu 57,7,57
mvaac 44,248,68
wl 4
ra 248,4,11264
mu 58,7,58
mvaac 36,228,72
wl 4
mu 59,7,59
cv 158,56,57
mvaac 36,232,84
cv 159,58,59
s_add_u32 s22, s29, s23
mvaac 40,228,76
aw 170,34
aw 171,35
mvaac 40,232,88
dm 1,12,25,1024
mvaac 44,228,80
ra 228,4,12288
s_mov_b32 m0, s22
mvaac 44,232,92
ra 232,4,13312
wv 6
s_barrier
wl 5
mvaac 36,236,96
wl 4
s_add_u32 s25, s24, 0x1000
cv 34,232,233
cv 35,234,235
mvaac 36,240,108
aw 148,34
aw 149,35
mvaac 40,236,100
cv 34,236,237
cv 35,238,239
mvaac 40,240,112
aw 150,34
aw 151,35
mvaac 44,236,104
ra 236,4,14336
cv 34,240,241
mvaac 44,240,116
wl 4
ra 240,4,15360
cv 35,242,243
mvaac 36,244,120
wl 4
aw 160,34
aw 161,35
mvaac 36,248,132
cv 34,244,245
cv 35,246,247
mvaac 40,244,124
aw 162,34
aw 163,35
mvaac 40,248,136
cv 34,184,185
cv 35,186,187
mvaac 44,244,128
ra 244,4,16384
aw 172,34
mvaac 44,248,140
wl 4
ra 248,4,17408
aw 173,35
mvaaz 48,228,0
wl 4
cv 34,188,189
cv 35,190,191
mvaac 48,232,12
aw 174,34
aw 175,35
mvaaz 52,228,4
dm 1,12,24,0
mvaac 52,232,16
s_mov_b32 m0, s22
cv 34,192,193
cv 35,194,195
mvaaz 56,228,8
ra 228,4,18432
aw 152,34
mvaac 56,232,20
wl 4
ra 232,4,19456
aw 153,35
mvaac 48,236,24
wl 4
cv 34,196,197
cv 35,198,199
mvaac 48,240,36
aw 154,34
aw 155,35
mvaac 52,236,28
dm 1,12,24,1024
mvaac 52,240,40
s_mov_b32 m0, s22
cv 34,200,201
cv 35,202,203
mvaac 56,236,32
ra 236,4,20480
aw 164,34
mvaac 56,240,44
wl 4
ra 240,4,21504
aw 165,35
mvaac 48,244,48
wl 4
cv 34,204,205
cv 35,206,207
mvaac 48,248,60
aw 166,34
aw 167,35
mvaac 52,244,52
dm 1,12,24,2048
mvaac 52,248,64
s_mov_b32 m0, s22
cv 34,208,209
cv 35,210,211
mvaac 56,244,56
ra 244,4,22528
aw 176,34
mvaac 56,248,68
wl 4
ra 248,4,23552
aw 177,35
mvaac 48,228,72
wl 4
cv 34,212,213
cv 35,214,215
mvaac 48,232,84
mu 36,5,36
mu 37,5,37
mvaac 52,228,76
dm 1,12,24,3072
mvaac 52,232,88
s_add_u32 m0, s22, 0x1000
mu 38,5,38
mu 39,5,39
mvaac 56,228,80
ra 228,2,0
mu 40,6,40
mvaac 56,232,92
wl 4
ra 232,2,1024
mu 41,6,41
mvaac 48,236,96
wl 4
mu 42,6,42
mu 43,6,43
mvaac 48,240,108
mu 44,7,44
mu 45,7,45
mvaac 52,236,100
dm 1,12,25,0
mvaac 52,240,112
s_add_u32 m0, s22, 0x1000
s_add_u32 s24, s24, 0x6000
mu 46,7,46
mvaac 56,236,104
ra 236,2,2048
mu 47,7,47
mvaac 56,240,116
wl 4
ra 240,2,3072
aw 178,34
mvaac 48,244,120
wl 4
aw 179,35
cv 160,36,37
mvaac 48,248,132
cv 161,38,39
cv 164,40,41
mvaac 52,244,124
dm 1,12,25,1024
mvaac 52,248,136
cv 165,42,43
cv 168,44,45
mvaac 56,244,128
cv 169,46,47
mvaac 56,248,140
s_branch L_b2
L_b1_1:
mvvvz 232,100,172
ds_read_u16 v106, v21 offset:192
ds_read_u16 v114, v21 offset:200
mvvvz 236,108,172
ds_read_u16 v122, v21 offset:256
ds_read_u16 v130, v21 offset:264
mvvvz 240,116,172
ds_read_u16 v138, v21 offset:320
ds_read_u16 v146, v21 offset:328
mvvvz 244,124,172
cv 140,48,49
cv 141,50,51
mvvvz 184,132,172
wl 9
cv 142,52,53
cv 143,54,55
mvaaz 36,228,0
cv 144,56,57
cv 145,58,59
mvvvz 188,140,172
wl 5
ra 244,2,4096
v_max3_f32 v26, v200, v201, v202
mvvvc 232,104,176
wl 5
ra 248,2,5120
v_max3_f32 v26, v26, v203, v204
mvvvc 236,112,176
wl 5
v_max3_f32 v26, v26, v205, v206
v_max3_f32 v26, v26, v207, v208
mvvvc 240,120,176
wl 4
v_max3_f32 v26, v26, v209, v210
v_max3_f32 v26, v26, v211, v212
mvvvc 244,128,176
wl 3
v_mov_b32 v27, v26
s_add_u32 s27, s27, 9
mvvvc 184,136,176
wl 2
v_permlane16_swap_b32 v26, v27
mvvvc 188,144,176
mx 26,26,27
v_mov_b32 v27, v26
mvaac 36,232,12
v_permlane32_swap_b32 v26, v27
mvaaz 40,228,4
mx 26,26,27
v_mul_f32 v28, s61, v26
mvaac 40,232,16
v_fma_f32 v200, v200, s32, v28
v_fma_f32 v201, v201, s32, v28
mvaaz 44,228,8
ra 228,2,6144
v_fma_f32 v202, v202, s32, v28
mvaac 44,232,20
ra 232,2,7168
v_fma_f32 v203, v203, s32, v28
mvaac 36,236,24
ex 200,200
mvaac 36,240,36
ex 201,201
mvaac 40,236,28
ex 202,202
mvaac 40,240,40
ex 203,203
mvaac 44,236,32
ra 236,2,8192
v_fma_f32 v204, v204, s32, v28
mvaac 44,240,44
wl 4
ra 240,2,9216
v_fma_f32 v205, v205, s32, v28
mvaac 36,244,48
wl 4
ex 204,204
mvaac 36,248,60
ad 249,200,201
v_fma_f32 v206, v206, s32, v28
mvaac 40,244,52
ex 205,205
mvaac 40,248,64
ad 249,249,202
v_fma_f32 v207, v207, s32, v28
mvaac 44,244,56
ra 244,2,10240
ad 249,249,203
mvaac 44,248,68
wl 4
ra 248,2,11264
v_fma_f32 v208, v208, s32, v28
mvaac 36,228,72
wl 4
ex 206,206
mvaac 36,232,84
ex 207,207
mvaac 40,228,76
ad 249,249,204
v_fma_f32 v209, v209, s32, v28
mvaac 40,232,88
ex 208,208
mvaac 44,228,80
ra 228,2,12288
ad 249,249,205
mvaac 44,232,92
wl 4
ra 232,2,13312
v_fma_f32 v210, v210, s32, v28
mvaac 36,236,96
wl 4
ex 209,209
mvaac 36,240,108
ad 249,249,206
v_fma_f32 v211, v211, s32, v28
mvaac 40,236,100
ex 210,210
mvaac 40,240,112
v_fma_f32 v212, v212, s32, v28
ad 249,249,207
mvaac 44,236,104
ra 236,2,14336
ad 249,249,208
mvaac 44,240,116
wl 4
ra 240,2,15360
ad 249,249,209
mvaac 36,244,120
wl 4
ex 211,211
mvaac 36,248,132
ex 212,212
mvaac 40,244,124
ad 249,249,210
mu 212,23,212
mvaac 40,248,136
ad 249,249,211
ad 249,249,212
mvaac 44,244,128
ra 244,2,16384
v_mov_b32 v32, v249
mvaac 44,248,140
ra 248,2,17408
mu 200,8,200
mvvvz 192,100,148
v_permlane16_swap_b32 v249, v32
mvvvc 192,104,152
ad 249,249,32
v_mov_b32 v32, v249
mvvvz 196,108,148
v_permlane32_swap_b32 v249, v32
mvvvc 196,112,152
wl 5
ad 249,249,32
v_rcp_f32 v249, v249
mvaaz 48,228,0
wl 4
mu 201,9,201
mu 202,10,202
mvaac 48,232,12
mu 203,11,203
mu 200,249,200
mvaaz 52,228,4
mu 201,249,201
mu 202,249,202
mvaac 52,232,16
mu 203,249,203
cv 156,200,201
mvaaz 56,228,8
ra 228,2,18432
cv 157,202,203
mvvvz 200,116,148
mu 204,12,204
mu 205,13,205
mvvvc 200,120,152
mu 206,14,206
mu 207,15,207
mvaac 56,232,20
wl 4
ra 232,2,19456
mu 204,249,204
mvaac 48,236,24
wl 4
mu 205,249,205
mu 206,249,206
mvaac 48,240,36
mu 207,249,207
cv 158,204,205
mvaac 52,236,28
cv 159,206,207
mu 208,16,208
mvvvz 204,124,148
mu 209,17,209
mu 210,18,210
mvvvc 204,128,152
mu 211,19,211
mu 208,249,208
mvaac 52,240,40
mu 209,249,209
mu 210,249,210
mvaac 56,236,32
ra 236,2,20480
mu 211,249,211
mvaac 56,240,44
wl 4
ra 240,2,21504
cv 160,208,209
mvaac 48,244,48
cv 161,210,211
mu 212,249,212
mvvvz 208,132,148
v_cvt_pk_bf16_f32 v162, v212, 0
s_add_u32 s37, s27, 0
mvvvc 208,136,152
s_and_b32 s37, s37, 3
s_mul_i32 s28, s37, 0x6000
s_add_u32 s37, s27, 1
mvvvz 212,140,148
s_and_b32 s37, s37, 3
s_mul_i32 s29, s37, 0x6000
s_add_u32 s37, s27, 2
mvvvc 212,144,152
wl 4
s_and_b32 s37, s37, 3
s_mul_i32 s30, s37, 0x6000
s_add_u32 s37, s27, 3
mvaac 48,248,60
s_and_b32 s37, s37, 3
s_mul_i32 s31, s37, 0x6000
s_add_u32 s71, s71, 0xc0
mvaac 52,244,52
s_add_u32 s22, s31, s23
s_mov_b32 m0, s22
wv 8
s_barrier
mvaac 52,248,64
cv 34,232,233
dm 1,12,24,0
mvaac 56,244,56
ra 244,2,22528
s_mov_b32 m0, s22
mvaac 56,248,68
wl 4
ra 248,2,23552
cv 35,234,235
mvaac 48,228,72
wl 4
dm 1,12,24,1024
mvaac 48,232,84
s_mov_b32 m0, s22
v_mov_b32 v163, 0
v_add_u32 v3, s29, v1
mvaac 52,228,76
s_mov_b64 exec, s[58:59]
ds_write_b64 v20, v[34:35] offset:192
s_mov_b64 exec, -1
mvaac 52,232,88
cv 34,236,237
cv 35,238,239
mvaac 56,228,80
ra 228,3,0
mu 36,5,36
mvaac 56,232,92
wl 5
ra 232,3,1024
mu 37,5,37
mvaac 48,236,96
wl 5
dm 1,12,24,2048
mvaac 48,240,108
s_mov_b64 exec, s[58:59]
ds_write_b64 v20, v[34:35] offset:200
s_mov_b64 exec, -1
mvaac 52,236,100
cv 34,240,241
cv 35,242,243
mvaac 52,240,112
s_mov_b64 exec, s[58:59]
ds_write_b64 v20, v[34:35] offset:256
s_mov_b64 exec, -1
mvaac 56,236,104
ra 236,3,2048
s_mov_b32 m0, s22
mvaac 56,240,116
wl 7
ra 240,3,3072
cv 34,244,245
mvaac 48,244,120
wl 7
cv 35,246,247
mu 38,5,38
mvaac 48,248,132
s_mov_b64 exec, s[58:59]
ds_write_b64 v20, v[34:35] offset:264
s_mov_b64 exec, -1
mvaac 52,244,124
cv 34,184,185
cv 35,186,187
mvaac 52,248,136
s_mov_b64 exec, s[58:59]
ds_write_b64 v20, v[34:35] offset:320
s_mov_b64 exec, -1
mvaac 56,244,128
ra 244,3,4096
cv 34,188,189
mvaac 56,248,140
ra 248,3,5120
cv 35,190,191
mvvvz 232,100,156
dm 1,12,24,3072
mvvvc 232,104,160
mu 39,5,39
cv 172,36,37
mvvvz 236,108,156
cv 173,38,39
mu 40,6,40
mvvvc 236,112,160
mu 41,6,41
mu 42,6,42
mvvvz 240,116,156
mu 43,6,43
cv 176,40,41
mvvvc 240,120,160
cv 177,42,43
mu 44,7,44
mvvvz 244,124,156
mu 45,7,45
mu 46,7,46
mvvvc 244,128,160
mu 47,7,47
cv 180,44,45
mvvvz 184,132,156
cv 181,46,47
s_add_u32 s25, s24, 0x1000
mvvvc 184,136,160
s_add_u32 m0, s22, 0x1000
mu 48,5,48
mu 49,5,49
mvvvz 188,140,156
mu 50,5,50
mu 51,5,51
mvvvc 188,144,160
wl 9
cv 174,48,49
cv 175,50,51
mvaaz 36,228,0
wl 8
mu 52,6,52
mu 53,6,53
mvaac 36,232,12
mu 54,6,54
mu 55,6,55
mvaaz 40,228,4
cv 178,52,53
cv 179,54,55
mvaac 40,232,16
mu 56,7,56
mu 57,7,57
mvaaz 44,228,8
ra 228,3,6144
mu 58,7,58
mvaac 44,232,20
wl 6
ra 232,3,7168
mu 59,7,59
mvaac 36,236,24
wl 6
cv 182,56,57
cv 183,58,59
mvaac 36,240,36
v_max3_f32 v29, v216, v217, v218
v_max3_f32 v29, v29, v219, v220
mvaac 40,236,28
v_max3_f32 v29, v29, v221, v222
v_max3_f32 v29, v29, v223, v224
mvaac 40,240,40
v_max3_f32 v29, v29, v225, v226
v_max3_f32 v29, v29, v227, v228
mvaac 44,236,32
ra 236,3,8192
v_mov_b32 v30, v29
mvaac 44,240,44
wl 4
ra 240,3,9216
v_mov_b32 v171, 0
mvaac 36,244,48
wl 4
dm 1,12,25,0
mvaac 36,248,60
s_add_u32 m0, s22, 0x1000
s_add_u32 s24, s24, 0x6000
s_add_u32 s22, s28, s23
mvaac 40,244,52
v_permlane16_swap_b32 v29, v30
mvaac 40,248,64
mx 29,29,30
v_mov_b32 v30, v29
mvaac 44,244,56
ra 244,3,10240
v_add_u32 v4, s30, v1
mvaac 44,248,68
wl 4
ra 248,3,11264
v_add_u32 v2, s31, v1
mvaac 36,228,72
wl 4
v_permlane32_swap_b32 v29, v30
mvaac 36,232,84
mx 29,29,30
v_mul_f32 v31, s61, v29
mvaac 40,228,76
v_fma_f32 v216, v216, s32, v31
v_fma_f32 v217, v217, s32, v31
mvaac 40,232,88
dm 1,12,25,1024
mvaac 44,228,80
ra 228,3,12288
s_mov_b32 m0, s22
mvaac 44,232,92
ra 232,3,13312
wv 7
s_barrier
wl 5
mvaac 36,236,96
wl 4
ex 216,216
mvaac 36,240,108
ex 217,217
mvaac 40,236,100
v_fma_f32 v218, v218, s32, v31
v_fma_f32 v219, v219, s32, v31
mvaac 40,240,112
ex 218,218
mvaac 44,236,104
ra 236,3,14336
v_fma_f32 v220, v220, s32, v31
mvaac 44,240,116
wl 4
ra 240,3,15360
v_fma_f32 v221, v221, s32, v31
mvaac 36,244,120
wl 4
ex 219,219
mvaac 36,248,132
ex 220,220
mvaac 40,244,124
ad 250,216,217
v_fma_f32 v222, v222, s32, v31
mvaac 40,248,136
ex 221,221
mvaac 44,244,128
ra 244,3,16384
ad 250,250,218
mvaac 44,248,140
wl 4
ra 248,3,17408
v_fma_f32 v223, v223, s32, v31
mvaaz 48,228,0
wl 4
ex 222,222
mvaac 48,232,12
ad 250,250,219
v_fma_f32 v224, v224, s32, v31
mvaaz 52,228,4
dm 1,12,24,0
mvaac 52,232,16
s_mov_b32 m0, s22
ex 223,223
mvaaz 56,228,8
ra 228,3,18432
ad 250,250,220
mvaac 56,232,20
wl 4
ra 232,3,19456
v_fma_f32 v225, v225, s32, v31
mvaac 48,236,24
wl 4
ex 224,224
mvaac 48,240,36
ad 250,250,221
v_fma_f32 v226, v226, s32, v31
mvaac 52,236,28
ex 225,225
mvaac 52,240,40
ad 250,250,222
v_fma_f32 v227, v227, s32, v31
mvaac 56,236,32
ra 236,3,20480
v_fma_f32 v228, v228, s32, v31
mvaac 56,240,44
wl 4
ra 240,3,21504
ad 250,250,223
mvaac 48,244,48
wl 4
ex 226,226
mvaac 48,248,60
dm 1,12,24,1024
mvaac 52,244,52
s_mov_b32 m0, s22
ex 227,227
mvaac 52,248,64
ex 228,228
mvaac 56,244,56
ra 244,3,22528
ad 250,250,224
mvaac 56,248,68
wl 4
ra 248,3,23552
ad 250,250,225
mvaac 48,228,72
wl 4
ad 250,250,226
mu 228,23,228
mvaac 48,232,84
ad 250,250,227
ad 250,250,228
mvaac 52,228,76
v_mov_b32 v32, v250
mu 216,8,216
mvaac 52,232,88
s_mov_b64 exec, s[58:59]
ds_write_b64 v20, v[34:35] offset:328
s_mov_b64 exec, -1
mvaac 56,228,80
ra 228,4,0
mu 217,9,217
mvaac 56,232,92
wl 5
ra 232,4,1024
mu 218,10,218
mvaac 48,236,96
wl 5
dm 1,12,24,2048
mvaac 48,240,108
v_permlane16_swap_b32 v250, v32
mvaac 52,236,100
ad 250,250,32
v_mov_b32 v32, v250
mvaac 52,240,112
v_permlane32_swap_b32 v250, v32
mvaac 56,236,104
ra 236,4,2048
ad 250,250,32
mvaac 56,240,116
wl 5
ra 240,4,3072
mu 219,11,219
mvaac 48,244,120
wl 5
v_rcp_f32 v250, v250
mvaac 48,248,132
mu 220,12,220
mu 221,13,221
mvaac 52,244,124
mu 222,14,222
mu 223,15,223
mvaac 52,248,136
mu 216,250,216
mu 217,250,217
mvaac 56,244,128
ra 244,4,4096
mu 218,250,218
mvaac 56,248,140
s_mov_b32 m0, s22
ra 248,4,5120
mu 219,250,219
mu 220,250,220
mu 221,250,221
mu 222,250,222
mu 223,250,223
cv 164,216,217
cv 165,218,219
cv 166,220,221
cv 167,222,223
mu 224,16,224
mu 225,17,225
mu 226,18,226
mu 227,19,227
cv 34,192,193
cv 35,194,195
mvvvz 192,100,164
s_add_u32 s25, s24, 0x1000
mu 224,250,224
mu 225,250,225
mu 226,250,226
mu 227,250,227
mu 228,250,228
cv 168,224,225
cv 169,226,227
v_cvt_pk_bf16_f32 v170, v228, 0
aw 192,34
aw 193,35
mvvvc 192,104,168
cv 34,196,197
cv 35,198,199
mvvvz 196,108,164
dm 1,12,24,3072
mvvvc 196,112,168
s_add_u32 m0, s22, 0x1000
aw 194,34
aw 195,35
cv 34,200,201
cv 35,202,203
mvvvz 200,116,164
aw 204,34
aw 205,35
mvvvc 200,120,168
cv 34,204,205
cv 35,206,207
mvvvz 204,124,164
aw 206,34
aw 207,35
mvvvc 204,128,168
cv 34,208,209
cv 35,210,211
mvvvz 208,132,164
aw 216,34
aw 217,35
mvvvc 208,136,168
cv 34,212,213
cv 35,214,215
mvvvz 212,140,164
mu 36,5,36
mu 37,5,37
mvvvc 212,144,168
mu 38,5,38
mu 39,5,39
cv 148,36,37
cv 149,38,39
wl 5
mvaaz 36,228,0
wl 4
mu 40,6,40
mu 41,6,41
mvaac 36,232,12
wl 3
mu 42,6,42
mu 43,6,43
mvaac 36,236,24
cv 152,40,41
cv 153,42,43
mvaaz 40,228,4
mu 44,7,44
mu 45,7,45
mvaac 40,232,16
wl 2
mu 46,7,46
mu 47,7,47
mvaac 36,240,36
cv 156,44,45
cv 157,46,47
mvaaz 44,228,8
ra 228,4,6144
mu 48,5,48
mvaac 44,232,20
ra 232,4,7168
mu 49,5,49
mvaac 40,236,28
mu 50,5,50
mu 51,5,51
mvaac 40,240,40
cv 150,48,49
cv 151,50,51
mvaac 44,236,32
ra 236,4,8192
mu 52,6,52
mvaac 44,240,44
wl 4
ra 240,4,9216
mu 53,6,53
mvaac 36,244,48
wl 4
dm 1,12,25,0
mvaac 36,248,60
s_add_u32 m0, s22, 0x1000
s_add_u32 s24, s24, 0x6000
mu 54,6,54
mvaac 40,244,52
mu 55,6,55
cv 154,52,53
mvaac 40,248,64
cv 155,54,55
mu 56,7,56
mvaac 44,244,56
ra 244,4,10240
mu 57,7,57
mvaac 44,248,68
wl 4
ra 248,4,11264
mu 58,7,58
mvaac 36,228,72
wl 4
mu 59,7,59
cv 158,56,57
mvaac 36,232,84
cv 159,58,59
s_add_u32 s22, s29, s23
mvaac 40,228,76
aw 218,34
aw 219,35
mvaac 40,232,88
dm 1,12,25,1024
mvaac 44,228,80
ra 228,4,12288
s_mov_b32 m0, s22
mvaac 44,232,92
ra 232,4,13312
wv 6
s_barrier
wl 5
mvaac 36,236,96
wl 4
s_add_u32 s25, s24, 0x1000
cv 34,232,233
cv 35,234,235
mvaac 36,240,108
aw 196,34
aw 197,35
mvaac 40,236,100
cv 34,236,237
cv 35,238,239
mvaac 40,240,112
aw 198,34
aw 199,35
mvaac 44,236,104
ra 236,4,14336
cv 34,240,241
mvaac 44,240,116
wl 4
ra 240,4,15360
cv 35,242,243
mvaac 36,244,120
wl 4
aw 208,34
aw 209,35
mvaac 36,248,132
cv 34,244,245
cv 35,246,247
mvaac 40,244,124
aw 210,34
aw 211,35
mvaac 40,248,136
cv 34,184,185
cv 35,186,187
mvaac 44,244,128
ra 244,4,16384
aw 220,34
mvaac 44,248,140
wl 4
ra 248,4,17408
aw 221,35
mvaaz 48,228,0
wl 4
cv 34,188,189
cv 35,190,191
mvaac 48,232,12
aw 222,34
aw 223,35
mvaaz 52,228,4
dm 1,12,24,0
mvaac 52,232,16
s_mov_b32 m0, s22
cv 34,192,193
cv 35,194,195
mvaaz 56,228,8
ra 228,4,18432
aw 200,34
mvaac 56,232,20
wl 4
ra 232,4,19456
aw 201,35
mvaac 48,236,24
wl 4
cv 34,196,197
cv 35,198,199
mvaac 48,240,36
aw 202,34
aw 203,35
mvaac 52,236,28
dm 1,12,24,1024
mvaac 52,240,40
s_mov_b32 m0, s22
cv 34,200,201
cv 35,202,203
mvaac 56,236,32
ra 236,4,20480
aw 212,34
mvaac 56,240,44
wl 4
ra 240,4,21504
aw 213,35
mvaac 48,244,48
wl 4
cv 34,204,205
cv 35,206,207
mvaac 48,248,60
aw 214,34
aw 215,35
mvaac 52,244,52
dm 1,12,24,2048
mvaac 52,248,64
s_mov_b32 m0, s22
cv 34,208,209
cv 35,210,211
mvaac 56,244,56
ra 244,4,22528
aw 224,34
mvaac 56,248,68
wl 4
ra 248,4,23552
aw 225,35
mvaac 48,228,72
wl 4
cv 34,212,213
cv 35,214,215
mvaac 48,232,84
mu 36,5,36
mu 37,5,37
mvaac 52,228,76
dm 1,12,24,3072
mvaac 52,232,88
s_add_u32 m0, s22, 0x1000
mu 38,5,38
mu 39,5,39
mvaac 56,228,80
ra 228,2,0
mu 40,6,40
mvaac 56,232,92
wl 4
ra 232,2,1024
mu 41,6,41
mvaac 48,236,96
wl 4
mu 42,6,42
mu 43,6,43
mvaac 48,240,108
mu 44,7,44
mu 45,7,45
mvaac 52,236,100
dm 1,12,25,0
mvaac 52,240,112
s_add_u32 m0, s22, 0x1000
s_add_u32 s24, s24, 0x6000
mu 46,7,46
mvaac 56,236,104
ra 236,2,2048
mu 47,7,47
mvaac 56,240,116
wl 4
ra 240,2,3072
aw 226,34
mvaac 48,244,120
wl 4
aw 227,35
cv 160,36,37
mvaac 48,248,132
cv 161,38,39
cv 164,40,41
mvaac 52,244,124
dm 1,12,25,1024
mvaac 52,248,136
cv 165,42,43
cv 168,44,45
mvaac 56,244,128
cv 169,46,47
mvaac 56,248,140
s_branch L_b2
L_b1_2:
mvvvz 232,100,172
ds_read_u16 v106, v21 offset:384
ds_read_u16 v114, v21 offset:392
mvvvz 236,108,172
ds_read_u16 v122, v21 offset:448
ds_read_u16 v130, v21 offset:456
mvvvz 240,116,172
ds_read_u16 v138, v21 offset:512
ds_read_u16 v146, v21 offset:520
mvvvz 244,124,172
cv 140,48,49
cv 141,50,51
mvvvz 184,132,172
wl 9
cv 142,52,53
cv 143,54,55
mvaaz 36,228,0
cv 144,56,57
cv 145,58,59
mvvvz 188,140,172
wl 5
ra 244,2,4096
v_max3_f32 v26, v200, v201, v202
mvvvc 232,104,176
wl 5
ra 248,2,5120
v_max3_f32 v26, v26, v203, v204
mvvvc 236,112,176
wl 5
v_max3_f32 v26, v26, v205, v206
v_max3_f32 v26, v26, v207, v208
mvvvc 240,120,176
wl 4
v_max3_f32 v26, v26, v209, v210
v_max3_f32 v26, v26, v211, v212
mvvvc 244,128,176
wl 3
v_mov_b32 v27, v26
s_add_u32 s27, s27, 9
mvvvc 184,136,176
wl 2
v_permlane16_swap_b32 v26, v27
mvvvc 188,144,176
mx 26,26,27
v_mov_b32 v27, v26
mvaac 36,232,12
v_permlane32_swap_b32 v26, v27
mvaaz 40,228,4
mx 26,26,27
v_mul_f32 v28, s61, v26
mvaac 40,232,16
v_fma_f32 v200, v200, s32, v28
v_fma_f32 v201, v201, s32, v28
mvaaz 44,228,8
ra 228,2,6144
v_fma_f32 v202, v202, s32, v28
mvaac 44,232,20
ra 232,2,7168
v_fma_f32 v203, v203, s32, v28
mvaac 36,236,24
ex 200,200
mvaac 36,240,36
ex 201,201
mvaac 40,236,28
ex 202,202
mvaac 40,240,40
ex 203,203
mvaac 44,236,32
ra 236,2,8192
v_fma_f32 v204, v204, s32, v28
mvaac 44,240,44
wl 4
ra 240,2,9216
v_fma_f32 v205, v205, s32, v28
mvaac 36,244,48
wl 4
ex 204,204
mvaac 36,248,60
ad 249,200,201
v_fma_f32 v206, v206, s32, v28
mvaac 40,244,52
ex 205,205
mvaac 40,248,64
ad 249,249,202
v_fma_f32 v207, v207, s32, v28
mvaac 44,244,56
ra 244,2,10240
ad 249,249,203
mvaac 44,248,68
wl 4
ra 248,2,11264
v_fma_f32 v208, v208, s32, v28
mvaac 36,228,72
wl 4
ex 206,206
mvaac 36,232,84
ex 207,207
mvaac 40,228,76
ad 249,249,204
v_fma_f32 v209, v209, s32, v28
mvaac 40,232,88
ex 208,208
mvaac 44,228,80
ra 228,2,12288
ad 249,249,205
mvaac 44,232,92
wl 4
ra 232,2,13312
v_fma_f32 v210, v210, s32, v28
mvaac 36,236,96
wl 4
ex 209,209
mvaac 36,240,108
ad 249,249,206
v_fma_f32 v211, v211, s32, v28
mvaac 40,236,100
ex 210,210
mvaac 40,240,112
v_fma_f32 v212, v212, s32, v28
ad 249,249,207
mvaac 44,236,104
ra 236,2,14336
ad 249,249,208
mvaac 44,240,116
wl 4
ra 240,2,15360
ad 249,249,209
mvaac 36,244,120
wl 4
ex 211,211
mvaac 36,248,132
ex 212,212
mvaac 40,244,124
ad 249,249,210
mu 212,23,212
mvaac 40,248,136
ad 249,249,211
ad 249,249,212
mvaac 44,244,128
ra 244,2,16384
v_mov_b32 v32, v249
mvaac 44,248,140
ra 248,2,17408
mu 200,8,200
mvvvz 192,100,148
v_permlane16_swap_b32 v249, v32
mvvvc 192,104,152
ad 249,249,32
v_mov_b32 v32, v249
mvvvz 196,108,148
v_permlane32_swap_b32 v249, v32
mvvvc 196,112,152
wl 5
ad 249,249,32
v_rcp_f32 v249, v249
mvaaz 48,228,0
wl 4
mu 201,9,201
mu 202,10,202
mvaac 48,232,12
mu 203,11,203
mu 200,249,200
mvaaz 52,228,4
mu 201,249,201
mu 202,249,202
mvaac 52,232,16
mu 203,249,203
cv 156,200,201
mvaaz 56,228,8
ra 228,2,18432
cv 157,202,203
mvvvz 200,116,148
mu 204,12,204
mu 205,13,205
mvvvc 200,120,152
mu 206,14,206
mu 207,15,207
mvaac 56,232,20
wl 4
ra 232,2,19456
mu 204,249,204
mvaac 48,236,24
wl 4
mu 205,249,205
mu 206,249,206
mvaac 48,240,36
mu 207,249,207
cv 158,204,205
mvaac 52,236,28
cv 159,206,207
mu 208,16,208
mvvvz 204,124,148
mu 209,17,209
mu 210,18,210
mvvvc 204,128,152
mu 211,19,211
mu 208,249,208
mvaac 52,240,40
mu 209,249,209
mu 210,249,210
mvaac 56,236,32
ra 236,2,20480
mu 211,249,211
mvaac 56,240,44
wl 4
ra 240,2,21504
cv 160,208,209
mvaac 48,244,48
cv 161,210,211
mu 212,249,212
mvvvz 208,132,148
v_cvt_pk_bf16_f32 v162, v212, 0
s_add_u32 s37, s27, 0
mvvvc 208,136,152
s_and_b32 s37, s37, 3
s_mul_i32 s28, s37, 0x6000
s_add_u32 s37, s27, 1
mvvvz 212,140,148
s_and_b32 s37, s37, 3
s_mul_i32 s29, s37, 0x6000
s_add_u32 s37, s27, 2
mvvvc 212,144,152
wl 4
s_and_b32 s37, s37, 3
s_mul_i32 s30, s37, 0x6000
s_add_u32 s37, s27, 3
mvaac 48,248,60
s_and_b32 s37, s37, 3
s_mul_i32 s31, s37, 0x6000
s_add_u32 s71, s71, 0xc0
mvaac 52,244,52
s_add_u32 s22, s31, s23
s_mov_b32 m0, s22
wv 8
s_barrier
mvaac 52,248,64
cv 34,232,233
dm 1,12,24,0
mvaac 56,244,56
ra 244,2,22528
s_mov_b32 m0, s22
mvaac 56,248,68
wl 4
ra 248,2,23552
cv 35,234,235
mvaac 48,228,72
wl 4
dm 1,12,24,1024
mvaac 48,232,84
s_mov_b32 m0, s22
v_mov_b32 v163, 0
v_add_u32 v3, s29, v1
mvaac 52,228,76
s_mov_b64 exec, s[58:59]
ds_write_b64 v20, v[34:35] offset:384
s_mov_b64 exec, -1
mvaac 52,232,88
cv 34,236,237
cv 35,238,239
mvaac 56,228,80
ra 228,3,0
mu 36,5,36
mvaac 56,232,92
wl 5
ra 232,3,1024
mu 37,5,37
mvaac 48,236,96
wl 5
dm 1,12,24,2048
mvaac 48,240,108
s_mov_b64 exec, s[58:59]
ds_write_b64 v20, v[34:35] offset:392
s_mov_b64 exec, -1
mvaac 52,236,100
cv 34,240,241
cv 35,242,243
mvaac 52,240,112
s_mov_b64 exec, s[58:59]
ds_write_b64 v20, v[34:35] offset:448
s_mov_b64 exec, -1
mvaac 56,236,104
ra 236,3,2048
s_mov_b32 m0, s22
mvaac 56,240,116
wl 7
ra 240,3,3072
cv 34,244,245
mvaac 48,244,120
wl 7
cv 35,246,247
mu 38,5,38
mvaac 48,248,132
s_mov_b64 exec, s[58:59]
ds_write_b64 v20, v[34:35] offset:456
s_mov_b64 exec, -1
mvaac 52,244,124
cv 34,184,185
cv 35,186,187
mvaac 52,248,136
s_mov_b64 exec, s[58:59]
ds_write_b64 v20, v[34:35] offset:512
s_mov_b64 exec, -1
mvaac 56,244,128
ra 244,3,4096
cv 34,188,189
mvaac 56,248,140
ra 248,3,5120
cv 35,190,191
mvvvz 232,100,156
dm 1,12,24,3072
mvvvc 232,104,160
mu 39,5,39
cv 172,36,37
mvvvz 236,108,156
cv 173,38,39
mu 40,6,40
mvvvc 236,112,160
mu 41,6,41
mu 42,6,42
mvvvz 240,116,156
mu 43,6,43
cv 176,40,41
mvvvc 240,120,160
cv 177,42,43
mu 44,7,44
mvvvz 244,124,156
mu 45,7,45
mu 46,7,46
mvvvc 244,128,160
mu 47,7,47
cv 180,44,45
mvvvz 184,132,156
cv 181,46,47
s_add_u32 s25, s24, 0x1000
mvvvc 184,136,160
s_add_u32 m0, s22, 0x1000
mu 48,5,48
mu 49,5,49
mvvvz 188,140,156
mu 50,5,50
mu 51,5,51
mvvvc 188,144,160
wl 9
cv 174,48,49
cv 175,50,51
mvaaz 36,228,0
wl 8
mu 52,6,52
mu 53,6,53
mvaac 36,232,12
mu 54,6,54
mu 55,6,55
mvaaz 40,228,4
cv 178,52,53
cv 179,54,55
mvaac 40,232,16
mu 56,7,56
mu 57,7,57
mvaaz 44,228,8
ra 228,3,6144
mu 58,7,58
mvaac 44,232,20
wl 6
ra 232,3,7168
mu 59,7,59
mvaac 36,236,24
wl 6
cv 182,56,57
cv 183,58,59
mvaac 36,240,36
v_max3_f32 v29, v216, v217, v218
v_max3_f32 v29, v29, v219, v220
mvaac 40,236,28
v_max3_f32 v29, v29, v221, v222
v_max3_f32 v29, v29, v223, v224
mvaac 40,240,40
v_max3_f32 v29, v29, v225, v226
v_max3_f32 v29, v29, v227, v228
mvaac 44,236,32
ra 236,3,8192
v_mov_b32 v30, v29
mvaac 44,240,44
wl 4
ra 240,3,9216
cv 64,192,193
mvaac 36,244,48
wl 4
dm 1,12,25,0
mvaac 36,248,60
s_add_u32 m0, s22, 0x1000
s_add_u32 s24, s24, 0x6000
s_add_u32 s22, s28, s23
mvaac 40,244,52
v_permlane16_swap_b32 v29, v30
mvaac 40,248,64
mx 29,29,30
v_mov_b32 v30, v29
mvaac 44,244,56
ra 244,3,10240
cv 65,194,195
mvaac 44,248,68
wl 4
ra 248,3,11264
v_mov_b32 v171, 0
mvaac 36,228,72
wl 4
v_permlane32_swap_b32 v29, v30
mvaac 36,232,84
mx 29,29,30
v_mul_f32 v31, s61, v29
mvaac 40,228,76
v_fma_f32 v216, v216, s32, v31
v_fma_f32 v217, v217, s32, v31
mvaac 40,232,88
dm 1,12,25,1024
mvaac 44,228,80
ra 228,3,12288
s_mov_b32 m0, s22
mvaac 44,232,92
ra 232,3,13312
wv 7
s_barrier
wl 5
mvaac 36,236,96
wl 4
ex 216,216
mvaac 36,240,108
ex 217,217
mvaac 40,236,100
v_fma_f32 v218, v218, s32, v31
v_fma_f32 v219, v219, s32, v31
mvaac 40,240,112
ex 218,218
mvaac 44,236,104
ra 236,3,14336
v_fma_f32 v220, v220, s32, v31
mvaac 44,240,116
wl 4
ra 240,3,15360
v_fma_f32 v221, v221, s32, v31
mvaac 36,244,120
wl 4
ex 219,219
mvaac 36,248,132
ex 220,220
mvaac 40,244,124
ad 250,216,217
v_fma_f32 v222, v222, s32, v31
mvaac 40,248,136
ex 221,221
mvaac 44,244,128
ra 244,3,16384
ad 250,250,218
mvaac 44,248,140
wl 4
ra 248,3,17408
v_fma_f32 v223, v223, s32, v31
mvaaz 48,228,0
wl 4
ex 222,222
mvaac 48,232,12
ad 250,250,219
v_fma_f32 v224, v224, s32, v31
mvaaz 52,228,4
dm 1,12,24,0
mvaac 52,232,16
s_mov_b32 m0, s22
ex 223,223
mvaaz 56,228,8
ra 228,3,18432
ad 250,250,220
mvaac 56,232,20
wl 4
ra 232,3,19456
v_fma_f32 v225, v225, s32, v31
mvaac 48,236,24
wl 4
ex 224,224
mvaac 48,240,36
ad 250,250,221
v_fma_f32 v226, v226, s32, v31
mvaac 52,236,28
ex 225,225
mvaac 52,240,40
ad 250,250,222
v_fma_f32 v227, v227, s32, v31
mvaac 56,236,32
ra 236,3,20480
v_fma_f32 v228, v228, s32, v31
mvaac 56,240,44
wl 4
ra 240,3,21504
ad 250,250,223
mvaac 48,244,48
wl 4
ex 226,226
mvaac 48,248,60
dm 1,12,24,1024
mvaac 52,244,52
s_mov_b32 m0, s22
ex 227,227
mvaac 52,248,64
ex 228,228
mvaac 56,244,56
ra 244,3,22528
ad 250,250,224
mvaac 56,248,68
wl 4
ra 248,3,23552
ad 250,250,225
mvaac 48,228,72
wl 4
ad 250,250,226
mu 228,23,228
mvaac 48,232,84
ad 250,250,227
ad 250,250,228
mvaac 52,228,76
v_mov_b32 v32, v250
mu 216,8,216
mvaac 52,232,88
v_permlane16_swap_b32 v250, v32
mvaac 56,228,80
ad 250,250,32
v_mov_b32 v32, v250
mvaac 56,232,92
wl 3
v_permlane32_swap_b32 v250, v32
mvaac 48,236,96
wl 2
dm 1,12,24,2048
mvaac 48,240,108
ad 250,250,32
mu 217,9,217
mvaac 52,236,100
v_rcp_f32 v250, v250
mvaac 52,240,112
mu 218,10,218
mu 219,11,219
mvaac 56,236,104
mu 220,12,220
mu 221,13,221
mvaac 56,240,116
wl 1
mu 222,14,222
mu 223,15,223
mvaac 48,244,120
wl 0
mu 216,250,216
mu 217,250,217
mvaac 48,248,132
mu 218,250,218
mu 219,250,219
mvaac 52,244,124
mu 220,250,220
mu 221,250,221
mvaac 52,248,136
mu 222,250,222
mu 223,250,223
mvaac 56,244,128
cv 164,216,217
cv 165,218,219
mvaac 56,248,140
s_mov_b32 m0, s22
cv 166,220,221
cv 167,222,223
mu 224,16,224
mu 225,17,225
mvvvz 192,100,164
s_add_u32 s25, s24, 0x1000
mu 226,18,226
mu 227,19,227
mu 224,250,224
mu 225,250,225
mu 226,250,226
mu 227,250,227
mu 228,250,228
cv 168,224,225
cv 169,226,227
v_cvt_pk_bf16_f32 v170, v228, 0
cv 66,196,197
cv 67,198,199
mvvvc 192,104,168
dm 1,12,24,3072
mvvvz 196,108,164
cv 76,200,201
cv 77,202,203
mvvvc 196,112,168
v_add_u32 v4, s30, v1
cv 78,204,205
mvvvz 200,116,164
ra 228,4,0
cv 79,206,207
mvvvc 200,120,168
ra 232,4,1024
cv 88,208,209
mvvvz 204,124,164
ra 236,4,2048
cv 89,210,211
mvvvc 204,128,168
ra 240,4,3072
cv 90,212,213
mvvvz 208,132,164
ra 244,4,4096
cv 91,214,215
mvvvc 208,136,168
ra 248,4,5120
mu 36,5,36
mvvvz 212,140,164
mu 37,5,37
mu 38,5,38
mvvvc 212,144,168
s_add_u32 m0, s22, 0x1000
mu 39,5,39
cv 148,36,37
cv 149,38,39
wl 5
mvaaz 36,228,0
wl 4
mu 40,6,40
mu 41,6,41
mvaac 36,232,12
wl 3
mu 42,6,42
mu 43,6,43
mvaac 36,236,24
cv 152,40,41
cv 153,42,43
mvaaz 40,228,4
mu 44,7,44
mu 45,7,45
mvaac 40,232,16
wl 2
mu 46,7,46
mu 47,7,47
mvaac 36,240,36
cv 156,44,45
cv 157,46,47
mvaaz 44,228,8
ra 228,4,6144
mu 48,5,48
mvaac 44,232,20
ra 232,4,7168
mu 49,5,49
mvaac 40,236,28
mu 50,5,50
mu 51,5,51
mvaac 40,240,40
cv 150,48,49
cv 151,50,51
mvaac 44,236,32
ra 236,4,8192
mu 52,6,52
mvaac 44,240,44
wl 4
ra 240,4,9216
mu 53,6,53
mvaac 36,244,48
wl 4
dm 1,12,25,0
mvaac 36,248,60
s_add_u32 m0, s22, 0x1000
s_add_u32 s24, s24, 0x6000
mu 54,6,54
mvaac 40,244,52
mu 55,6,55
cv 154,52,53
mvaac 40,248,64
cv 155,54,55
mu 56,7,56
mvaac 44,244,56
ra 244,4,10240
mu 57,7,57
mvaac 44,248,68
wl 4
ra 248,4,11264
mu 58,7,58
mvaac 36,228,72
wl 4
mu 59,7,59
cv 158,56,57
mvaac 36,232,84
cv 159,58,59
s_add_u32 s22, s29, s23
mvaac 40,228,76
s_mov_b64 exec, s[58:59]
ds_write_b64 v20, v[34:35] offset:520
s_mov_b64 exec, -1
mvaac 40,232,88
dm 1,12,25,1024
mvaac 44,228,80
ra 228,4,12288
s_mov_b32 m0, s22
mvaac 44,232,92
ra 232,4,13312
wv 6
s_barrier
wl 6
mvaac 36,236,96
wl 5
s_add_u32 s25, s24, 0x1000
v_add_u32 v2, s31, v1
cv 68,232,233
mvaac 36,240,108
cv 69,234,235
cv 70,236,237
mvaac 40,236,100
cv 71,238,239
cv 80,240,241
mvaac 40,240,112
cv 81,242,243
cv 82,244,245
mvaac 44,236,104
ra 236,4,14336
cv 83,246,247
mvaac 44,240,116
wl 5
ra 240,4,15360
cv 92,184,185
mvaac 36,244,120
wl 5
cv 93,186,187
cv 94,188,189
mvaac 36,248,132
cv 95,190,191
cv 72,192,193
mvaac 40,244,124
cv 73,194,195
cv 74,196,197
mvaac 40,248,136
mu 36,5,36
mu 37,5,37
mvaac 44,244,128
ra 244,4,16384
mu 38,5,38
mvaac 44,248,140
wl 4
ra 248,4,17408
mu 39,5,39
mvaaz 48,228,0
wl 4
mu 40,6,40
mu 41,6,41
mvaac 48,232,12
mu 42,6,42
mu 43,6,43
mvaaz 52,228,4
dm 1,12,24,0
mvaac 52,232,16
s_mov_b32 m0, s22
mu 44,7,44
mu 45,7,45
mvaaz 56,228,8
ra 228,4,18432
mu 46,7,46
mvaac 56,232,20
wl 4
ra 232,4,19456
mu 47,7,47
mvaac 48,236,24
wl 4
cv 75,198,199
cv 84,200,201
mvaac 48,240,36
cv 85,202,203
cv 86,204,205
mvaac 52,236,28
dm 1,12,24,1024
mvaac 52,240,40
s_mov_b32 m0, s22
cv 87,206,207
cv 96,208,209
mvaac 56,236,32
ra 236,4,20480
cv 97,210,211
mvaac 56,240,44
wl 4
ra 240,4,21504
cv 98,212,213
mvaac 48,244,48
wl 4
cv 99,214,215
cv 160,36,37
mvaac 48,248,60
cv 161,38,39
cv 164,40,41
mvaac 52,244,52
dm 1,12,24,2048
mvaac 52,248,64
s_mov_b32 m0, s22
cv 165,42,43
cv 168,44,45
mvaac 56,244,56
ra 244,4,22528
cv 169,46,47
mvaac 56,248,68
wl 4
ra 248,4,23552
mvaac 48,228,72
wl 4
mvaac 48,232,84
mvaac 52,228,76
dm 1,12,24,3072
mvaac 52,232,88
s_add_u32 m0, s22, 0x1000
mvaac 56,228,80
ra 228,2,0
mvaac 56,232,92
wl 4
ra 232,2,1024
mvaac 48,236,96
wl 4
mvaac 48,240,108
mvaac 52,236,100
dm 1,12,25,0
mvaac 52,240,112
s_add_u32 m0, s22, 0x1000
s_add_u32 s24, s24, 0x6000
mvaac 56,236,104
ra 236,2,2048
mvaac 56,240,116
wl 4
ra 240,2,3072
mvaac 48,244,120
wl 4
mvaac 48,248,132
mvaac 52,244,124
dm 1,12,25,1024
mvaac 52,248,136
mvaac 56,244,128
mvaac 56,248,140
L_b2:
wl 3
mvaaz 36,228,0
wl 2
ra 244,2,4096
mu 48,5,48
mvaac 36,232,12
ra 248,2,5120
mu 49,5,49
mvaaz 40,228,4
mu 50,5,50
mu 51,5,51
mvaac 40,232,16
cv 162,48,49
cv 163,50,51
mvaaz 44,228,8
ra 228,2,6144
s_mov_b32 s98, L_b1_a-L_cp3
mvaac 44,232,20
wl 4
ra 232,2,7168
s_mov_b32 s99, L_b2-L_b1_a
mvaac 36,236,24
wl 4
s_mov_b32 s100, L_out-L_cp3
s_mov_b32 s101, L_codeend-L_out
s_cmp_eq_u32 s71, 0x240
mvaac 36,240,36
s_cselect_b32 s98, s100, s98
s_cselect_b32 s99, s101, s99
s_getpc_b64 s[96:97]
L_cp3:
mvaac 40,236,28
s_ashr_i32 s100, s98, 31
s_add_u32 s96, s96, s98
mu 52,6,52
mvaac 40,240,40
mu 53,6,53
mu 54,6,54
mvaac 44,236,32
ra 236,2,8192
mu 55,6,55
mvaac 44,240,44
wl 4
ra 240,2,9216
s_addc_u32 s97, s97, s100
mvaac 36,244,48
wl 4
cv 166,52,53
cv 167,54,55
mvaac 36,248,60
s_lshr_b32 s100, s2, 3
s_and_b32 s100, s100, 31
s_lshl_b32 s100, s100, 13
mvaac 40,244,52
s_add_u32 s101, s99, 0x1fff
s_and_b32 s101, s101, 0xffffe000
s_lshl_b32 s98, s101, 3
mvaac 40,248,64
s_cmp_ge_u32 s100, s98
mu 56,7,56
mu 57,7,57
mvaac 44,244,56
ra 244,2,10240
mu 58,7,58
mvaac 44,248,68
wl 4
ra 248,2,11264
mu 59,7,59
mvaac 36,228,72
wl 4
s_cselect_b32 s98, s98, 0
cv 170,56,57
cv 171,58,59
mvaac 36,232,84
s_sub_u32 s100, s100, s98
s_lshl_b32 s98, s101, 2
s_cmp_ge_u32 s100, s98
mvaac 40,228,76
s_cselect_b32 s98, s98, 0
s_sub_u32 s100, s100, s98
s_lshl_b32 s98, s101, 1
mvaac 40,232,88
s_cmp_ge_u32 s100, s98
s_cselect_b32 s98, s98, 0
s_sub_u32 s100, s100, s98
mvaac 44,228,80
ra 228,2,12288
s_lshl_b32 s98, s101, 0
mvaac 44,232,92
wl 4
ra 232,2,13312
s_cmp_ge_u32 s100, s98
mvaac 36,236,96
wl 4
s_cselect_b32 s98, s98, 0
s_sub_u32 s100, s100, s98
v_lshlrev_b32 v61, 7, v0
mvaac 36,240,108
s_sub_u32 s99, s99, 4
v_add_u32 v61, s100, v61
v_min_u32 v61, s99, v61
mvaac 40,236,100
s_add_u32 s22, s30, s23
v_add_co_u32 v62, vcc, s96, v61
s_mov_b32 m0, s22
mvaac 40,240,112
v_mov_b32 v63, s97
v_addc_co_u32 v63, vcc, 0, v63, vcc
mvaac 44,236,104
ra 236,2,14336
wv 6
s_barrier
mvaac 44,240,116
wl 4
ra 240,2,15360
v_add_u32 v3, s28, v1
mvaac 36,244,120
wl 4
global_load_dword a254, v[62:63], off
mvaac 36,248,132
s_add_u32 s25, s24, 0x1000
s_mul_i32 s86, s34, 0x300
v_mov_b32 v253, 0x80000000
mvaac 40,244,124
v_add_u32 v4, s29, v1
v_add_u32 v252, s71, v20
mvaac 40,248,136
mu 36,5,36
mu 37,5,37
mvaac 44,244,128
ra 244,2,16384
mu 38,5,38
mvaac 44,248,140
wl 4
ra 248,2,17408
mu 39,5,39
mvaaz 48,228,0
wl 4
cv 100,36,37
cv 101,38,39
mvaac 48,232,12
mu 40,6,40
mu 41,6,41
mvaaz 52,228,4
dm 1,12,24,0
mvaac 52,232,16
s_mov_b32 m0, s22
mu 42,6,42
mu 43,6,43
mvaaz 56,228,8
ra 228,2,18432
cv 112,40,41
mvaac 56,232,20
wl 4
ra 232,2,19456
cv 113,42,43
mvaac 48,236,24
wl 4
mu 44,7,44
mu 45,7,45
mvaac 48,240,36
mu 46,7,46
mu 47,7,47
mvaac 52,236,28
cv 124,44,45
cv 125,46,47
mvaac 52,240,40
rv 184,252,768
v_mov_b32 v139, 0
mvaac 56,236,32
ra 236,2,20480
v_mov_b32 v147, 0
mvaac 56,240,44
wl 5
ra 240,2,21504
mvaac 48,244,48
wl 5
rv 200,252,0
mvaac 48,248,60
dm 1,12,24,1024
mvaac 52,244,52
s_mov_b32 m0, s22
rv 188,252,832
mvaac 52,248,64
rv 204,252,64
mvaac 56,244,56
ra 244,2,22528
mvaac 56,248,68
wl 8
ra 248,2,23552
v_add_u32 v2, s30, v1
mvaac 48,228,72
wl 8
rv 192,252,896
mvaac 48,232,84
rv 208,252,128
mvaac 52,228,76
mvaac 52,232,88
mvaac 56,228,80
ra 228,3,0
mvaac 56,232,92
wl 9
ra 232,3,1024
mvaac 48,236,96
wl 9
dm 1,12,24,2048
mvaac 48,240,108
s_mov_b32 m0, s22
mvaac 52,236,100
mvaac 52,240,112
mvaac 56,236,104
ra 236,3,2048
mvaac 56,240,116
wl 6
ra 240,3,3072
mvaac 48,244,120
wl 6
mvaac 48,248,132
mvaac 52,244,124
mvaac 52,248,136
mu 48,5,48
mu 49,5,49
mvaac 56,244,128
ra 244,3,4096
mu 50,5,50
mvaac 56,248,140
wl 4
ra 248,3,5120
mu 51,5,51
mvaaz 36,228,0
wl 4
dm 1,12,24,3072
mvaac 36,232,12
s_add_u32 m0, s22, 0x1000
cv 102,48,49
cv 103,50,51
mvaaz 40,228,4
mu 52,6,52
mu 53,6,53
mvaac 40,232,16
mu 54,6,54
mu 55,6,55
mvaaz 44,228,8
ra 228,3,6144
cv 114,52,53
mvaac 44,232,20
wl 4
ra 232,3,7168
cv 115,54,55
mvaac 36,236,24
wl 4
mu 56,7,56
mu 57,7,57
mvaac 36,240,36
mu 58,7,58
mu 59,7,59
mvaac 40,236,28
cv 126,56,57
cv 127,58,59
mvaac 40,240,40
mvaac 44,236,32
ra 236,3,8192
mvaac 44,240,44
wl 4
ra 240,3,9216
mvaac 36,244,48
wl 4
dm 1,12,25,0
mvaac 36,248,60
s_add_u32 m0, s22, 0x1000
s_add_u32 s24, s24, 0x6000
s_lshr_b32 s83, s71, 6
mvaac 40,244,52
s_mul_i32 s83, s83, 0x56
s_lshr_b32 s83, s83, 8
s_add_u32 s84, s33, 13
mvaac 40,248,64
s_mul_i32 s85, s84, 0x46e00
s_add_u32 s85, s85, s86
s_mul_i32 s79, s83, 6
mvaac 44,244,56
ra 244,3,10240
s_sub_u32 s87, s85, 0x300
mvaac 44,248,68
wl 4
ra 248,3,11264
s_add_u32 s83, s79, 0
mvaac 36,228,72
wl 4
s_and_b32 s84, s83, 3
s_lshl_b32 s83, s83, 6
v_add_u32 v33, s83, v0
mvaac 36,232,84
s_cmp_eq_u32 s84, s20
v_mul_u32_u24 v34, 0x2ab, v33
s_cselect_b32 s85, 0x17a, 0
mvaac 40,228,76
v_lshrrev_b32 v34, 16, v34
s_cmp_eq_u32 s21, 2
mvaac 40,232,88
dm 1,12,25,1024
mvaac 44,228,80
ra 228,3,12288
v_mul_u32_u24 v35, 0x60, v34
mvaac 44,232,92
wl 4
ra 232,3,13312
s_cselect_b32 s85, 0, s85
mvaac 36,236,96
wl 4
v_sub_u32 v35, v33, v35
s_mov_b32 s86, 0x46e00
mvaac 36,240,108
v_mul_lo_u32 v33, v34, s86
s_add_u32 s84, s33, 13
mvaac 40,236,100
v_add_u32 v34, s84, v34
v_cmp_gt_u32 vcc, s85, v34
mvaac 40,240,112
v_lshl_add_u32 v33, v35, 7, v33
v_add_u32 v33, s87, v33
mvaac 44,236,104
ra 236,3,14336
v_cndmask_b32 v33, v253, v33, vcc
mvaac 44,240,116
wl 4
ra 240,3,15360
s_add_u32 s22, s31, s23
mvaac 36,244,120
wl 4
buffer_load_dword a252, v33, s[8:11], 0 offen offset:0
mvaac 36,248,132
s_mov_b32 m0, s22
wv 8
s_barrier
s_add_u32 s25, s24, 0x1000
mvaac 40,244,124
s_mov_b32 s86, 0x46e00
v_mov_b32 v253, 0x80000000
mvaac 40,248,136
mu 36,5,36
mu 37,5,37
mvaac 44,244,128
ra 244,3,16384
mu 38,5,38
mvaac 44,248,140
wl 4
ra 248,3,17408
mu 39,5,39
mvaaz 48,228,0
wl 4
cv 104,36,37
cv 105,38,39
mvaac 48,232,12
mu 40,6,40
mu 41,6,41
mvaaz 52,228,4
dm 1,12,24,0
mvaac 52,232,16
s_mov_b32 m0, s22
mu 42,6,42
mu 43,6,43
mvaaz 56,228,8
ra 228,3,18432
cv 116,40,41
mvaac 56,232,20
wl 4
ra 232,3,19456
cv 117,42,43
mvaac 48,236,24
wl 4
mu 44,7,44
mu 45,7,45
mvaac 48,240,36
mu 46,7,46
mu 47,7,47
mvaac 52,236,28
cv 128,44,45
cv 129,46,47
mvaac 52,240,40
mvaac 56,236,32
ra 236,3,20480
mvaac 56,240,44
wl 4
ra 240,3,21504
mvaac 48,244,48
wl 4
mvaac 48,248,60
dm 1,12,24,1024
mvaac 52,244,52
s_mov_b32 m0, s22
mvaac 52,248,64
mvaac 56,244,56
ra 244,3,22528
mvaac 56,248,68
wl 4
ra 248,3,23552
v_add_u32 v3, s31, v1
mvaac 48,228,72
wl 4
mvaac 48,232,84
mvaac 52,228,76
mvaac 52,232,88
mvaac 56,228,80
ra 228,4,0
mvaac 56,232,92
wl 4
ra 232,4,1024
mvaac 48,236,96
wl 4
dm 1,12,24,2048
mvaac 48,240,108
s_mov_b32 m0, s22
mvaac 52,236,100
mvaac 52,240,112
mvaac 56,236,104
ra 236,4,2048
mvaac 56,240,116
wl 4
ra 240,4,3072
mvaac 48,244,120
wl 4
mvaac 48,248,132
mvaac 52,244,124
mvaac 52,248,136
mu 48,5,48
mu 49,5,49
mvaac 56,244,128
ra 244,4,4096
mu 50,5,50
mvaac 56,248,140
wl 4
ra 248,4,5120
mu 51,5,51
mvaaz 36,228,0
wl 4
dm 1,12,24,3072
mvaac 36,232,12
s_add_u32 m0, s22, 0x1000
cv 106,48,49
cv 107,50,51
mvaaz 40,228,4
mu 52,6,52
mu 53,6,53
mvaac 40,232,16
mu 54,6,54
mu 55,6,55
mvaaz 44,228,8
ra 228,4,6144
cv 118,52,53
mvaac 44,232,20
wl 4
ra 232,4,7168
cv 119,54,55
mvaac 36,236,24
wl 4
mu 56,7,56
mu 57,7,57
mvaac 36,240,36
mu 58,7,58
mu 59,7,59
mvaac 40,236,28
cv 130,56,57
cv 131,58,59
mvaac 40,240,40
mvaac 44,236,32
ra 236,4,8192
mvaac 44,240,44
wl 4
ra 240,4,9216
mvaac 36,244,48
wl 4
dm 1,12,25,0
mvaac 36,248,60
s_add_u32 m0, s22, 0x1000
s_add_u32 s24, s24, 0x6000
s_add_u32 s83, s79, 1
mvaac 40,244,52
s_and_b32 s84, s83, 3
s_lshl_b32 s83, s83, 6
v_add_u32 v33, s83, v0
mvaac 40,248,64
s_cmp_eq_u32 s84, s20
v_mul_u32_u24 v34, 0x2ab, v33
s_cselect_b32 s85, 0x17a, 0
mvaac 44,244,56
ra 244,4,10240
v_lshrrev_b32 v34, 16, v34
mvaac 44,248,68
wl 4
ra 248,4,11264
s_cmp_eq_u32 s21, 2
mvaac 36,228,72
wl 4
v_mul_u32_u24 v35, 0x60, v34
s_cselect_b32 s85, 0, s85
mvaac 36,232,84
v_sub_u32 v35, v33, v35
v_mul_lo_u32 v33, v34, s86
mvaac 40,228,76
s_add_u32 s84, s33, 13
v_add_u32 v34, s84, v34
v_cmp_gt_u32 vcc, s85, v34
mvaac 40,232,88
dm 1,12,25,1024
mvaac 44,228,80
ra 228,4,12288
v_lshl_add_u32 v33, v35, 7, v33
mvaac 44,232,92
wl 4
ra 232,4,13312
v_add_u32 v33, s87, v33
mvaac 36,236,96
wl 4
v_cndmask_b32 v33, v253, v33, vcc
s_add_u32 s22, s28, s23
mvaac 36,240,108
buffer_load_dword a253, v33, s[8:11], 0 offen offset:0
mvaac 40,236,100
s_mov_b32 m0, s22
wv 8
s_barrier
s_add_u32 s25, s24, 0x1000
mvaac 40,240,112
s_mov_b32 s86, 0x46e00
v_mov_b32 v253, 0x80000000
mvaac 44,236,104
ra 236,4,14336
mvaac 44,240,116
wl 4
ra 240,4,15360
mvaac 36,244,120
wl 4
mvaac 36,248,132
mvaac 40,244,124
mvaac 40,248,136
mu 36,5,36
mu 37,5,37
mvaac 44,244,128
ra 244,4,16384
mu 38,5,38
mvaac 44,248,140
wl 4
ra 248,4,17408
mu 39,5,39
mvaaz 48,228,0
wl 4
cv 108,36,37
cv 109,38,39
mvaac 48,232,12
mu 44,7,44
mu 45,7,45
mvaaz 52,228,4
dm 1,12,24,0
mvaac 52,232,16
s_mov_b32 m0, s22
mu 46,7,46
mu 47,7,47
mvaaz 56,228,8
ra 228,4,18432
cv 132,44,45
mvaac 56,232,20
wl 4
ra 232,4,19456
cv 133,46,47
mvaac 48,236,24
wl 4
mu 40,6,40
mu 41,6,41
mvaac 48,240,36
mu 42,6,42
mu 43,6,43
mvaac 52,236,28
cv 120,40,41
cv 121,42,43
mvaac 52,240,40
mvaac 56,236,32
ra 236,4,20480
mvaac 56,240,44
wl 4
ra 240,4,21504
mvaac 48,244,48
wl 4
mvaac 48,248,60
dm 1,12,24,1024
mvaac 52,244,52
s_mov_b32 m0, s22
mvaac 52,248,64
mvaac 56,244,56
ra 244,4,22528
mvaac 56,248,68
wl 4
ra 248,4,23552
v_add_u32 v4, s28, v1
mvaac 48,228,72
wl 4
mvaac 48,232,84
mvaac 52,228,76
mvaac 52,232,88
mvaac 56,228,80
ra 228,2,0
mvaac 56,232,92
wl 4
ra 232,2,1024
mvaac 48,236,96
wl 4
dm 1,12,24,2048
mvaac 48,240,108
s_mov_b32 m0, s22
mvaac 52,236,100
mvaac 52,240,112
mvaac 56,236,104
ra 236,2,2048
mvaac 56,240,116
wl 4
ra 240,2,3072
mvaac 48,244,120
wl 4
mvaac 48,248,132
mvaac 52,244,124
mvaac 52,248,136
mu 48,5,48
mu 49,5,49
mvaac 56,244,128
ra 244,2,4096
mu 50,5,50
mvaac 56,248,140
ra 248,2,5120
mu 51,5,51
mvvvz 244,184,200
dm 1,12,24,3072
mvvvc 244,188,204
mu 56,7,56
mu 57,7,57
mvvvc 244,192,208
mu 58,7,58
mu 59,7,59
mvvvz 228,184,124
cv 134,56,57
cv 135,58,59
mvvvc 228,188,128
cv 110,48,49
cv 111,50,51
mvvvc 228,192,132
mu 52,6,52
mu 53,6,53
mvvvz 232,172,200
mu 54,6,54
mu 55,6,55
mvvvc 232,148,204
cv 122,52,53
cv 123,54,55
mvvvc 232,160,208
s_add_u32 m0, s22, 0x1000
mvvvz 236,176,200
mvvvc 236,152,204
v_max3_f32 v26, v232, v233, v234
mvvvc 236,164,208
mvvvz 240,180,200
mvvvc 240,156,204
v_max3_f32 v26, v26, v235, v236
v_max3_f32 v26, v26, v237, v238
mvvvc 240,168,208
mvvvz 196,184,100
mvvvc 196,188,104
v_max3_f32 v26, v26, v239, v240
v_max3_f32 v26, v26, v241, v242
mvvvc 196,192,108
v_max3_f32 v26, v26, v243, v244
v_mov_b32 v27, v26
mvvvz 212,184,112
v_permlane16_swap_b32 v26, v27
mvvvc 212,188,116
mx 26,26,27
v_mov_b32 v27, v26
mvvvc 212,192,120
v_permlane32_swap_b32 v26, v27
mvvvz 216,172,124
mx 26,26,27
v_mul_f32 v28, s61, v26
mvvvc 216,148,128
v_fma_f32 v232, v232, s32, v28
v_fma_f32 v233, v233, s32, v28
mvvvc 216,160,132
ex 232,232
mvvvz 220,176,124
ex 233,233
mvvvc 220,152,128
v_fma_f32 v234, v234, s32, v28
v_fma_f32 v235, v235, s32, v28
mvvvc 220,164,132
ex 234,234
mvvvz 224,180,124
ex 235,235
mvvvc 224,156,128
v_fma_f32 v236, v236, s32, v28
v_fma_f32 v237, v237, s32, v28
mvvvc 224,168,132
ex 236,236
mvvvz 184,172,100
ad 251,232,233
v_fma_f32 v238, v238, s32, v28
mvvvc 184,148,104
ex 237,237
mvvvc 184,160,108
ad 251,251,234
v_fma_f32 v239, v239, s32, v28
mvvvz 188,176,100
ex 238,238
mvvvc 188,152,104
v_max3_f32 v29, v184, v185, v186
ad 251,251,235
mvvvc 188,164,108
ex 239,239
mvvvz 192,180,100
v_fma_f32 v240, v240, s32, v28
ad 251,251,236
mvvvc 192,156,104
v_max3_f32 v29, v29, v187, v188
v_max3_f32 v29, v29, v189, v190
mvvvc 192,168,108
ex 240,240
mvvvz 200,172,112
v_fma_f32 v241, v241, s32, v28
ad 251,251,237
mvvvc 200,148,116
v_max3_f32 v29, v29, v191, v192
v_max3_f32 v29, v29, v193, v194
mvvvc 200,160,120
v_max3_f32 v29, v29, v195, v196
v_mov_b32 v30, v29
mvvvz 204,176,112
v_permlane16_swap_b32 v29, v30
mvvvc 204,152,116
mx 29,29,30
v_mov_b32 v30, v29
mvvvc 204,164,120
v_permlane32_swap_b32 v29, v30
mvvvz 208,180,112
ex 241,241
mvvvc 208,156,116
v_fma_f32 v242, v242, s32, v28
ad 251,251,238
mvvvc 208,168,120
wl 5
ex 242,242
mvaaz 36,0,228
wl 4
v_fma_f32 v243, v243, s32, v28
v_fma_f32 v244, v244, s32, v28
mvaac 36,12,232
ad 251,251,239
mx 29,29,30
mvaaz 40,4,228
ex 243,243
mvaac 40,16,232
ex 244,244
mvaaz 44,8,228
ra 228,2,6144
ad 251,251,240
mvaac 44,20,232
wl 4
ra 232,2,7168
v_mul_f32 v31, s61, v29
mvaac 36,24,236
wl 4
ad 251,251,241
v_fma_f32 v184, v184, s32, v31
mvaac 36,36,240
v_fma_f32 v185, v185, s32, v31
ad 251,251,242
mvaac 40,28,236
ex 184,184
mvaac 40,40,240
ex 185,185
mvaac 44,32,236
ra 236,2,8192
v_fma_f32 v186, v186, s32, v31
mvaac 44,44,240
wl 4
ra 240,2,9216
mu 244,23,244
mvaac 36,48,244
wl 4
dm 1,12,25,0
mvaac 36,60,248
s_add_u32 m0, s22, 0x1000
s_add_u32 s24, s24, 0x6000
s_add_u32 s83, s79, 2
mvaac 40,52,244
s_and_b32 s84, s83, 3
s_lshl_b32 s83, s83, 6
v_add_u32 v33, s83, v0
mvaac 40,64,248
s_cmp_eq_u32 s84, s20
v_mul_u32_u24 v34, 0x2ab, v33
s_cselect_b32 s85, 0x17a, 0
mvaac 44,56,244
ra 244,2,10240
v_lshrrev_b32 v34, 16, v34
mvaac 44,68,248
wl 4
ra 248,2,11264
s_cmp_eq_u32 s21, 2
mvaac 36,72,228
wl 4
v_mul_u32_u24 v35, 0x60, v34
s_cselect_b32 s85, 0, s85
mvaac 36,84,232
v_sub_u32 v35, v33, v35
v_mul_lo_u32 v33, v34, s86
mvaac 40,76,228
s_add_u32 s84, s33, 13
v_add_u32 v34, s84, v34
v_cmp_gt_u32 vcc, s85, v34
mvaac 40,88,232
dm 1,12,25,1024
mvaac 44,80,228
ra 228,2,12288
v_lshl_add_u32 v33, v35, 7, v33
mvaac 44,92,232
wl 4
ra 232,2,13312
v_add_u32 v33, s87, v33
mvaac 36,96,236
wl 4
v_cndmask_b32 v33, v253, v33, vcc
s_add_u32 s22, s29, s23
mvaac 36,108,240
wv 13
buffer_load_dword a252, v33, s[8:11], 0 offen offset:0
mvaac 40,100,236
s_mov_b32 m0, s22
wv 8
s_barrier
s_add_u32 s25, s24, 0x1000
mvaac 40,112,240
s_mov_b32 s86, 0x46e00
v_mov_b32 v253, 0x80000000
ad 251,251,243
mvaac 44,104,236
ra 236,2,14336
v_fma_f32 v187, v187, s32, v31
mvaac 44,116,240
wl 4
ra 240,2,15360
ad 251,251,244
mvaac 36,120,244
wl 4
ex 186,186
mvaac 36,132,248
ex 187,187
mvaac 40,124,244
v_fma_f32 v188, v188, s32, v31
v_mov_b32 v32, v251
mvaac 40,136,248
cv 100,36,37
cv 101,38,39
mvaac 44,128,244
ra 244,2,16384
v_fma_f32 v189, v189, s32, v31
mvaac 44,140,248
wl 4
ra 248,2,17408
cv 102,40,41
mvaaz 48,0,228
wl 4
cv 103,42,43
ad 248,184,185
mvaac 48,12,232
cv 104,44,45
cv 105,46,47
mvaaz 52,4,228
dm 1,12,24,0
mvaac 52,16,232
s_mov_b32 m0, s22
ex 188,188
mvaaz 56,8,228
ra 228,2,18432
v_fma_f32 v190, v190, s32, v31
mvaac 56,20,232
wl 4
ra 232,2,19456
ad 248,248,186
mvaac 48,24,236
wl 4
ex 189,189
mvaac 48,36,240
ex 190,190
mvaac 52,28,236
v_fma_f32 v191, v191, s32, v31
ad 248,248,187
mvaac 52,40,240
v_permlane16_swap_b32 v251, v32
mvaac 56,32,236
ra 236,2,20480
v_fma_f32 v192, v192, s32, v31
mvaac 56,44,240
wl 4
ra 240,2,21504
ad 248,248,188
mvaac 48,48,244
wl 4
ex 191,191
mvaac 48,60,248
dm 1,12,24,1024
mvaac 52,52,244
s_mov_b32 m0, s22
ex 192,192
mvaac 52,64,248
v_fma_f32 v193, v193, s32, v31
ad 248,248,189
mvaac 56,56,244
ra 244,2,22528
ad 251,251,32
mvaac 56,68,248
wl 4
ra 248,2,23552
v_fma_f32 v194, v194, s32, v31
mvaac 48,72,228
wl 4
ex 193,193
mvaac 48,84,232
ad 248,248,190
v_mov_b32 v32, v251
mvaac 52,76,228
ex 194,194
mvaac 52,88,232
v_fma_f32 v195, v195, s32, v31
v_fma_f32 v196, v196, s32, v31
mvaac 56,80,228
ra 228,3,0
ad 248,248,191
mvaac 56,92,232
wl 4
ra 232,3,1024
ad 248,248,192
mvaac 48,96,236
wl 4
dm 1,12,24,2048
mvaac 48,108,240
s_mov_b32 m0, s22
ex 195,195
mvaac 52,100,236
ex 196,196
mvaac 52,112,240
ad 248,248,193
ad 248,248,194
mvaac 56,104,236
ra 236,3,2048
mu 196,23,196
mvaac 56,116,240
wl 4
ra 240,3,3072
ad 248,248,195
mvaac 48,120,244
wl 4
v_permlane32_swap_b32 v251, v32
mvaac 48,132,248
ad 251,251,32
ad 248,248,196
mvaac 52,124,244
v_mov_b32 v32, v248
mu 232,8,232
mvaac 52,136,248
cv 108,48,49
cv 109,50,51
mvaac 56,128,244
ra 244,3,4096
mu 233,9,233
mvaac 56,140,248
wl 4
ra 248,3,5120
cv 110,52,53
mvaaz 36,0,228
wl 4
dm 1,12,24,3072
mvaac 36,12,232
s_add_u32 m0, s22, 0x1000
cv 111,54,55
cv 112,56,57
mvaaz 40,4,228
cv 113,58,59
mu 234,10,234
mvaac 40,16,232
v_permlane16_swap_b32 v248, v32
mvaaz 44,8,228
ra 228,3,6144
ad 248,248,32
mvaac 44,20,232
wl 4
ra 232,3,7168
v_mov_b32 v32, v248
mvaac 36,24,236
wl 4
v_permlane32_swap_b32 v248, v32
mvaac 36,36,240
ad 248,248,32
mu 235,11,235
mvaac 40,28,236
v_rcp_f32 v251, v251
mvaac 40,40,240
v_rcp_f32 v248, v248
mvaac 44,32,236
ra 236,3,8192
mu 236,12,236
mvaac 44,44,240
wl 4
ra 240,3,9216
mu 237,13,237
mvaac 36,48,244
wl 4
dm 1,12,25,0
mvaac 36,60,248
s_add_u32 m0, s22, 0x1000
s_add_u32 s24, s24, 0x6000
s_add_u32 s83, s79, 3
mvaac 40,52,244
s_and_b32 s84, s83, 3
s_lshl_b32 s83, s83, 6
v_add_u32 v33, s83, v0
mvaac 40,64,248
s_cmp_eq_u32 s84, s20
v_mul_u32_u24 v34, 0x2ab, v33
s_cselect_b32 s85, 0x17a, 0
mvaac 44,56,244
ra 244,3,10240
v_lshrrev_b32 v34, 16, v34
mvaac 44,68,248
wl 4
ra 248,3,11264
s_cmp_eq_u32 s21, 2
mvaac 36,72,228
wl 4
v_mul_u32_u24 v35, 0x60, v34
s_cselect_b32 s85, 0, s85
mvaac 36,84,232
v_sub_u32 v35, v33, v35
v_mul_lo_u32 v33, v34, s86
mvaac 40,76,228
s_add_u32 s84, s33, 13
v_add_u32 v34, s84, v34
v_cmp_gt_u32 vcc, s85, v34
mvaac 40,88,232
dm 1,12,25,1024
mvaac 44,80,228
ra 228,3,12288
v_lshl_add_u32 v33, v35, 7, v33
mvaac 44,92,232
wl 4
ra 232,3,13312
v_add_u32 v33, s87, v33
mvaac 36,96,236
wl 4
v_cndmask_b32 v33, v253, v33, vcc
s_add_u32 s22, s30, s23
mvaac 36,108,240
wv 13
buffer_load_dword a253, v33, s[8:11], 0 offen offset:0
mvaac 40,100,236
s_mov_b32 m0, s22
wv 8
s_barrier
s_add_u32 s25, s24, 0x1000
mvaac 40,112,240
s_mov_b32 s86, 0x46e00
v_mov_b32 v253, 0x80000000
mu 238,14,238
mvaac 44,104,236
ra 236,3,14336
mu 239,15,239
mvaac 44,116,240
wl 4
ra 240,3,15360
mu 240,16,240
mvaac 36,120,244
wl 4
mu 241,17,241
mu 242,18,242
mvaac 36,132,248
mu 243,19,243
mu 184,8,184
mvaac 40,124,244
mu 185,9,185
mu 186,10,186
mvaac 40,136,248
cv 116,36,37
cv 117,38,39
mvaac 44,128,244
ra 244,3,16384
mu 187,11,187
mvaac 44,140,248
wl 4
ra 248,3,17408
cv 118,40,41
mvaaz 48,0,228
wl 4
cv 119,42,43
mu 188,12,188
mvaac 48,12,232
cv 120,44,45
cv 121,46,47
mvaaz 52,4,228
dm 1,12,24,0
mvaac 52,16,232
s_mov_b32 m0, s22
mu 189,13,189
mu 190,14,190
mvaaz 56,8,228
ra 228,3,18432
mu 191,15,191
mvaac 56,20,232
wl 4
ra 232,3,19456
mu 192,16,192
mvaac 48,24,236
wl 4
mu 193,17,193
mu 194,18,194
mvaac 48,36,240
mu 195,19,195
mu 232,251,232
mvaac 52,28,236
mu 233,251,233
mu 234,251,234
mvaac 52,40,240
mu 235,251,235
mu 236,251,236
mvaac 56,32,236
ra 236,3,20480
mu 237,251,237
mvaac 56,44,240
wl 4
ra 240,3,21504
mu 238,251,238
mvaac 48,48,244
wl 4
mu 239,251,239
mu 240,251,240
mvaac 48,60,248
dm 1,12,24,1024
mvaac 52,52,244
s_mov_b32 m0, s22
mu 241,251,241
mu 242,251,242
mvaac 52,64,248
mu 243,251,243
mu 244,251,244
mvaac 56,56,244
ra 244,3,22528
mu 184,248,184
mvaac 56,68,248
wl 4
ra 248,3,23552
mu 185,248,185
mvaac 48,72,228
wl 4
mu 186,248,186
mu 187,248,187
mvaac 48,84,232
mu 188,248,188
mu 189,248,189
mvaac 52,76,228
mu 190,248,190
mu 191,248,191
mvaac 52,88,232
mu 192,248,192
mu 193,248,193
mvaac 56,80,228
ra 228,4,0
mu 194,248,194
mvaac 56,92,232
wl 4
ra 232,4,1024
mu 195,248,195
mvaac 48,96,236
wl 4
dm 1,12,24,2048
mvaac 48,108,240
s_mov_b32 m0, s22
mu 196,248,196
v_add_u32 v2, s29, v1
mvaac 52,100,236
cv 172,232,233
cv 173,234,235
mvaac 52,112,240
cv 174,236,237
cv 175,238,239
mvaac 56,104,236
ra 236,4,2048
cv 176,240,241
mvaac 56,116,240
wl 4
ra 240,4,3072
cv 177,242,243
mvaac 48,120,244
wl 4
v_cvt_pk_bf16_f32 v178, v244, 0
v_mov_b32 v179, 0
mvaac 48,132,248
cv 148,184,185
cv 149,186,187
mvaac 52,124,244
cv 150,188,189
cv 151,190,191
mvaac 52,136,248
cv 124,48,49
cv 125,50,51
mvaac 56,128,244
ra 244,4,4096
cv 152,192,193
mvaac 56,140,248
wl 4
ra 248,4,5120
cv 126,52,53
mvaaz 36,0,228
wl 4
dm 1,12,24,3072
mvaac 36,12,232
s_add_u32 m0, s22, 0x1000
cv 127,54,55
cv 128,56,57
mvaaz 40,4,228
cv 129,58,59
cv 153,194,195
mvaac 40,16,232
v_cvt_pk_bf16_f32 v154, v196, 0
v_mov_b32 v155, 0
mvaaz 44,8,228
ra 228,4,6144
mvaac 44,20,232
wl 4
ra 232,4,7168
mvaac 36,24,236
wl 4
mvaac 36,36,240
mvaac 40,28,236
mvaac 40,40,240
mvaac 44,32,236
ra 236,4,8192
mvaac 44,44,240
wl 4
ra 240,4,9216
mvaac 36,48,244
wl 4
dm 1,12,25,0
mvaac 36,60,248
s_add_u32 m0, s22, 0x1000
s_add_u32 s24, s24, 0x6000
s_add_u32 s83, s79, 4
mvaac 40,52,244
s_and_b32 s84, s83, 3
s_lshl_b32 s83, s83, 6
v_add_u32 v33, s83, v0
mvaac 40,64,248
s_cmp_eq_u32 s84, s20
v_mul_u32_u24 v34, 0x2ab, v33
s_cselect_b32 s85, 0x17a, 0
mvaac 44,56,244
ra 244,4,10240
v_lshrrev_b32 v34, 16, v34
mvaac 44,68,248
wl 4
ra 248,4,11264
s_cmp_eq_u32 s21, 2
mvaac 36,72,228
wl 4
v_mul_u32_u24 v35, 0x60, v34
s_cselect_b32 s85, 0, s85
mvaac 36,84,232
v_sub_u32 v35, v33, v35
v_mul_lo_u32 v33, v34, s86
mvaac 40,76,228
s_add_u32 s84, s33, 13
v_add_u32 v34, s84, v34
v_cmp_gt_u32 vcc, s85, v34
mvaac 40,88,232
dm 1,12,25,1024
mvaac 44,80,228
ra 228,4,12288
v_lshl_add_u32 v33, v35, 7, v33
mvaac 44,92,232
wl 4
ra 232,4,13312
v_add_u32 v33, s87, v33
mvaac 36,96,236
wl 4
v_cndmask_b32 v33, v253, v33, vcc
s_add_u32 s22, s31, s23
mvaac 36,108,240
wv 13
buffer_load_dword a252, v33, s[8:11], 0 offen offset:0
mvaac 40,100,236
s_mov_b32 m0, s22
wv 8
s_barrier
s_add_u32 s25, s24, 0x1000
mvaac 40,112,240
s_mov_b32 s86, 0x46e00
v_mov_b32 v253, 0x80000000
mvaac 44,104,236
ra 236,4,14336
mvaac 44,116,240
wl 4
ra 240,4,15360
mvaac 36,120,244
wl 4
mvaac 36,132,248
mvaac 40,124,244
mvaac 40,136,248
cv 132,36,37
cv 133,38,39
mvaac 44,128,244
ra 244,4,16384
mvaac 44,140,248
wl 4
ra 248,4,17408
cv 134,40,41
mvaaz 48,0,228
wl 4
cv 135,42,43
mvaac 48,12,232
cv 136,44,45
cv 137,46,47
mvaaz 52,4,228
dm 1,12,24,0
mvaac 52,16,232
s_mov_b32 m0, s22
mvaaz 56,8,228
ra 228,4,18432
mvaac 56,20,232
wl 4
ra 232,4,19456
mvaac 48,24,236
wl 4
mvaac 48,36,240
mvaac 52,28,236
dm 1,12,24,1024
mvaac 52,40,240
s_mov_b32 m0, s22
mvaac 56,32,236
ra 236,4,20480
mvaac 56,44,240
wl 4
ra 240,4,21504
mvaac 48,48,244
wl 4
mvaac 48,60,248
mvaac 52,52,244
dm 1,12,24,2048
mvaac 52,64,248
s_mov_b32 m0, s22
mvaac 56,56,244
ra 244,4,22528
mvaac 56,68,248
wl 4
ra 248,4,23552
mvaac 48,72,228
wl 4
mvaac 48,84,232
mvaac 52,76,228
dm 1,12,24,3072
mvaac 52,88,232
s_add_u32 m0, s22, 0x1000
mvaac 56,80,228
ra 228,2,0
mvaac 56,92,232
wl 4
ra 232,2,1024
mvaac 48,96,236
wl 4
mvaac 48,108,240
mvaac 52,100,236
dm 1,12,25,0
mvaac 52,112,240
s_add_u32 m0, s22, 0x1000
s_add_u32 s24, s24, 0x6000
s_add_u32 s83, s79, 5
mvaac 56,104,236
ra 236,2,2048
s_and_b32 s84, s83, 3
mvaac 56,116,240
wl 4
ra 240,2,3072
s_lshl_b32 s83, s83, 6
mvaac 48,120,244
wl 4
v_add_u32 v33, s83, v0
s_cmp_eq_u32 s84, s20
mvaac 48,132,248
v_mul_u32_u24 v34, 0x2ab, v33
s_cselect_b32 s85, 0x17a, 0
mvaac 52,124,244
dm 1,12,25,1024
mvaac 52,136,248
v_lshrrev_b32 v34, 16, v34
s_cmp_eq_u32 s21, 2
mvaac 56,128,244
v_mul_u32_u24 v35, 0x60, v34
s_cselect_b32 s85, 0, s85
mvaac 56,140,248
s_add_u32 s84, s33, 13
v_sub_u32 v35, v33, v35
v_mul_lo_u32 v33, v34, s86
v_add_u32 v34, s84, v34
v_cmp_gt_u32 vcc, s85, v34
v_lshl_add_u32 v33, v35, 7, v33
v_add_u32 v33, s87, v33
v_cndmask_b32 v33, v253, v33, vcc
wv 13
buffer_load_dword a253, v33, s[8:11], 0 offen offset:0
s_cmp_eq_u32 s71, 0
s_cbranch_scc1 L_b1_0
s_cmp_eq_u32 s71, 192
s_cbranch_scc1 L_b1_1
s_cmp_eq_u32 s71, 384
s_cbranch_scc1 L_b1_2
s_cmp_eq_u32 s21, 2
s_cbranch_scc1 L_outl
L_out:
mvvvz 232,100,172
v_and_b32 v24, 15, v0
v_lshrrev_b32 v25, 4, v0
mvvvz 236,108,172
v_and_b32 v60, 3, v24
v_cmp_eq_u32 vcc, v60, v25
mvvvz 240,116,172
v_lshrrev_b32 v61, 2, v24
v_mov_b32 v60, 63
mvvvz 244,124,172
v_cndmask_b32 v61, v60, v61, vcc
v_cmp_eq_u32 vcc, 0, v61
mvvvz 184,132,172
v_mov_b32 v24, 0x3f80
v_cndmask_b32 v60, 0, v24, vcc
mvvvz 192,100,148
v_cmp_eq_u32 vcc, 1, v61
aw 180,60
mvvvz 196,108,148
s_add_u32 s85, s77, 0x1000
v_lshlrev_b32 v62, 16, v60
v_cndmask_b32 v60, 0, v24, vcc
aw 184,62
v_cmp_eq_u32 vcc, 2, v61
aw 181,60
v_lshlrev_b32 v62, 16, v60
v_cndmask_b32 v60, 0, v24, vcc
aw 185,62
v_cmp_eq_u32 vcc, 3, v61
aw 182,60
v_lshlrev_b32 v62, 16, v60
aw 186,62
v_cndmask_b32 v60, 0, v24, vcc
ds_read_u16 v106, v21 offset:576
ds_read_u16 v114, v21 offset:584
ds_read_u16 v122, v21 offset:640
ds_read_u16 v130, v21 offset:648
ds_read_u16 v138, v21 offset:704
ds_read_u16 v146, v21 offset:712
v_lshlrev_b32 v62, 16, v60
cv 140,48,49
cv 141,50,51
cv 142,52,53
cv 143,54,55
cv 144,56,57
cv 145,58,59
mvvvz 188,140,172
aw 183,60
aw 187,62
v_max3_f32 v26, v200, v201, v202
mvaaz 36,0,180
wl 5
ra 244,2,4096
v_max3_f32 v26, v26, v203, v204
mvvvc 232,104,176
wl 5
ra 248,2,5120
v_max3_f32 v26, v26, v205, v206
mvvvc 236,112,176
wl 5
v_max3_f32 v26, v26, v207, v208
v_max3_f32 v26, v26, v209, v210
mvvvc 240,120,176
wl 4
v_max3_f32 v26, v26, v211, v212
v_mov_b32 v27, v26
mvvvc 244,128,176
wl 3
v_permlane16_swap_b32 v26, v27
mvvvc 184,136,176
wl 2
mx 26,26,27
v_mov_b32 v27, v26
mvvvc 188,144,176
v_permlane32_swap_b32 v26, v27
mvvvc 192,104,152
mx 26,26,27
v_mul_f32 v28, s61, v26
mvvvc 196,112,152
v_fma_f32 v200, v200, s32, v28
v_fma_f32 v201, v201, s32, v28
mvaac 36,144,228
ex 200,200
mvaac 36,156,232
ex 201,201
mvaaz 40,4,180
v_fma_f32 v202, v202, s32, v28
ex 202,202
mvaac 40,148,228
v_fma_f32 v203, v203, s32, v28
ex 203,203
mvaac 40,160,232
v_fma_f32 v204, v204, s32, v28
ex 204,204
mvaaz 44,8,180
v_fma_f32 v205, v205, s32, v28
ad 249,200,201
mvaac 44,152,228
ra 228,2,6144
ex 205,205
mvaac 44,164,232
ra 232,2,7168
v_fma_f32 v206, v206, s32, v28
mvaac 36,168,236
ad 249,249,202
ex 206,206
mvaac 36,192,240
v_fma_f32 v207, v207, s32, v28
ad 249,249,203
mvaac 40,172,236
ex 207,207
mvaac 40,196,240
v_fma_f32 v208, v208, s32, v28
ad 249,249,204
mvaac 44,176,236
ra 236,2,8192
ex 208,208
mvaac 44,200,240
wl 4
ra 240,2,12288
v_fma_f32 v209, v209, s32, v28
mvaac 36,204,244
wl 4
ad 249,249,205
ex 209,209
mvaac 36,216,248
v_fma_f32 v210, v210, s32, v28
ad 249,249,206
mvaac 40,208,244
ex 210,210
mvaac 40,220,248
v_fma_f32 v211, v211, s32, v28
v_fma_f32 v212, v212, s32, v28
mvaac 44,212,244
ra 244,2,13312
ad 249,249,207
mvaac 44,224,248
wl 4
ra 248,2,14336
ex 211,211
mvvac 36,64,228
wl 4
ex 212,212
mvvac 36,76,232
ad 249,249,208
ad 249,249,209
mvvac 40,68,228
ad 249,249,210
mu 212,23,212
mvvac 40,80,232
ad 249,249,211
ad 249,249,212
mvvac 44,72,228
ra 228,2,15360
v_mov_b32 v32, v249
mvvac 44,84,232
wl 4
ra 232,2,16384
v_permlane16_swap_b32 v249, v32
mvvac 36,88,236
ad 249,249,32
v_mov_b32 v32, v249
mvvac 40,92,236
v_permlane32_swap_b32 v249, v32
mvvac 44,96,236
ra 236,2,17408
ad 249,249,32
mvaaz 48,0,184
wl 5
v_rcp_f32 v249, v249
mvaac 48,144,240
wl 4
mu 200,8,200
mu 201,9,201
mvaac 48,156,244
mu 202,10,202
mu 203,11,203
mvaaz 52,4,184
mu 200,249,200
mu 201,249,201
mvaac 52,148,240
mu 202,249,202
mu 203,249,203
mvaac 52,160,244
cv 156,200,201
cv 157,202,203
mvvvz 200,116,148
mu 204,12,204
mu 205,13,205
mvvvc 200,120,152
mu 206,14,206
mu 207,15,207
mvaaz 56,8,184
mu 204,249,204
mu 205,249,205
mvaac 56,152,240
ra 240,2,18432
mu 206,249,206
mvaac 56,164,244
wl 4
ra 244,2,19456
mu 207,249,207
mvaac 48,168,248
cv 158,204,205
cv 159,206,207
mvvvz 204,124,148
mu 208,16,208
mu 209,17,209
mvvvc 204,128,152
wl 4
mu 210,18,210
mu 211,19,211
mvaac 48,192,228
mu 208,249,208
mu 209,249,209
mvaac 52,172,248
mu 210,249,210
mu 211,249,211
mvaac 52,196,228
cv 160,208,209
cv 161,210,211
mvvvz 208,132,148
mu 212,249,212
v_cvt_pk_bf16_f32 v162, v212, 0
mvvvc 208,136,152
v_max3_f32 v29, v216, v217, v218
v_max3_f32 v29, v29, v219, v220
mvvvz 212,140,148
v_max3_f32 v29, v29, v221, v222
v_max3_f32 v29, v29, v223, v224
mvvvc 212,144,152
v_max3_f32 v29, v29, v225, v226
v_max3_f32 v29, v29, v227, v228
mvaac 56,176,248
ra 248,2,20480
v_mov_b32 v30, v29
mvaac 56,200,228
wl 4
ra 228,2,9216
v_permlane16_swap_b32 v29, v30
mvaac 48,204,232
wl 4
mx 29,29,30
v_mov_b32 v30, v29
mvaac 48,216,236
v_permlane32_swap_b32 v29, v30
mvaac 52,208,232
mx 29,29,30
v_mul_f32 v31, s61, v29
mvaac 52,220,236
v_fma_f32 v216, v216, s32, v31
v_fma_f32 v217, v217, s32, v31
mvaac 56,212,232
ra 232,2,10240
ex 216,216
mvaac 56,224,236
wl 4
ra 236,2,11264
ex 217,217
mvvac 48,64,240
wl 4
v_fma_f32 v218, v218, s32, v31
ex 218,218
mvvac 48,76,244
v_fma_f32 v219, v219, s32, v31
ex 219,219
mvvac 52,68,240
v_fma_f32 v220, v220, s32, v31
ex 220,220
mvvac 52,80,244
v_fma_f32 v221, v221, s32, v31
ad 250,216,217
mvvac 56,72,240
ra 240,2,21504
ex 221,221
mvvac 56,84,244
wl 4
ra 244,2,22528
v_fma_f32 v222, v222, s32, v31
mvvac 48,88,248
ad 250,250,218
s_add_u32 s37, s33, s73
mvvac 52,92,248
ex 222,222
mvvac 56,96,248
s_add_u32 s38, s34, s74
ra 248,2,23552
v_fma_f32 v223, v223, s32, v31
ad 250,250,219
ex 223,223
v_fma_f32 v224, v224, s32, v31
ad 250,250,220
s_mul_i32 s37, s37, 0x46e00
s_mul_i32 s38, s38, 0x300
ex 224,224
v_fma_f32 v225, v225, s32, v31
ad 250,250,221
s_add_u32 s39, s37, s38
ex 225,225
v_fma_f32 v226, v226, s32, v31
ad 250,250,222
s_add_u32 s78, s33, 14
ex 226,226
v_fma_f32 v227, v227, s32, v31
v_fma_f32 v228, v228, s32, v31
ad 250,250,223
s_lshl_b32 s81, s20, 2
ex 227,227
ex 228,228
ad 250,250,224
s_add_u32 s81, s81, s78
ad 250,250,225
s_sub_u32 s81, s81, 1
ad 250,250,226
s_add_u32 s82, s81, 0
mu 228,23,228
ad 250,250,227
s_mul_i32 s42, s82, 0x46e00
s_cmp_lt_u32 s82, 0x17a
ad 250,250,228
s_cselect_b32 s42, s42, 0x80000000
v_mov_b32 v32, v250
s_add_u32 s82, s81, 1
s_mul_i32 s43, s82, 0x46e00
s_cmp_lt_u32 s82, 0x17a
s_cselect_b32 s43, s43, 0x80000000
v_permlane16_swap_b32 v250, v32
s_add_u32 s82, s81, 2
s_mul_i32 s46, s82, 0x46e00
s_cmp_lt_u32 s82, 0x17a
ad 250,250,32
s_cselect_b32 s46, s46, 0x80000000
v_mov_b32 v32, v250
s_add_u32 s82, s81, 3
s_mul_i32 s47, s82, 0x46e00
s_cmp_lt_u32 s82, 0x17a
s_cselect_b32 s47, s47, 0x80000000
v_permlane32_swap_b32 v250, v32
s_lshl_b32 s81, s20, 2
v_and_b32 v27, 15, v0
s_sub_u32 s83, s34, 1
ad 250,250,32
v_lshrrev_b32 v26, 4, v0
v_lshrrev_b32 v30, 1, v27
s_add_u32 s82, s81, 0
v_and_b32 v29, 1, v26
v_add_u32 v32, s82, v30
v_lshlrev_b32 v29, 3, v29
v_and_b32 v32, 7, v32
v_add_u32 v32, v32, v29
v_add_u32 v33, s83, v32
s_add_u32 s82, s81, 1
v_add_u32 v32, s82, v30
mu 216,8,216
s_mov_b32 s86, 0x17a
v_and_b32 v32, 7, v32
v_mul_u32_u24 v8, 0x300, v33
v_cmp_gt_u32 vcc, s86, v33
v_add_u32 v32, v32, v29
v_add_u32 v33, s83, v32
s_add_u32 s82, s81, 2
v_add_u32 v32, s82, v30
v_rcp_f32 v250, v250
s_add_u32 s82, s81, 3
s_lshl_b32 s44, s20, 10
mu 224,16,224
mu 225,17,225
mu 226,18,226
mu 227,19,227
s_add_u32 s45, s44, 0x120000
mu 224,250,224
mu 225,250,225
mu 226,250,226
mu 227,250,227
s_add_u32 m0, s44, 0x12000
cv 168,224,225
cv 169,226,227
mu 228,250,228
v_cvt_pk_bf16_f32 v170, v228, 0
s_barrier
buffer_load_dwordx4 v[224:227], v1, s[12:15], s85 offen offset:0
buffer_load_dwordx4 v[228:231], v1, s[12:15], s85 offen offset:1024
buffer_load_dwordx4 v[60:63], v1, s[12:15], s85 offen offset:2048
dm 1,12,45,0
s_and_b32 s44, s20, 1
s_lshl_b32 s44, s44, 10
s_add_u32 s45, s44, 0x121000
s_add_u32 m0, s44, 0x13000
v_and_b32 v31, 1, v27
v_lshrrev_b32 v28, 1, v26
v_lshlrev_b32 v31, 4, v31
v_lshl_add_u32 v31, v28, 5, v31
v_mov_b32 v34, 0x80000000
v_add_u32 v8, v8, v31
v_cndmask_b32 v8, v34, v8, vcc
mu 217,9,217
v_cmp_gt_u32 vcc, s86, v33
v_mul_u32_u24 v9, 0x300, v33
v_and_b32 v32, 7, v32
v_add_u32 v9, v9, v31
v_add_u32 v32, v32, v29
v_cndmask_b32 v9, v34, v9, vcc
v_add_u32 v33, s83, v32
mu 218,10,218
v_cmp_gt_u32 vcc, s86, v33
v_add_u32 v32, s82, v30
v_mul_u32_u24 v10, 0x300, v33
v_and_b32 v32, 7, v32
v_add_u32 v10, v10, v31
v_add_u32 v32, v32, v29
v_cndmask_b32 v10, v34, v10, vcc
v_add_u32 v33, s83, v32
mu 219,11,219
v_cmp_gt_u32 vcc, s86, v33
dm 1,12,45,0
s_add_u32 m0, s80, 0x15000
s_add_u32 s81, s42, 0
v_mul_u32_u24 v11, 0x300, v33
v_add_u32 v11, v11, v31
v_cndmask_b32 v11, v34, v11, vcc
cv 34,232,233
cv 35,234,235
mvvvz 232,100,156
wv 13
s_barrier
dm 8,8,81,0
s_add_u32 m0, s80, 0x15400
s_add_u32 s81, s43, 0
s_mov_b64 exec, s[58:59]
ds_write_b64 v20, v[34:35] offset:576
s_mov_b64 exec, -1
v_mov_b32 v163, 0
cv 34,236,237
cv 35,238,239
mvvvc 232,104,160
dm 9,8,81,0
mvvvz 236,108,156
s_add_u32 m0, s80, 0x15800
s_add_u32 s81, s46, 0
s_mov_b64 exec, s[58:59]
ds_write_b64 v20, v[34:35] offset:584
s_mov_b64 exec, -1
mvvvc 236,112,160
s_lshl_b32 s44, s20, 10
dm 10,8,81,0
s_add_u32 s45, s44, 0x121800
s_add_u32 m0, s44, 0x13800
s_and_b32 s44, s20, 1
s_lshl_b32 s44, s44, 10
mu 220,12,220
mu 221,13,221
mu 222,14,222
mu 223,15,223
mu 216,250,216
mu 217,250,217
mu 218,250,218
mu 219,250,219
mu 220,250,220
mu 221,250,221
mu 222,250,222
mu 223,250,223
cv 164,216,217
cv 165,218,219
cv 166,220,221
cv 167,222,223
cv 34,240,241
cv 35,242,243
mvvvz 240,116,156
dm 1,12,45,0
mvvvc 240,120,160
s_add_u32 s45, s44, 0x122800
s_mov_b64 exec, s[58:59]
ds_write_b64 v20, v[34:35] offset:640
s_mov_b64 exec, -1
s_add_u32 m0, s44, 0x14800
cv 150,196,197
cv 151,198,199
mvvvz 196,108,164
dm 1,12,45,0
mvaaz 108,20,180
s_add_u32 m0, s80, 0x15c00
s_add_u32 s81, s47, 0
v_mov_b32 v171, 0
cv 152,200,201
cv 153,202,203
mvvvc 196,112,168
dm 11,8,81,0
mvvvz 200,116,164
buffer_load_dwordx4 v[112:115], v1, s[12:15], s77 offen offset:0
mvvvc 200,120,168
s_mov_b32 s98, L_round-L_cp4
buffer_load_dwordx4 v[116:119], v1, s[12:15], s77 offen offset:1024
cv 34,244,245
cv 35,246,247
mvvvz 244,124,156
s_mov_b64 exec, s[58:59]
ds_write_b64 v20, v[34:35] offset:648
s_mov_b64 exec, -1
mvvvc 244,128,160
s_getpc_b64 s[96:97]
L_cp4:
cv 34,184,185
cv 35,186,187
mvvvz 184,132,156
s_mov_b64 exec, s[58:59]
ds_write_b64 v20, v[34:35] offset:704
s_mov_b64 exec, -1
mvvvc 184,136,160
s_mov_b32 s99, L_out-L_round
cv 34,188,189
cv 35,190,191
mvvvz 188,140,156
buffer_load_dwordx4 v[120:123], v1, s[12:15], s77 offen offset:2048
mvvvc 188,144,160
cv 154,204,205
cv 155,206,207
mvvvz 204,124,164
buffer_load_dwordx4 v[124:127], v1, s[12:15], s77 offen offset:3072
mvvvc 204,128,168
cv 148,192,193
cv 149,194,195
mvvvz 192,100,164
cv 180,208,209
cv 181,210,211
mvvvc 192,104,168
cv 182,212,213
cv 183,214,215
mvvvz 208,132,164
cv 156,232,233
cv 157,234,235
mvvvc 208,136,168
cv 158,236,237
cv 159,238,239
mvvvz 212,140,164
cv 160,240,241
cv 161,242,243
mvvvc 212,144,168
wl 10
cv 162,244,245
cv 163,246,247
mvvac 36,148,228
wl 9
cv 164,192,193
cv 165,194,195
mvvac 36,152,232
cv 166,196,197
cv 167,198,199
mvvac 40,156,228
cv 168,200,201
cv 169,202,203
mvvac 40,160,232
cv 170,204,205
cv 171,206,207
mvvac 44,164,228
cv 252,184,185
cv 253,186,187
mvvac 44,168,232
wl 8
cv 254,188,189
cv 255,190,191
mvvac 36,180,236
cv 172,208,209
cv 173,210,211
mvvac 40,252,236
wl 7
cv 174,212,213
cv 175,214,215
mvvac 48,148,240
v_add_u32 v3, 0x6000, v1
v_and_b32 v6, 3, v0
mvvac 44,172,236
wl 6
ra 228,3,0
v_xor_b32 v32, 1, v6
mvvac 48,152,244
ra 232,3,1024
v_lshl_or_b32 v6, v32, 2, v6
mvvac 52,156,240
ra 236,3,2048
v_add_u32 v4, 0xc000, v1
mvvac 52,160,244
v_add_u32 v5, 0x12000, v1
v_mul_u32_u24 v6, 0x1111, v6
mvvac 56,164,240
ra 240,3,3072
v_add_u32 v2, 0, v1
mvvac 56,168,244
wl 9
ra 244,3,4096
mvvac 48,180,248
s_mov_b64 exec, s[58:59]
ds_write_b64 v20, v[34:35] offset:712
s_mov_b64 exec, -1
mvvac 52,252,248
mvvac 56,172,248
ra 248,3,5120
cv 208,36,48
mvaaz 100,12,180
wl 6
cv 210,37,49
cv 244,38,50
mvaac 100,144,228
wl 5
cv 246,39,51
cv 248,40,52
mvaac 100,156,232
cv 250,41,53
cv 24,42,54
mvaaz 104,16,180
cv 26,43,55
cv 28,44,56
mvaac 104,148,228
cv 30,45,57
cv 32,46,58
mvaac 104,160,232
cv 204,47,59
mvaac 108,152,228
ra 228,3,6144
mvaac 108,164,232
wl 5
ra 232,3,7168
mvaac 100,168,236
wl 5
mvaac 100,192,240
mvaac 104,172,236
mvaac 104,196,240
mvaac 108,176,236
ra 236,3,8192
mvaac 108,200,240
wl 5
ra 240,3,9216
s_add_u32 m0, s80, 0x19000
mvaac 100,204,244
wl 4
s_add_u32 s81, s42, 64
mvaac 100,216,248
dm 8,8,81,0
mvaac 104,208,244
mvaac 104,220,248
mvaac 108,212,244
ra 244,3,10240
mvaac 108,224,248
wl 4
ra 248,3,11264
s_add_u32 m0, s80, 0x19400
mvvac 100,64,228
wl 4
s_add_u32 s81, s43, 64
mvvac 100,76,232
dm 9,8,81,0
mvvac 104,68,228
mvvac 104,80,232
wv 6
s_barrier
rv 136,5,2048
mvvac 108,72,228
ra 228,3,12288
mvvac 108,84,232
wl 5
ra 232,3,13312
s_add_u32 m0, s80, 0x19800
mvvac 100,88,236
wl 5
s_add_u32 s81, s46, 64
rv 128,5,0
mvvac 100,148,240
dm 10,8,81,0
mvvac 104,92,236
rv 132,5,1024
mvvac 104,156,240
mvvac 108,96,236
ra 236,3,14336
mvvac 108,164,240
wl 7
ra 240,3,15360
s_add_u32 m0, s80, 0x19c00
mvvac 100,152,244
wl 7
s_add_u32 s81, s47, 64
s_add_u32 s22, s23, 0
s_add_u32 s25, s24, 0x1000
mvvac 100,180,248
dm 11,8,81,0
mvvac 104,160,244
s_mov_b32 m0, s22
mvvac 104,252,248
mvvac 108,168,244
ra 244,3,16384
mvvac 108,172,248
ra 248,3,17408
mvaaz 36,12,184
wl 7
mvaac 36,144,228
wl 6
mvaac 36,156,232
mvaaz 40,16,184
mvaac 40,148,228
mvaac 40,160,232
mvaaz 44,20,184
mvaac 44,152,228
ra 228,3,18432
mvaac 44,164,232
wl 4
ra 232,3,19456
mvaac 36,168,236
wl 4
dm 1,12,24,0
mvaac 36,192,240
s_mov_b32 m0, s22
mvaac 40,172,236
mvaac 40,196,240
mvaac 44,176,236
ra 236,3,20480
mvaac 44,200,240
wl 4
ra 240,3,21504
mvaac 36,204,244
wl 4
dm 1,12,24,1024
mvaac 36,216,248
s_mov_b32 m0, s22
mvaac 40,208,244
mvaac 40,220,248
mvaac 44,212,244
ra 244,3,22528
mvaac 44,224,248
wl 4
ra 248,3,23552
v_add_u32 v3, 0x6000, v1
mvvac 36,64,228
wl 4
dm 1,12,24,2048
mvvac 36,76,232
s_mov_b32 m0, s22
mvvac 40,68,228
mvvac 40,80,232
mvvac 44,72,228
ra 228,4,0
mvvac 44,84,232
wl 4
ra 232,4,1024
mvvac 36,88,236
wl 4
dm 1,12,24,3072
mvvac 36,148,240
s_add_u32 m0, s22, 0x1000
mvvac 40,92,236
mvvac 40,156,240
v_add_u32 v224, s39, v224
v_add_u32 v225, s39, v225
mvvac 44,96,236
ra 236,4,2048
v_add_u32 v226, s39, v226
mvvac 44,164,240
wl 4
ra 240,4,3072
v_add_u32 v227, s39, v227
mvvac 36,152,244
wl 4
dm 1,12,25,0
mvvac 36,180,248
s_add_u32 m0, s22, 0x1000
s_add_u32 s24, s24, 0x6000
v_add_u32 v228, s39, v228
mvvac 40,160,244
v_add_u32 v229, s39, v229
v_add_u32 v230, s39, v230
mvvac 40,252,248
cv 209,100,36
cv 211,101,37
mvvac 44,168,244
ra 244,4,4096
cv 245,102,38
mvvac 44,172,248
ra 248,4,5120
cv 247,103,39
mvaaz 48,24,180
wl 5
dm 1,12,25,1024
mvaac 48,144,228
wl 4
cv 249,104,40
cv 251,105,41
mvaac 48,156,232
cv 25,106,42
cv 27,107,43
mvaaz 52,28,180
cv 29,108,44
cv 31,109,45
mvaac 52,148,228
cv 33,110,46
cv 205,111,47
mvaac 52,160,232
buffer_store_dwordx2 v[208:209], v224, s[16:19], 0 offen offset:0
mvaaz 56,32,180
v_add_u32 v231, s39, v231
v_add_u32 v60, s39, v60
mvaac 56,152,228
ra 228,4,6144
v_add_u32 v61, s39, v61
mvaac 56,164,232
wl 4
ra 232,4,7168
s_add_u32 m0, s80, 0x1d000
mvaac 48,168,236
wl 4
s_add_u32 s81, s42, 0x80
v_add_u32 v62, s39, v62
v_add_u32 v63, s39, v63
mvaac 48,192,240
dm 8,8,81,0
mvaac 52,172,236
wv 14
rv 200,116,0
mvaac 52,196,240
rv 184,112,0
rv 188,113,0
mvaac 56,176,236
ra 236,4,8192
rv 192,114,0
mvaac 56,200,240
wl 8
ra 240,4,9216
rv 196,115,0
mvaac 48,204,244
wl 9
rv 140,117,0
rv 144,118,0
mvaac 48,216,248
s_waitcnt vmcnt(13) lgkmcnt(8)
s_add_u32 m0, s80, 0x1d400
s_add_u32 s81, s43, 0x80
rv 176,121,0
mvvvz 232,136,200
s_waitcnt vmcnt(12) lgkmcnt(7)
rv 200,126,0
v_smfmac_f32_16x16x64_bf16 v[232:235], v[128:131], v[184:191], v6
rv 184,119,0
rv 188,120,0
mvaac 52,208,244
mvaac 52,220,248
mvaac 56,212,244
wl 6
ra 244,4,10240
v_smfmac_f32_16x16x64_bf16 v[232:235], v[132:135], v[192:199], v6
rv 192,122,0
rv 196,123,0
mvaac 56,224,248
wl 6
ra 248,4,11264
mvvvz 236,136,176
buffer_store_dwordx2 v[210:211], v225, s[16:19], 0 offen offset:0
v_smfmac_f32_16x16x64_bf16 v[236:239], v[128:131], v[140:147], v6
wl 6
dm 9,8,81,0
mvvvz 240,136,200
wl 4
rv 140,124,0
s_add_u32 m0, s80, 0x1d800
v_smfmac_f32_16x16x64_bf16 v[236:239], v[132:135], v[184:191], v6
rv 144,125,0
s_add_u32 s81, s46, 0x80
mvvac 48,64,228
rv 136,5,5120
rv 176,116,512
mvvac 48,76,232
wl 5
dm 10,8,81,0
v_smfmac_f32_16x16x64_bf16 v[240:243], v[128:131], v[192:199], v6
buffer_store_dwordx2 v[244:245], v226, s[16:19], 0 offen offset:0
mvvac 52,68,228
rv 128,5,3072
s_add_u32 m0, s80, 0x1dc00
mvvac 52,80,232
rv 184,112,512
s_add_u32 s81, s47, 0x80
mvvac 56,72,228
wl 4
ra 228,4,12288
mu 15,232,232
v_smfmac_f32_16x16x64_bf16 v[240:243], v[132:135], v[140:147], v6
rv 188,113,512
rv 132,5,4096
mvvac 56,84,232
ra 232,4,13312
rv 192,114,512
mvvac 48,88,236
rv 196,115,512
ad 12,232,233
mvvac 48,148,240
dm 11,8,81,0
mvvac 52,92,236
buffer_store_dwordx2 v[246:247], v227, s[16:19], 0 offen offset:0
mvvac 52,156,240
rv 200,121,512
v_fma_f32 v15, v233, v233, v15
mvvac 56,96,236
ra 236,4,14336
ad 12,12,234
mvvac 56,164,240
ra 240,4,15360
v_fma_f32 v15, v234, v234, v15
mvvac 48,152,244
ad 12,12,235
v_fma_f32 v15, v235, v235, v15
mvvac 48,180,248
wl 11
cv 212,232,233
cv 213,234,235
mvvvz 232,136,176
wl 7
rv 140,117,512
mu 16,236,236
v_smfmac_f32_16x16x64_bf16 v[232:235], v[128:131], v[184:191], v6
wl 4
rv 144,118,512
ad 13,236,237
v_smfmac_f32_16x16x64_bf16 v[232:235], v[132:135], v[192:199], v6
rv 184,119,512
rv 188,120,512
mvvac 52,160,244
buffer_store_dwordx2 v[248:249], v228, s[16:19], 0 offen offset:0
mvvac 52,252,248
rv 176,126,512
v_fma_f32 v16, v237, v237, v16
mvvac 56,168,244
ra 244,4,16384
ad 13,13,238
mvvac 56,172,248
ra 248,4,17408
v_fma_f32 v16, v238, v238, v16
mvaaz 100,24,184
ad 13,13,239
v_fma_f32 v16, v239, v239, v16
mvaac 100,144,228
wl 9
cv 214,236,237
cv 215,238,239
mvvvz 236,136,200
wl 5
rv 192,122,512
mu 17,240,240
v_smfmac_f32_16x16x64_bf16 v[236:239], v[128:131], v[140:147], v6
wl 4
rv 196,123,512
ad 14,240,241
v_smfmac_f32_16x16x64_bf16 v[236:239], v[132:135], v[184:191], v6
rv 140,124,512
rv 144,125,512
mvaac 100,156,232
buffer_store_dwordx2 v[250:251], v229, s[16:19], 0 offen offset:0
mvaaz 104,28,184
v_fma_f32 v17, v241, v241, v17
aw 0,212
mvaac 104,148,228
aw 12,213
ad 14,14,242
mvaac 104,160,232
v_fma_f32 v17, v242, v242, v17
ad 14,14,243
mvaaz 108,32,184
v_fma_f32 v17, v243, v243, v17
cv 212,240,241
mvaac 108,152,228
wl 6
ra 228,4,18432
cv 213,242,243
mvvvz 240,136,176
wl 3
buffer_store_dwordx2 v[24:25], v230, s[16:19], 0 offen offset:0
v_smfmac_f32_16x16x64_bf16 v[240:243], v[128:131], v[192:199], v6
wl 1
buffer_store_dwordx2 v[26:27], v231, s[16:19], 0 offen offset:0
v_smfmac_f32_16x16x64_bf16 v[240:243], v[132:135], v[140:147], v6
ad 12,12,232
mvaac 108,164,232
ra 232,4,19456
v_fma_f32 v15, v232, v232, v15
mvaac 100,168,236
ad 12,12,233
v_fma_f32 v15, v233, v233, v15
mvaac 100,192,240
aw 4,214
aw 16,215
mvaac 104,172,236
ad 12,12,234
v_fma_f32 v15, v234, v234, v15
mvaac 104,196,240
buffer_store_dwordx2 v[28:29], v60, s[16:19], 0 offen offset:0
mvaac 108,176,236
ra 236,4,20480
ad 12,12,235
mvaac 108,200,240
ra 240,4,21504
v_fma_f32 v15, v235, v235, v15
mvaac 100,204,244
cv 214,232,233
cv 215,234,235
mvaac 100,216,248
ad 13,13,236
v_fma_f32 v16, v236, v236, v16
mvaac 104,208,244
ad 13,13,237
wv 13
s_barrier
mvaac 104,220,248
rv 136,5,8192
v_fma_f32 v16, v237, v237, v16
mvaac 108,212,244
ra 244,4,22528
aw 8,212
mvaac 108,224,248
wl 5
ra 248,4,23552
aw 20,213
mvvac 100,64,228
wl 5
buffer_store_dwordx2 v[30:31], v61, s[16:19], 0 offen offset:0
mvvac 100,76,232
rv 200,116,16384
ad 13,13,238
mvvac 104,68,228
s_lshl_b32 s44, s20, 10
s_add_u32 s45, s44, 0x123000
s_add_u32 m0, s44, 0x12000
mvvac 104,80,232
rv 128,5,6144
v_fma_f32 v16, v238, v238, v16
mvvac 108,72,228
ra 228,2,0
s_and_b32 s44, s20, 1
mvvac 108,84,232
wl 7
ra 232,2,1024
s_lshl_b32 s44, s44, 10
mvvac 100,88,236
wl 7
dm 1,12,45,0
mvvac 100,148,240
s_add_u32 s45, s44, 0x124000
s_add_u32 m0, s44, 0x13000
s_add_u32 s22, s23, 0x6000
mvvac 104,92,236
rv 184,112,16384
ad 13,13,239
mvvac 104,156,240
dm 1,12,45,0
mvvac 108,96,236
ra 236,2,2048
s_mov_b32 m0, s22
mvvac 108,164,240
wl 7
ra 240,2,3072
v_fma_f32 v16, v239, v239, v16
mvvac 100,152,244
wl 7
buffer_store_dwordx2 v[32:33], v62, s[16:19], 0 offen offset:0
mvvac 100,180,248
dm 1,12,24,0
mvvac 104,160,244
rv 188,113,16384
s_mov_b32 m0, s22
mvvac 104,252,248
rv 132,5,7168
cv 212,236,237
mvvac 108,168,244
ra 244,2,4096
cv 213,238,239
mvvac 108,172,248
ra 248,2,5120
s_add_u32 s25, s24, 0x1000
mvaaz 36,36,180
wl 8
dm 1,12,24,1024
mvaac 36,144,228
wl 7
buffer_store_dwordx2 v[204:205], v63, s[16:19], 0 offen offset:0
mvaac 36,156,232
rv 192,114,16384
s_mov_b32 m0, s22
mvaaz 40,40,180
rv 196,115,16384
ad 14,14,240
mvaac 40,148,228
dm 1,12,24,2048
mvaac 40,160,232
rv 176,121,16384
s_mov_b32 m0, s22
mvaaz 44,44,180
rv 140,117,16384
v_fma_f32 v17, v240, v240, v17
mvaac 44,152,228
ra 228,2,6144
ad 14,14,241
mvaac 44,164,232
ra 232,2,7168
v_fma_f32 v17, v241, v241, v17
mvvvz 232,136,200
wl 9
rv 144,118,16384
aw 1,214
v_smfmac_f32_16x16x64_bf16 v[232:235], v[128:131], v[184:191], v6
wl 5
rv 184,119,16384
aw 13,215
v_smfmac_f32_16x16x64_bf16 v[232:235], v[132:135], v[192:199], v6
rv 188,120,16384
ad 14,14,242
mvaac 36,168,236
dm 1,12,24,3072
mvaac 36,192,240
rv 200,126,16384
s_add_u32 m0, s22, 0x1000
mvaac 40,172,236
rv 192,122,16384
v_fma_f32 v17, v242, v242, v17
mvaac 40,196,240
dm 1,12,25,0
mvaac 44,176,236
ra 236,2,8192
s_add_u32 m0, s22, 0x1000
mvaac 44,200,240
wl 9
ra 240,2,9216
s_add_u32 s24, s24, 0x6000
mvvvz 236,136,176
wl 6
rv 196,123,16384
ad 14,14,243
v_smfmac_f32_16x16x64_bf16 v[236:239], v[128:131], v[140:147], v6
wl 5
rv 140,124,16384
v_fma_f32 v17, v243, v243, v17
v_smfmac_f32_16x16x64_bf16 v[236:239], v[132:135], v[184:191], v6
rv 144,125,16384
cv 214,240,241
mvaac 36,204,244
dm 1,12,25,1024
mvaac 36,216,248
rv 176,116,16896
cv 215,242,243
mvaac 40,208,244
rv 184,112,16896
ad 12,12,232
mvaac 40,220,248
rv 188,113,16896
v_fma_f32 v15, v232, v232, v15
mvaac 44,212,244
ra 244,2,10240
ad 12,12,233
mvaac 44,224,248
wl 10
ra 248,2,11264
v_fma_f32 v15, v233, v233, v15
mvvvz 240,136,200
wl 7
rv 136,5,11264
aw 5,212
v_smfmac_f32_16x16x64_bf16 v[240:243], v[128:131], v[192:199], v6
wl 6
rv 128,5,9216
aw 17,213
v_smfmac_f32_16x16x64_bf16 v[240:243], v[132:135], v[140:147], v6
rv 132,5,10240
s_add_u32 m0, s80, 0x15000
mvvac 36,64,228
rv 192,114,16896
s_add_u32 s81, s42, 0xc0
mvvac 36,76,232
rv 196,115,16896
ad 12,12,234
mvvac 40,68,228
dm 8,8,81,0
mvvac 40,80,232
rv 200,121,16896
v_fma_f32 v15, v234, v234, v15
mvvac 44,72,228
ra 228,2,12288
ad 12,12,235
mvvac 44,84,232
ra 232,2,13312
v_fma_f32 v15, v235, v235, v15
mvvac 36,88,236
wl 7
cv 212,232,233
cv 213,234,235
mvvvz 232,136,176
wl 6
rv 140,117,16896
s_add_u32 m0, s80, 0x15400
v_smfmac_f32_16x16x64_bf16 v[232:235], v[128:131], v[184:191], v6
wl 4
rv 144,118,16896
s_add_u32 s81, s43, 0xc0
v_smfmac_f32_16x16x64_bf16 v[232:235], v[132:135], v[192:199], v6
rv 184,119,16896
ad 13,13,236
mvvac 36,148,240
rv 188,120,16896
v_fma_f32 v16, v236, v236, v16
mvvac 40,92,236
dm 9,8,81,0
mvvac 40,156,240
rv 176,126,16896
ad 13,13,237
mvvac 44,96,236
ra 236,2,14336
v_fma_f32 v16, v237, v237, v16
mvvac 44,164,240
ra 240,2,15360
aw 9,214
mvvac 36,152,244
aw 21,215
ad 13,13,238
mvvac 36,180,248
v_fma_f32 v16, v238, v238, v16
ad 13,13,239
mvvac 40,160,244
v_fma_f32 v16, v239, v239, v16
cv 214,236,237
mvvac 40,252,248
wl 9
cv 215,238,239
s_add_u32 m0, s80, 0x15800
mvvvz 236,136,200
wl 5
rv 192,122,16896
s_add_u32 s81, s46, 0xc0
v_smfmac_f32_16x16x64_bf16 v[236:239], v[128:131], v[140:147], v6
wl 4
rv 196,123,16896
ad 14,14,240
v_smfmac_f32_16x16x64_bf16 v[236:239], v[132:135], v[184:191], v6
dm 10,8,81,0
mvvac 44,168,244
ra 244,2,16384
s_add_u32 m0, s80, 0x15c00
mvvac 44,172,248
s_add_u32 s81, s47, 0xc0
rv 140,124,16896
rv 144,125,16896
v_fma_f32 v17, v240, v240, v17
ra 248,2,17408
ad 14,14,241
v_fma_f32 v17, v241, v241, v17
aw 2,212
aw 14,213
ad 14,14,242
v_fma_f32 v17, v242, v242, v17
ad 14,14,243
v_fma_f32 v17, v243, v243, v17
cv 212,240,241
cv 213,242,243
wl 8
mvvvz 240,136,176
wl 4
dm 11,8,81,0
v_smfmac_f32_16x16x64_bf16 v[240:243], v[128:131], v[192:199], v6
cv 208,48,100
cv 210,49,101
cv 244,50,102
cv 246,51,103
mvaaz 48,36,184
wl 1
cv 248,52,104
cv 250,53,105
v_smfmac_f32_16x16x64_bf16 v[240:243], v[132:135], v[140:147], v6
cv 24,54,106
mvaac 48,144,228
cv 26,55,107
cv 28,56,108
mvaac 48,156,232
cv 30,57,109
cv 32,58,110
mvaaz 52,40,184
cv 204,59,111
ad 12,12,232
mvaac 52,148,228
v_fma_f32 v15, v232, v232, v15
ad 12,12,233
mvaac 52,160,232
v_fma_f32 v15, v233, v233, v15
aw 6,214
mvaaz 56,44,184
aw 18,215
ad 12,12,234
mvaac 56,152,228
ra 228,2,18432
v_fma_f32 v15, v234, v234, v15
mvaac 56,164,232
ra 232,2,19456
ad 12,12,235
mvaac 48,168,236
v_fma_f32 v15, v235, v235, v15
cv 214,232,233
mvaac 48,192,240
cv 215,234,235
ad 13,13,236
mvaac 52,172,236
v_fma_f32 v16, v236, v236, v16
ad 13,13,237
mvaac 52,196,240
v_fma_f32 v16, v237, v237, v16
aw 10,212
mvaac 56,176,236
ra 236,2,20480
aw 22,213
mvaac 56,200,240
ra 240,2,21504
ad 13,13,238
mvaac 48,204,244
wl 4
v_fma_f32 v16, v238, v238, v16
ad 13,13,239
mvaac 48,216,248
v_fma_f32 v16, v239, v239, v16
cv 212,236,237
mvaac 52,208,244
cv 213,238,239
wv 4
s_barrier
mvaac 52,220,248
rv 136,5,2048
ad 14,14,240
mvaac 56,212,244
ra 244,2,22528
v_fma_f32 v17, v240, v240, v17
mvaac 56,224,248
wl 5
ra 248,2,23552
ad 14,14,241
mvvac 48,64,228
wl 5
rv 200,116,32768
v_fma_f32 v17, v241, v241, v17
mvvac 48,76,232
rv 128,5,0
aw 3,214
mvvac 52,68,228
rv 184,112,32768
s_lshl_b32 s44, s20, 10
mvvac 52,80,232
s_add_u32 s45, s44, 0x124800
s_add_u32 m0, s44, 0x13800
rv 188,113,32768
mvvac 56,72,228
ra 228,3,0
s_and_b32 s44, s20, 1
mvvac 56,84,232
wl 9
ra 232,3,1024
s_lshl_b32 s44, s44, 10
mvvac 48,88,236
wl 9
dm 1,12,45,0
mvvac 48,148,240
s_add_u32 s45, s44, 0x125800
s_add_u32 m0, s44, 0x14800
s_add_u32 s22, s23, 0xc000
mvvac 52,92,236
rv 132,5,1024
s_add_u32 s25, s24, 0x1000
mvvac 52,156,240
dm 1,12,45,0
mvvac 56,96,236
ra 236,3,2048
s_mov_b32 m0, s22
mvvac 56,164,240
wl 9
ra 240,3,3072
aw 15,215
mvvac 48,152,244
wl 9
dm 1,12,24,0
mvvac 48,180,248
s_mov_b32 m0, s22
rv 192,114,32768
ad 14,14,242
mvvac 52,160,244
dm 1,12,24,1024
mvvac 52,252,248
rv 196,115,32768
s_mov_b32 m0, s22
mvvac 56,168,244
ra 244,3,4096
cv 209,36,48
mvvac 56,172,248
ra 248,3,5120
cv 211,37,49
mvaaz 100,48,180
wl 8
rv 176,121,32768
v_fma_f32 v17, v242, v242, v17
mvaac 100,144,228
wl 8
dm 1,12,24,2048
mvaac 100,156,232
rv 140,117,32768
s_mov_b32 m0, s22
mvaaz 104,52,180
rv 144,118,32768
ad 14,14,243
mvaac 104,148,228
v_fma_f32 v17, v243, v243, v17
cv 214,240,241
mvaac 104,160,232
buffer_store_dwordx2 v[208:209], v224, s[16:19], 0 offen offset:128
mvaaz 108,56,180
cv 215,242,243
cv 245,38,50
mvaac 108,152,228
ra 228,3,6144
aw 7,212
mvaac 108,164,232
ra 232,3,7168
aw 19,213
mvvvz 232,136,200
dm 1,12,24,3072
v_smfmac_f32_16x16x64_bf16 v[232:235], v[128:131], v[184:191], v6
wl 7
rv 184,119,32768
s_add_u32 m0, s22, 0x1000
v_smfmac_f32_16x16x64_bf16 v[232:235], v[132:135], v[192:199], v6
rv 188,120,32768
cv 247,39,51
mvaac 100,168,236
rv 200,126,32768
cv 249,40,52
mvaac 100,192,240
dm 1,12,25,0
mvaac 104,172,236
buffer_store_dwordx2 v[210:211], v225, s[16:19], 0 offen offset:128
mvaac 104,196,240
rv 192,122,32768
s_add_u32 m0, s22, 0x1000
mvaac 108,176,236
ra 236,3,8192
s_add_u32 s24, s24, 0x6000
mvaac 108,200,240
wl 9
ra 240,3,9216
ad 12,12,232
mvvvz 236,136,176
wl 8
rv 196,123,32768
v_fma_f32 v15, v232, v232, v15
v_smfmac_f32_16x16x64_bf16 v[236:239], v[128:131], v[140:147], v6
wl 5
rv 140,124,32768
ad 12,12,233
v_smfmac_f32_16x16x64_bf16 v[236:239], v[132:135], v[184:191], v6
rv 144,125,32768
v_fma_f32 v15, v233, v233, v15
mvaac 100,204,244
dm 1,12,25,1024
mvaac 100,216,248
buffer_store_dwordx2 v[244:245], v226, s[16:19], 0 offen offset:128
mvaac 104,208,244
rv 176,116,33280
ad 12,12,234
mvaac 104,220,248
rv 184,112,33280
v_fma_f32 v15, v234, v234, v15
mvaac 108,212,244
ra 244,3,10240
ad 12,12,235
mvaac 108,224,248
wl 9
ra 248,3,11264
v_fma_f32 v15, v235, v235, v15
mvvvz 240,136,200
wl 6
rv 136,5,5120
cv 212,232,233
v_smfmac_f32_16x16x64_bf16 v[240:243], v[128:131], v[192:199], v6
wl 5
rv 128,5,3072
cv 213,234,235
v_smfmac_f32_16x16x64_bf16 v[240:243], v[132:135], v[140:147], v6
rv 188,113,33280
s_add_u32 m0, s80, 0x19000
mvvac 100,64,228
rv 132,5,4096
s_add_u32 s81, s42, 0x100
mvvac 100,76,232
rv 192,114,33280
rv 196,115,33280
mvvac 104,68,228
dm 8,8,81,0
mvvac 104,80,232
buffer_store_dwordx2 v[246:247], v227, s[16:19], 0 offen offset:128
mvvac 108,72,228
ra 228,3,12288
ad 13,13,236
mvvac 108,84,232
wl 6
ra 232,3,13312
s_add_u32 m0, s80, 0x19400
mvvvz 232,136,176
wl 5
rv 200,121,33280
s_add_u32 s81, s43, 0x100
v_smfmac_f32_16x16x64_bf16 v[232:235], v[128:131], v[184:191], v6
rv 140,117,33280
v_fma_f32 v16, v236, v236, v16
mvvac 100,88,236
wl 4
rv 144,118,33280
ad 13,13,237
v_smfmac_f32_16x16x64_bf16 v[232:235], v[132:135], v[192:199], v6
rv 184,119,33280
v_fma_f32 v16, v237, v237, v16
mvvac 100,148,240
rv 188,120,33280
aw 11,214
mvvac 104,92,236
dm 9,8,81,0
mvvac 104,156,240
buffer_store_dwordx2 v[248:249], v228, s[16:19], 0 offen offset:128
mvvac 108,96,236
ra 236,3,14336
aw 23,215
mvvac 108,164,240
ra 240,3,15360
ad 13,13,238
mvvac 100,152,244
rv 176,126,33280
v_fma_f32 v16, v238, v238, v16
mvvac 100,180,248
ad 13,13,239
v_fma_f32 v16, v239, v239, v16
mvvac 104,160,244
wl 7
cv 214,236,237
cv 215,238,239
mvvvz 236,136,200
wl 5
rv 192,122,33280
s_add_u32 m0, s80, 0x19800
v_smfmac_f32_16x16x64_bf16 v[236:239], v[128:131], v[140:147], v6
wl 4
rv 196,123,33280
s_add_u32 s81, s46, 0x100
v_smfmac_f32_16x16x64_bf16 v[236:239], v[132:135], v[184:191], v6
rv 140,124,33280
cv 251,41,53
mvvac 104,252,248
dm 10,8,81,0
mvvac 108,168,244
ra 244,3,16384
s_add_u32 m0, s80, 0x19c00
mvvac 108,172,248
ra 248,3,17408
s_add_u32 s81, s47, 0x100
mvaaz 36,48,184
rv 144,125,33280
ad 14,14,240
mvaac 36,144,228
buffer_store_dwordx2 v[250:251], v229, s[16:19], 0 offen offset:128
mvaac 36,156,232
wl 8
dm 11,8,81,0
mvaac 36,168,236
wl 7
v_fma_f32 v17, v240, v240, v17
ad 14,14,241
mvaac 36,192,240
wl 2
v_fma_f32 v17, v241, v241, v17
aw 24,212
mvaac 36,204,244
wl 1
aw 36,213
ad 14,14,242
mvaac 36,216,248
v_fma_f32 v17, v242, v242, v17
ad 14,14,243
mvaaz 48,60,180
v_fma_f32 v17, v243, v243, v17
cv 212,240,241
cv 213,242,243
mvvvz 240,136,176
cv 25,42,54
cv 27,43,55
v_smfmac_f32_16x16x64_bf16 v[240:243], v[128:131], v[192:199], v6
wl 0
buffer_store_dwordx2 v[24:25], v230, s[16:19], 0 offen offset:128
v_smfmac_f32_16x16x64_bf16 v[240:243], v[132:135], v[140:147], v6
buffer_store_dwordx2 v[26:27], v231, s[16:19], 0 offen offset:128
mvaaz 40,52,184
cv 29,44,56
cv 31,45,57
mvaac 40,148,228
cv 33,46,58
cv 205,47,59
mvaac 40,160,232
buffer_store_dwordx2 v[28:29], v60, s[16:19], 0 offen offset:128
mvaaz 44,56,184
wv 11
s_barrier
v_add_u32 v4, 0xc000, v1
ad 12,12,232
mvaac 44,152,228
ra 228,3,18432
v_fma_f32 v15, v232, v232, v15
mvaac 44,164,232
ra 232,3,19456
ad 12,12,233
mvaac 40,172,236
rv 136,5,8192
v_fma_f32 v15, v233, v233, v15
mvaac 40,196,240
rv 200,116,0
aw 28,214
mvaac 44,176,236
ra 236,3,20480
aw 40,215
mvaac 44,200,240
ra 240,3,21504
ad 12,12,234
mvaac 40,208,244
rv 128,5,6144
v_fma_f32 v15, v234, v234, v15
mvaac 40,220,248
rv 184,112,0
ad 12,12,235
mvaac 44,212,244
ra 244,3,22528
v_fma_f32 v15, v235, v235, v15
mvaac 44,224,248
wl 8
ra 248,3,23552
cv 214,232,233
mvvac 36,64,228
wl 8
buffer_store_dwordx2 v[30:31], v61, s[16:19], 0 offen offset:128
mvvac 36,76,232
rv 188,113,0
cv 215,234,235
mvvac 40,68,228
s_lshl_b32 s44, s20, 10
s_add_u32 s45, s44, 0x126000
s_add_u32 m0, s44, 0x12000
mvvac 40,80,232
rv 132,5,7168
ad 13,13,236
mvvac 44,72,228
ra 228,4,0
s_and_b32 s44, s20, 1
mvvac 44,84,232
wl 8
ra 232,4,1024
s_lshl_b32 s44, s44, 10
mvvac 36,88,236
wl 8
dm 1,12,45,0
mvvac 36,148,240
s_add_u32 s45, s44, 0x127000
s_add_u32 m0, s44, 0x13000
s_add_u32 s22, s23, 0
mvvac 40,92,236
rv 192,114,0
v_fma_f32 v16, v236, v236, v16
mvvac 40,156,240
dm 1,12,45,0
mvvac 44,96,236
ra 236,4,2048
s_mov_b32 m0, s22
mvvac 44,164,240
wl 7
ra 240,4,3072
ad 13,13,237
mvvac 36,152,244
wl 7
buffer_store_dwordx2 v[32:33], v62, s[16:19], 0 offen offset:128
mvvac 36,180,248
dm 1,12,24,0
mvvac 40,160,244
s_mov_b32 m0, s22
rv 196,115,0
v_fma_f32 v16, v237, v237, v16
mvvac 40,252,248
dm 1,12,24,1024
mvvac 44,168,244
ra 244,4,4096
s_mov_b32 m0, s22
mvvac 44,172,248
wl 6
ra 248,4,5120
aw 32,212
mvaac 48,144,228
wl 6
buffer_store_dwordx2 v[204:205], v63, s[16:19], 0 offen offset:128
mvaac 48,156,232
dm 1,12,24,2048
mvaaz 52,64,180
rv 176,121,0
s_mov_b32 m0, s22
mvaac 52,148,228
rv 140,117,0
aw 44,213
mvaac 52,160,232
rv 144,118,0
ad 13,13,238
mvaaz 56,68,180
v_fma_f32 v16, v238, v238, v16
ad 13,13,239
mvaac 56,152,228
ra 228,4,6144
v_fma_f32 v16, v239, v239, v16
mvaac 56,164,232
ra 232,4,7168
cv 212,236,237
mvvvz 232,136,200
dm 1,12,24,3072
v_smfmac_f32_16x16x64_bf16 v[232:235], v[128:131], v[184:191], v6
wl 7
rv 184,119,0
cv 213,238,239
v_smfmac_f32_16x16x64_bf16 v[232:235], v[132:135], v[192:199], v6
rv 188,120,0
s_add_u32 s25, s24, 0x1000
mvaac 48,168,236
rv 200,126,0
s_add_u32 m0, s22, 0x1000
mvaac 48,192,240
rv 192,122,0
ad 14,14,240
mvaac 52,172,236
dm 1,12,25,0
mvaac 52,196,240
rv 196,123,0
s_add_u32 m0, s22, 0x1000
mvaac 56,176,236
ra 236,4,8192
s_add_u32 s24, s24, 0x6000
mvaac 56,200,240
wl 10
ra 240,4,9216
v_fma_f32 v17, v240, v240, v17
mvvvz 236,136,176
wl 9
rv 176,116,512
ad 14,14,241
v_smfmac_f32_16x16x64_bf16 v[236:239], v[128:131], v[140:147], v6
wl 6
rv 140,124,0
v_fma_f32 v17, v241, v241, v17
v_smfmac_f32_16x16x64_bf16 v[236:239], v[132:135], v[184:191], v6
rv 144,125,0
aw 25,214
mvaac 48,204,244
dm 1,12,25,1024
mvaac 48,216,248
aw 37,215
ad 14,14,242
mvaac 52,208,244
v_fma_f32 v17, v242, v242, v17
ad 14,14,243
mvaac 52,220,248
v_fma_f32 v17, v243, v243, v17
cv 214,240,241
mvaac 56,212,244
ra 244,4,10240
cv 215,242,243
mvaac 56,224,248
wl 8
ra 248,4,11264
ad 12,12,232
mvvvz 240,136,200
wl 7
rv 136,5,11264
v_fma_f32 v15, v232, v232, v15
v_smfmac_f32_16x16x64_bf16 v[240:243], v[128:131], v[192:199], v6
wl 3
rv 128,5,9216
ad 12,12,233
v_smfmac_f32_16x16x64_bf16 v[240:243], v[132:135], v[140:147], v6
rv 184,112,512
s_add_u32 m0, s80, 0x1d000
mvvac 48,64,228
rv 188,113,512
s_add_u32 s81, s42, 0x140
mvvac 48,76,232
rv 132,5,10240
rv 192,114,512
mvvac 52,68,228
rv 196,115,512
v_fma_f32 v15, v233, v233, v15
mvvac 52,80,232
dm 8,8,81,0
mvvac 56,72,228
ra 228,4,12288
aw 29,212
mvvac 56,84,232
ra 232,4,13312
aw 41,213
mvvac 48,88,236
rv 200,121,512
ad 12,12,234
mvvac 48,148,240
v_fma_f32 v15, v234, v234, v15
ad 12,12,235
mvvac 52,92,236
v_fma_f32 v15, v235, v235, v15
cv 212,232,233
mvvac 52,156,240
wl 9
cv 213,234,235
s_add_u32 m0, s80, 0x1d400
mvvvz 232,136,176
wl 6
rv 140,117,512
s_add_u32 s81, s43, 0x140
v_smfmac_f32_16x16x64_bf16 v[232:235], v[128:131], v[184:191], v6
wl 4
rv 144,118,512
ad 13,13,236
v_smfmac_f32_16x16x64_bf16 v[232:235], v[132:135], v[192:199], v6
rv 184,119,512
v_fma_f32 v16, v236, v236, v16
mvvac 56,96,236
ra 236,4,14336
rv 188,120,512
mvvac 56,164,240
ra 240,4,15360
ad 13,13,237
mvvac 48,152,244
dm 9,8,81,0
mvvac 48,180,248
rv 176,126,512
v_fma_f32 v16, v237, v237, v16
mvvac 52,160,244
aw 33,214
aw 45,215
mvvac 52,252,248
ad 13,13,238
v_fma_f32 v16, v238, v238, v16
mvvac 56,168,244
ra 244,4,16384
ad 13,13,239
mvvac 56,172,248
s_add_u32 m0, s80, 0x1d800
rv 192,122,512
rv 196,123,512
v_fma_f32 v16, v239, v239, v16
ra 248,4,17408
cv 214,236,237
cv 215,238,239
wl 11
mvvvz 236,136,200
wl 9
s_add_u32 s81, s46, 0x140
ad 14,14,240
v_fma_f32 v17, v240, v240, v17
v_smfmac_f32_16x16x64_bf16 v[236:239], v[128:131], v[140:147], v6
wl 6
dm 10,8,81,0
v_smfmac_f32_16x16x64_bf16 v[236:239], v[132:135], v[184:191], v6
rv 140,124,512
rv 144,125,512
s_add_u32 m0, s80, 0x1dc00
s_add_u32 s81, s47, 0x140
ad 14,14,241
v_fma_f32 v17, v241, v241, v17
aw 26,212
aw 38,213
ad 14,14,242
v_fma_f32 v17, v242, v242, v17
ad 14,14,243
v_fma_f32 v17, v243, v243, v17
cv 212,240,241
cv 213,242,243
wl 6
mvvvz 240,136,176
wl 3
dm 11,8,81,0
v_smfmac_f32_16x16x64_bf16 v[240:243], v[128:131], v[192:199], v6
cv 208,100,36
cv 210,101,37
cv 244,102,38
cv 246,103,39
mvaaz 100,60,184
cv 248,104,40
cv 250,105,41
mvaac 100,144,228
wl 0
cv 24,106,42
cv 26,107,43
v_smfmac_f32_16x16x64_bf16 v[240:243], v[132:135], v[140:147], v6
cv 28,108,44
mvaac 100,156,232
cv 30,109,45
cv 32,110,46
mvaaz 104,64,184
cv 204,111,47
v_add_u32 v2, 0, v1
mvaac 104,148,228
ad 12,12,232
v_fma_f32 v15, v232, v232, v15
mvaac 104,160,232
ad 12,12,233
v_fma_f32 v15, v233, v233, v15
mvaaz 108,68,184
aw 30,214
aw 42,215
mvaac 108,152,228
ra 228,4,18432
ad 12,12,234
mvaac 108,164,232
ra 232,4,19456
v_fma_f32 v15, v234, v234, v15
mvaac 100,168,236
ad 12,12,235
v_fma_f32 v15, v235, v235, v15
mvaac 100,192,240
cv 214,232,233
cv 215,234,235
mvaac 104,172,236
ad 13,13,236
v_fma_f32 v16, v236, v236, v16
mvaac 104,196,240
ad 13,13,237
v_fma_f32 v16, v237, v237, v16
mvaac 108,176,236
ra 236,4,20480
aw 34,212
mvaac 108,200,240
ra 240,4,21504
aw 46,213
mvaac 100,204,244
ad 13,13,238
v_fma_f32 v16, v238, v238, v16
mvaac 100,216,248
ad 13,13,239
v_fma_f32 v16, v239, v239, v16
mvaac 104,208,244
cv 212,236,237
wv 4
s_barrier
mvaac 104,220,248
rv 136,5,2048
cv 213,238,239
mvaac 108,212,244
ra 244,4,22528
ad 14,14,240
mvaac 108,224,248
wl 5
ra 248,4,23552
v_fma_f32 v17, v240, v240, v17
mvvac 100,64,228
wl 5
rv 200,116,16384
ad 14,14,241
mvvac 100,76,232
rv 128,5,0
v_fma_f32 v17, v241, v241, v17
mvvac 104,68,228
rv 184,112,16384
s_lshl_b32 s44, s20, 10
mvvac 104,80,232
s_add_u32 s45, s44, 0x127800
s_add_u32 m0, s44, 0x13800
rv 188,113,16384
mvvac 108,72,228
ra 228,2,0
s_and_b32 s44, s20, 1
mvvac 108,84,232
wl 9
ra 232,2,1024
s_lshl_b32 s44, s44, 10
mvvac 100,88,236
wl 9
dm 1,12,45,0
mvvac 100,148,240
s_add_u32 s45, s44, 0x128800
s_add_u32 m0, s44, 0x14800
s_add_u32 s22, s23, 0x6000
mvvac 104,92,236
rv 132,5,1024
s_add_u32 s25, s24, 0x1000
mvvac 104,156,240
dm 1,12,45,0
mvvac 108,96,236
ra 236,2,2048
s_mov_b32 m0, s22
mvvac 108,164,240
wl 9
ra 240,2,3072
aw 27,214
mvvac 100,152,244
wl 9
dm 1,12,24,0
mvvac 100,180,248
s_mov_b32 m0, s22
rv 192,114,16384
aw 39,215
mvvac 104,160,244
dm 1,12,24,1024
mvvac 104,252,248
rv 196,115,16384
s_mov_b32 m0, s22
mvvac 108,168,244
ra 244,2,4096
cv 209,48,100
mvvac 108,172,248
ra 248,2,5120
cv 211,49,101
mvaaz 36,72,180
wl 8
rv 176,121,16384
ad 14,14,242
mvaac 36,144,228
wl 8
dm 1,12,24,2048
mvaac 36,156,232
rv 140,117,16384
s_mov_b32 m0, s22
mvaaz 40,76,180
rv 144,118,16384
v_fma_f32 v17, v242, v242, v17
mvaac 40,148,228
ad 14,14,243
v_fma_f32 v17, v243, v243, v17
mvaac 40,160,232
buffer_store_dwordx2 v[208:209], v224, s[16:19], 0 offen offset:256
mvaaz 44,80,180
cv 214,240,241
cv 215,242,243
mvaac 44,152,228
ra 228,2,6144
cv 245,50,102
mvaac 44,164,232
ra 232,2,7168
aw 31,212
mvvvz 232,136,200
dm 1,12,24,3072
v_smfmac_f32_16x16x64_bf16 v[232:235], v[128:131], v[184:191], v6
wl 7
rv 184,119,16384
s_add_u32 m0, s22, 0x1000
v_smfmac_f32_16x16x64_bf16 v[232:235], v[132:135], v[192:199], v6
rv 188,120,16384
aw 43,213
mvaac 36,168,236
rv 200,126,16384
cv 247,51,103
mvaac 36,192,240
dm 1,12,25,0
mvaac 40,172,236
buffer_store_dwordx2 v[210:211], v225, s[16:19], 0 offen offset:256
mvaac 40,196,240
rv 192,122,16384
s_add_u32 m0, s22, 0x1000
mvaac 44,176,236
ra 236,2,8192
s_add_u32 s24, s24, 0x6000
mvaac 44,200,240
wl 9
ra 240,2,9216
ad 12,12,232
mvvvz 236,136,176
wl 8
rv 196,123,16384
v_fma_f32 v15, v232, v232, v15
v_smfmac_f32_16x16x64_bf16 v[236:239], v[128:131], v[140:147], v6
wl 5
rv 140,124,16384
ad 12,12,233
v_smfmac_f32_16x16x64_bf16 v[236:239], v[132:135], v[184:191], v6
rv 144,125,16384
v_fma_f32 v15, v233, v233, v15
mvaac 36,204,244
dm 1,12,25,1024
mvaac 36,216,248
buffer_store_dwordx2 v[244:245], v226, s[16:19], 0 offen offset:256
mvaac 40,208,244
rv 176,116,16896
ad 12,12,234
mvaac 40,220,248
rv 184,112,16896
v_fma_f32 v15, v234, v234, v15
mvaac 44,212,244
ra 244,2,10240
ad 12,12,235
mvaac 44,224,248
wl 9
ra 248,2,11264
v_fma_f32 v15, v235, v235, v15
mvvvz 240,136,200
wl 6
rv 136,5,5120
cv 212,232,233
v_smfmac_f32_16x16x64_bf16 v[240:243], v[128:131], v[192:199], v6
wl 5
rv 128,5,3072
cv 213,234,235
v_smfmac_f32_16x16x64_bf16 v[240:243], v[132:135], v[140:147], v6
rv 188,113,16896
s_add_u32 m0, s80, 0x15000
mvvac 36,64,228
rv 132,5,4096
s_add_u32 s81, s42, 0x180
mvvac 36,76,232
rv 192,114,16896
rv 196,115,16896
mvvac 40,68,228
dm 8,8,81,0
mvvac 40,80,232
buffer_store_dwordx2 v[246:247], v227, s[16:19], 0 offen offset:256
mvvac 44,72,228
ra 228,2,12288
cv 249,52,104
mvvac 44,84,232
wl 6
ra 232,2,13312
s_add_u32 m0, s80, 0x15400
mvvvz 232,136,176
wl 5
rv 200,121,16896
s_add_u32 s81, s43, 0x180
v_smfmac_f32_16x16x64_bf16 v[232:235], v[128:131], v[184:191], v6
rv 140,117,16896
ad 13,13,236
mvvac 36,88,236
wl 4
rv 144,118,16896
v_fma_f32 v16, v236, v236, v16
v_smfmac_f32_16x16x64_bf16 v[232:235], v[132:135], v[192:199], v6
rv 184,119,16896
ad 13,13,237
mvvac 36,148,240
rv 188,120,16896
v_fma_f32 v16, v237, v237, v16
mvvac 40,92,236
dm 9,8,81,0
mvvac 40,156,240
buffer_store_dwordx2 v[248:249], v228, s[16:19], 0 offen offset:256
mvvac 44,96,236
ra 236,2,14336
aw 35,214
mvvac 44,164,240
ra 240,2,15360
aw 47,215
mvvac 36,152,244
rv 176,126,16896
ad 13,13,238
mvvac 36,180,248
v_fma_f32 v16, v238, v238, v16
ad 13,13,239
mvvac 40,160,244
v_fma_f32 v16, v239, v239, v16
cv 214,236,237
mvvac 40,252,248
wl 7
cv 215,238,239
s_add_u32 m0, s80, 0x15800
mvvvz 236,136,200
wl 5
rv 192,122,16896
s_add_u32 s81, s46, 0x180
v_smfmac_f32_16x16x64_bf16 v[236:239], v[128:131], v[140:147], v6
wl 4
rv 196,123,16896
cv 251,53,105
v_smfmac_f32_16x16x64_bf16 v[236:239], v[132:135], v[184:191], v6
dm 10,8,81,0
mvvac 44,168,244
ra 244,2,16384
s_add_u32 m0, s80, 0x15c00
mvvac 44,172,248
ra 248,2,17408
s_add_u32 s81, s47, 0x180
mvaaz 48,72,184
rv 140,124,16896
ad 14,14,240
mvaac 48,144,228
rv 144,125,16896
v_fma_f32 v17, v240, v240, v17
mvaac 48,156,232
wl 8
buffer_store_dwordx2 v[250:251], v229, s[16:19], 0 offen offset:256
mvaac 48,168,236
wl 7
dm 11,8,81,0
mvaac 48,192,240
wl 3
ad 14,14,241
v_fma_f32 v17, v241, v241, v17
mvaac 48,204,244
wl 2
aw 48,212
aw 60,213
mvaac 48,216,248
ad 14,14,242
v_fma_f32 v17, v242, v242, v17
mvaaz 100,84,180
ad 14,14,243
v_fma_f32 v17, v243, v243, v17
cv 212,240,241
cv 213,242,243
mvvvz 240,136,176
cv 25,54,106
cv 27,55,107
v_smfmac_f32_16x16x64_bf16 v[240:243], v[128:131], v[192:199], v6
wl 0
buffer_store_dwordx2 v[24:25], v230, s[16:19], 0 offen offset:256
v_smfmac_f32_16x16x64_bf16 v[240:243], v[132:135], v[140:147], v6
buffer_store_dwordx2 v[26:27], v231, s[16:19], 0 offen offset:256
mvaaz 52,76,184
cv 29,56,108
cv 31,57,109
mvaac 52,148,228
cv 33,58,110
cv 205,59,111
mvaac 52,160,232
buffer_store_dwordx2 v[28:29], v60, s[16:19], 0 offen offset:256
mvaaz 56,80,184
wv 11
s_barrier
v_add_u32 v3, 0x6000, v1
ad 12,12,232
mvaac 56,152,228
ra 228,2,18432
v_fma_f32 v15, v232, v232, v15
mvaac 56,164,232
ra 232,2,19456
ad 12,12,233
mvaac 52,172,236
rv 136,5,8192
v_fma_f32 v15, v233, v233, v15
mvaac 52,196,240
rv 200,116,32768
aw 52,214
mvaac 56,176,236
ra 236,2,20480
aw 64,215
mvaac 56,200,240
ra 240,2,21504
ad 12,12,234
mvaac 52,208,244
rv 128,5,6144
v_fma_f32 v15, v234, v234, v15
mvaac 52,220,248
rv 184,112,32768
ad 12,12,235
mvaac 56,212,244
ra 244,2,22528
v_fma_f32 v15, v235, v235, v15
mvaac 56,224,248
wl 8
ra 248,2,23552
cv 214,232,233
mvvac 48,64,228
wl 8
buffer_store_dwordx2 v[30:31], v61, s[16:19], 0 offen offset:256
mvvac 48,76,232
rv 188,113,32768
cv 215,234,235
mvvac 52,68,228
s_lshl_b32 s44, s20, 10
s_add_u32 s45, s44, 0x129000
s_add_u32 m0, s44, 0x12000
mvvac 52,80,232
rv 132,5,7168
ad 13,13,236
mvvac 56,72,228
ra 228,3,0
s_and_b32 s44, s20, 1
mvvac 56,84,232
wl 8
ra 232,3,1024
s_lshl_b32 s44, s44, 10
mvvac 48,88,236
wl 8
dm 1,12,45,0
mvvac 48,148,240
s_add_u32 s45, s44, 0x12a000
s_add_u32 m0, s44, 0x13000
s_add_u32 s22, s23, 0xc000
mvvac 52,92,236
rv 192,114,32768
v_fma_f32 v16, v236, v236, v16
mvvac 52,156,240
dm 1,12,45,0
mvvac 56,96,236
ra 236,3,2048
s_mov_b32 m0, s22
mvvac 56,164,240
wl 7
ra 240,3,3072
ad 13,13,237
mvvac 48,152,244
wl 7
buffer_store_dwordx2 v[32:33], v62, s[16:19], 0 offen offset:256
mvvac 48,180,248
dm 1,12,24,0
mvvac 52,160,244
s_mov_b32 m0, s22
rv 196,115,32768
v_fma_f32 v16, v237, v237, v16
mvvac 52,252,248
dm 1,12,24,1024
mvvac 56,168,244
ra 244,3,4096
s_mov_b32 m0, s22
mvvac 56,172,248
wl 6
ra 248,3,5120
aw 56,212
mvaac 100,144,228
wl 6
buffer_store_dwordx2 v[204:205], v63, s[16:19], 0 offen offset:256
mvaac 100,156,232
dm 1,12,24,2048
mvaaz 104,88,180
rv 176,121,32768
s_mov_b32 m0, s22
mvaac 104,148,228
rv 140,117,32768
aw 68,213
mvaac 104,160,232
rv 144,118,32768
ad 13,13,238
mvaaz 108,92,180
v_fma_f32 v16, v238, v238, v16
ad 13,13,239
mvaac 108,152,228
ra 228,3,6144
v_fma_f32 v16, v239, v239, v16
mvaac 108,164,232
ra 232,3,7168
cv 212,236,237
mvvvz 232,136,200
dm 1,12,24,3072
v_smfmac_f32_16x16x64_bf16 v[232:235], v[128:131], v[184:191], v6
wl 7
rv 184,119,32768
cv 213,238,239
v_smfmac_f32_16x16x64_bf16 v[232:235], v[132:135], v[192:199], v6
rv 188,120,32768
s_add_u32 s25, s24, 0x1000
mvaac 100,168,236
rv 200,126,32768
s_add_u32 m0, s22, 0x1000
mvaac 100,192,240
rv 192,122,32768
ad 14,14,240
mvaac 104,172,236
dm 1,12,25,0
mvaac 104,196,240
rv 196,123,32768
s_add_u32 m0, s22, 0x1000
mvaac 108,176,236
ra 236,3,8192
s_add_u32 s24, s24, 0x6000
mvaac 108,200,240
wl 10
ra 240,3,9216
v_fma_f32 v17, v240, v240, v17
mvvvz 236,136,176
wl 9
rv 176,116,33280
ad 14,14,241
v_smfmac_f32_16x16x64_bf16 v[236:239], v[128:131], v[140:147], v6
wl 6
rv 140,124,32768
v_fma_f32 v17, v241, v241, v17
v_smfmac_f32_16x16x64_bf16 v[236:239], v[132:135], v[184:191], v6
rv 144,125,32768
aw 49,214
mvaac 100,204,244
dm 1,12,25,1024
mvaac 100,216,248
aw 61,215
ad 14,14,242
mvaac 104,208,244
v_fma_f32 v17, v242, v242, v17
ad 14,14,243
mvaac 104,220,248
v_fma_f32 v17, v243, v243, v17
cv 214,240,241
mvaac 108,212,244
ra 244,3,10240
cv 215,242,243
mvaac 108,224,248
wl 8
ra 248,3,11264
ad 12,12,232
mvvvz 240,136,200
wl 7
rv 136,5,11264
v_fma_f32 v15, v232, v232, v15
v_smfmac_f32_16x16x64_bf16 v[240:243], v[128:131], v[192:199], v6
wl 3
rv 128,5,9216
ad 12,12,233
v_smfmac_f32_16x16x64_bf16 v[240:243], v[132:135], v[140:147], v6
rv 184,112,33280
s_add_u32 m0, s80, 0x19000
mvvac 100,64,228
rv 188,113,33280
s_add_u32 s81, s42, 0x1c0
mvvac 100,76,232
rv 132,5,10240
rv 192,114,33280
mvvac 104,68,228
rv 196,115,33280
v_fma_f32 v15, v233, v233, v15
mvvac 104,80,232
dm 8,8,81,0
mvvac 108,72,228
ra 228,3,12288
aw 53,212
mvvac 108,84,232
ra 232,3,13312
aw 65,213
mvvac 100,88,236
rv 200,121,33280
ad 12,12,234
mvvac 100,148,240
v_fma_f32 v15, v234, v234, v15
ad 12,12,235
mvvac 104,92,236
v_fma_f32 v15, v235, v235, v15
cv 212,232,233
mvvac 104,156,240
wl 9
cv 213,234,235
s_add_u32 m0, s80, 0x19400
mvvvz 232,136,176
wl 6
rv 140,117,33280
s_add_u32 s81, s43, 0x1c0
v_smfmac_f32_16x16x64_bf16 v[232:235], v[128:131], v[184:191], v6
wl 4
rv 144,118,33280
ad 13,13,236
v_smfmac_f32_16x16x64_bf16 v[232:235], v[132:135], v[192:199], v6
rv 184,119,33280
v_fma_f32 v16, v236, v236, v16
mvvac 108,96,236
ra 236,3,14336
rv 188,120,33280
mvvac 108,164,240
ra 240,3,15360
ad 13,13,237
mvvac 100,152,244
dm 9,8,81,0
mvvac 100,180,248
rv 176,126,33280
v_fma_f32 v16, v237, v237, v16
mvvac 104,160,244
aw 57,214
aw 69,215
mvvac 104,252,248
ad 13,13,238
v_fma_f32 v16, v238, v238, v16
mvvac 108,168,244
ra 244,3,16384
ad 13,13,239
mvvac 108,172,248
s_add_u32 m0, s80, 0x19800
rv 192,122,33280
rv 196,123,33280
v_fma_f32 v16, v239, v239, v16
ra 248,3,17408
cv 214,236,237
cv 215,238,239
wl 11
mvvvz 236,136,200
wl 9
s_add_u32 s81, s46, 0x1c0
ad 14,14,240
v_fma_f32 v17, v240, v240, v17
v_smfmac_f32_16x16x64_bf16 v[236:239], v[128:131], v[140:147], v6
wl 6
dm 10,8,81,0
v_smfmac_f32_16x16x64_bf16 v[236:239], v[132:135], v[184:191], v6
rv 140,124,33280
rv 144,125,33280
s_add_u32 m0, s80, 0x19c00
s_add_u32 s81, s47, 0x1c0
ad 14,14,241
v_fma_f32 v17, v241, v241, v17
aw 50,212
aw 62,213
ad 14,14,242
v_fma_f32 v17, v242, v242, v17
ad 14,14,243
v_fma_f32 v17, v243, v243, v17
cv 212,240,241
cv 213,242,243
wl 6
mvvvz 240,136,176
wl 3
dm 11,8,81,0
v_smfmac_f32_16x16x64_bf16 v[240:243], v[128:131], v[192:199], v6
cv 208,36,48
cv 210,37,49
cv 244,38,50
cv 246,39,51
mvaaz 36,84,184
cv 248,40,52
cv 250,41,53
mvaac 36,144,228
wl 0
cv 24,42,54
cv 26,43,55
v_smfmac_f32_16x16x64_bf16 v[240:243], v[132:135], v[140:147], v6
cv 28,44,56
mvaac 36,156,232
cv 30,45,57
cv 32,46,58
mvaaz 40,88,184
cv 204,47,59
v_add_u32 v4, 0xc000, v1
mvaac 40,148,228
ad 12,12,232
v_fma_f32 v15, v232, v232, v15
mvaac 40,160,232
ad 12,12,233
v_fma_f32 v15, v233, v233, v15
mvaaz 44,92,184
aw 54,214
aw 66,215
mvaac 44,152,228
ra 228,3,18432
ad 12,12,234
mvaac 44,164,232
ra 232,3,19456
v_fma_f32 v15, v234, v234, v15
mvaac 36,168,236
ad 12,12,235
v_fma_f32 v15, v235, v235, v15
mvaac 36,192,240
cv 214,232,233
cv 215,234,235
mvaac 40,172,236
ad 13,13,236
v_fma_f32 v16, v236, v236, v16
mvaac 40,196,240
ad 13,13,237
v_fma_f32 v16, v237, v237, v16
mvaac 44,176,236
ra 236,3,20480
aw 58,212
mvaac 44,200,240
ra 240,3,21504
aw 70,213
mvaac 36,204,244
ad 13,13,238
v_fma_f32 v16, v238, v238, v16
mvaac 36,216,248
ad 13,13,239
v_fma_f32 v16, v239, v239, v16
mvaac 40,208,244
cv 212,236,237
wv 4
s_barrier
mvaac 40,220,248
rv 136,5,2048
cv 213,238,239
mvaac 44,212,244
ra 244,3,22528
ad 14,14,240
mvaac 44,224,248
wl 5
ra 248,3,23552
v_fma_f32 v17, v240, v240, v17
mvvac 36,64,228
wl 5
rv 200,116,0
ad 14,14,241
mvvac 36,76,232
rv 128,5,0
v_fma_f32 v17, v241, v241, v17
mvvac 40,68,228
rv 184,112,0
s_lshl_b32 s44, s20, 10
mvvac 40,80,232
s_add_u32 s45, s44, 0x12a800
s_add_u32 m0, s44, 0x13800
rv 188,113,0
mvvac 44,72,228
ra 228,4,0
s_and_b32 s44, s20, 1
mvvac 44,84,232
wl 9
ra 232,4,1024
s_lshl_b32 s44, s44, 10
mvvac 36,88,236
wl 9
dm 1,12,45,0
mvvac 36,148,240
s_add_u32 s45, s44, 0x12b800
s_add_u32 m0, s44, 0x14800
s_add_u32 s22, s23, 0
mvvac 40,92,236
rv 132,5,1024
s_add_u32 s25, s24, 0x1000
mvvac 40,156,240
dm 1,12,45,0
mvvac 44,96,236
ra 236,4,2048
s_mov_b32 m0, s22
mvvac 44,164,240
wl 9
ra 240,4,3072
aw 51,214
mvvac 36,152,244
wl 9
dm 1,12,24,0
mvvac 36,180,248
s_mov_b32 m0, s22
rv 192,114,0
aw 63,215
mvvac 40,160,244
dm 1,12,24,1024
mvvac 40,252,248
rv 196,115,0
s_mov_b32 m0, s22
mvvac 44,168,244
ra 244,4,4096
cv 209,100,36
mvvac 44,172,248
ra 248,4,5120
cv 211,101,37
mvaaz 48,96,180
wl 8
rv 176,121,0
ad 14,14,242
mvaac 48,144,228
wl 8
dm 1,12,24,2048
mvaac 48,156,232
rv 140,117,0
s_mov_b32 m0, s22
mvaaz 52,100,180
rv 144,118,0
v_fma_f32 v17, v242, v242, v17
mvaac 52,148,228
ad 14,14,243
v_fma_f32 v17, v243, v243, v17
mvaac 52,160,232
buffer_store_dwordx2 v[208:209], v224, s[16:19], 0 offen offset:384
mvaaz 56,104,180
cv 214,240,241
cv 215,242,243
mvaac 56,152,228
ra 228,4,6144
cv 245,102,38
mvaac 56,164,232
ra 232,4,7168
aw 55,212
mvvvz 232,136,200
dm 1,12,24,3072
v_smfmac_f32_16x16x64_bf16 v[232:235], v[128:131], v[184:191], v6
wl 7
rv 184,119,0
s_add_u32 m0, s22, 0x1000
v_smfmac_f32_16x16x64_bf16 v[232:235], v[132:135], v[192:199], v6
rv 188,120,0
aw 67,213
mvaac 48,168,236
rv 200,126,0
cv 247,103,39
mvaac 48,192,240
dm 1,12,25,0
mvaac 52,172,236
buffer_store_dwordx2 v[210:211], v225, s[16:19], 0 offen offset:384
mvaac 52,196,240
rv 192,122,0
s_add_u32 m0, s22, 0x1000
mvaac 56,176,236
ra 236,4,8192
s_add_u32 s24, s24, 0x6000
mvaac 56,200,240
wl 9
ra 240,4,9216
ad 12,12,232
mvvvz 236,136,176
wl 8
rv 196,123,0
v_fma_f32 v15, v232, v232, v15
v_smfmac_f32_16x16x64_bf16 v[236:239], v[128:131], v[140:147], v6
wl 5
rv 140,124,0
ad 12,12,233
v_smfmac_f32_16x16x64_bf16 v[236:239], v[132:135], v[184:191], v6
rv 144,125,0
v_fma_f32 v15, v233, v233, v15
mvaac 48,204,244
dm 1,12,25,1024
mvaac 48,216,248
buffer_store_dwordx2 v[244:245], v226, s[16:19], 0 offen offset:384
mvaac 52,208,244
rv 176,116,512
ad 12,12,234
mvaac 52,220,248
rv 184,112,512
v_fma_f32 v15, v234, v234, v15
mvaac 56,212,244
ra 244,4,10240
ad 12,12,235
mvaac 56,224,248
wl 9
ra 248,4,11264
v_fma_f32 v15, v235, v235, v15
mvvvz 240,136,200
wl 6
rv 136,5,5120
cv 212,232,233
v_smfmac_f32_16x16x64_bf16 v[240:243], v[128:131], v[192:199], v6
wl 5
rv 128,5,3072
cv 213,234,235
v_smfmac_f32_16x16x64_bf16 v[240:243], v[132:135], v[140:147], v6
rv 188,113,512
s_add_u32 m0, s80, 0x1d000
mvvac 48,64,228
rv 132,5,4096
s_add_u32 s81, s42, 0x200
mvvac 48,76,232
rv 192,114,512
rv 196,115,512
mvvac 52,68,228
dm 8,8,81,0
mvvac 52,80,232
buffer_store_dwordx2 v[246:247], v227, s[16:19], 0 offen offset:384
mvvac 56,72,228
ra 228,4,12288
cv 249,104,40
mvvac 56,84,232
wl 6
ra 232,4,13312
s_add_u32 m0, s80, 0x1d400
mvvvz 232,136,176
wl 5
rv 200,121,512
s_add_u32 s81, s43, 0x200
v_smfmac_f32_16x16x64_bf16 v[232:235], v[128:131], v[184:191], v6
rv 140,117,512
ad 13,13,236
mvvac 48,88,236
wl 4
rv 144,118,512
v_fma_f32 v16, v236, v236, v16
v_smfmac_f32_16x16x64_bf16 v[232:235], v[132:135], v[192:199], v6
rv 184,119,512
ad 13,13,237
mvvac 48,148,240
rv 188,120,512
v_fma_f32 v16, v237, v237, v16
mvvac 52,92,236
dm 9,8,81,0
mvvac 52,156,240
buffer_store_dwordx2 v[248:249], v228, s[16:19], 0 offen offset:384
mvvac 56,96,236
ra 236,4,14336
aw 59,214
mvvac 56,164,240
ra 240,4,15360
aw 71,215
mvvac 48,152,244
rv 176,126,512
ad 13,13,238
mvvac 48,180,248
v_fma_f32 v16, v238, v238, v16
ad 13,13,239
mvvac 52,160,244
v_fma_f32 v16, v239, v239, v16
cv 214,236,237
mvvac 52,252,248
wl 7
cv 215,238,239
s_add_u32 m0, s80, 0x1d800
mvvvz 236,136,200
wl 5
rv 192,122,512
s_add_u32 s81, s46, 0x200
v_smfmac_f32_16x16x64_bf16 v[236:239], v[128:131], v[140:147], v6
wl 4
rv 196,123,512
cv 251,105,41
v_smfmac_f32_16x16x64_bf16 v[236:239], v[132:135], v[184:191], v6
dm 10,8,81,0
mvvac 56,168,244
ra 244,4,16384
s_add_u32 m0, s80, 0x1dc00
mvvac 56,172,248
ra 248,4,17408
s_add_u32 s81, s47, 0x200
mvaaz 100,96,184
rv 140,124,512
ad 14,14,240
mvaac 100,144,228
rv 144,125,512
v_fma_f32 v17, v240, v240, v17
mvaac 100,156,232
wl 8
buffer_store_dwordx2 v[250:251], v229, s[16:19], 0 offen offset:384
mvaac 100,168,236
wl 7
dm 11,8,81,0
mvaac 100,192,240
wl 3
ad 14,14,241
v_fma_f32 v17, v241, v241, v17
mvaac 100,204,244
wl 2
aw 72,212
aw 84,213
mvaac 100,216,248
ad 14,14,242
v_fma_f32 v17, v242, v242, v17
mvaaz 36,108,180
s_ashr_i32 s100, s98, 31
ad 14,14,243
v_fma_f32 v17, v243, v243, v17
cv 212,240,241
cv 213,242,243
mvvvz 240,136,176
cv 25,106,42
cv 27,107,43
v_smfmac_f32_16x16x64_bf16 v[240:243], v[128:131], v[192:199], v6
wl 0
buffer_store_dwordx2 v[24:25], v230, s[16:19], 0 offen offset:384
v_smfmac_f32_16x16x64_bf16 v[240:243], v[132:135], v[140:147], v6
buffer_store_dwordx2 v[26:27], v231, s[16:19], 0 offen offset:384
mvaaz 104,100,184
cv 29,108,44
cv 31,109,45
mvaac 104,148,228
cv 33,110,46
cv 205,111,47
mvaac 104,160,232
buffer_store_dwordx2 v[28:29], v60, s[16:19], 0 offen offset:384
mvaaz 108,104,184
s_add_u32 s96, s96, s98
s_addc_u32 s97, s97, s100
s_lshr_b32 s100, s2, 3
mvaac 108,152,228
ra 228,4,18432
s_and_b32 s100, s100, 31
mvaac 108,164,232
ra 232,4,19456
s_lshl_b32 s100, s100, 13
mvaac 104,172,236
s_add_u32 s101, s99, 0x1fff
s_and_b32 s101, s101, 0xffffe000
s_lshl_b32 s98, s101, 3
mvaac 104,196,240
s_cmp_ge_u32 s100, s98
s_cselect_b32 s98, s98, 0
s_sub_u32 s100, s100, s98
mvaac 108,176,236
ra 236,4,20480
s_lshl_b32 s98, s101, 2
mvaac 108,200,240
ra 240,4,21504
s_cmp_ge_u32 s100, s98
mvaac 104,208,244
s_cselect_b32 s98, s98, 0
s_sub_u32 s100, s100, s98
s_lshl_b32 s98, s101, 1
mvaac 104,220,248
s_cmp_ge_u32 s100, s98
s_cselect_b32 s98, s98, 0
aw 76,214
mvaac 108,212,244
ra 244,4,22528
s_sub_u32 s100, s100, s98
mvaac 108,224,248
wl 4
ra 248,4,23552
cv 214,232,233
mvvac 100,64,228
wl 4
buffer_store_dwordx2 v[30:31], v61, s[16:19], 0 offen offset:384
mvvac 100,76,232
s_lshl_b32 s98, s101, 0
aw 73,214
s_cmp_ge_u32 s100, s98
mvvac 104,68,228
cv 214,240,241
s_cselect_b32 s98, s98, 0
mvvac 104,80,232
aw 81,214
s_sub_u32 s100, s100, s98
mvvac 108,72,228
aw 80,212
s_sub_u32 s99, s99, 4
mvvac 108,84,232
wl 3
v_lshlrev_b32 v214, 7, v0
cv 212,236,237
mvvac 100,88,236
wl 2
v_add_u32 v214, s100, v214
s_lshl_b32 s44, s20, 10
mvvac 100,148,240
aw 92,213
aw 77,212
mvvac 104,92,236
v_min_u32 v214, s99, v214
s_add_u32 s45, s44, 0x12c000
mvvac 104,156,240
cv 213,238,239
v_add_co_u32 v212, vcc, s96, v214
mvvac 108,96,236
s_add_u32 m0, s44, 0x12000
aw 89,213
v_mov_b32 v213, s97
mvvac 108,164,240
v_addc_co_u32 v213, vcc, 0, v213, vcc
wv 12
s_barrier
wl 1
mvvac 100,152,244
wl 0
global_load_dword a254, v[212:213], off
mvvac 100,180,248
dm 1,12,45,0
mvvac 104,160,244
s_and_b32 s44, s20, 1
s_lshl_b32 s44, s44, 10
s_add_u32 s45, s44, 0x12d000
mvvac 104,252,248
s_add_u32 m0, s44, 0x13000
v_add_u32 v2, 0, v1
s_add_u32 s22, s23, 0x6000
mvvac 108,168,244
ra 228,2,0
dm 1,12,45,0
mvvac 108,172,248
ra 232,2,1024
s_mov_b32 m0, s22
mvaaz 40,112,180
ra 236,2,2048
buffer_store_dwordx2 v[32:33], v62, s[16:19], 0 offen offset:384
mvaaz 44,116,180
ra 240,2,3072
dm 1,12,24,0
s_mov_b32 m0, s22
ra 244,2,4096
rv 136,5,8192
rv 200,116,16384
wl 6
mvaac 36,144,228
wl 5
ra 248,2,5120
dm 1,12,24,1024
mvaac 36,156,232
rv 128,5,6144
s_mov_b32 m0, s22
mvaac 40,148,228
rv 184,112,16384
rv 188,113,16384
mvaac 40,160,232
buffer_store_dwordx2 v[204:205], v63, s[16:19], 0 offen offset:384
mvaac 44,152,228
ra 228,2,6144
ad 12,12,232
mvaac 44,164,232
wl 9
ra 232,2,7168
v_fma_f32 v15, v232, v232, v15
mvaac 36,168,236
wl 9
rv 132,5,7168
rv 192,114,16384
mvaac 36,192,240
rv 196,115,16384
ad 12,12,233
mvaac 40,172,236
dm 1,12,24,2048
mvaac 40,196,240
rv 176,121,16384
v_fma_f32 v15, v233, v233, v15
mvaac 44,176,236
ra 236,2,8192
aw 88,215
mvaac 44,200,240
wl 13
ra 240,2,9216
ad 12,12,234
mvaac 36,204,244
wl 11
v_fma_f32 v15, v234, v234, v15
ad 12,12,235
mvaac 36,216,248
v_fma_f32 v15, v235, v235, v15
cv 215,234,235
mvvvz 232,136,200
wl 8
rv 140,117,16384
s_mov_b32 m0, s22
v_smfmac_f32_16x16x64_bf16 v[232:235], v[128:131], v[184:191], v6
wl 4
rv 144,118,16384
ad 13,13,236
v_smfmac_f32_16x16x64_bf16 v[232:235], v[132:135], v[192:199], v6
rv 184,119,16384
v_fma_f32 v16, v236, v236, v16
mvaac 40,208,244
rv 188,120,16384
ad 13,13,237
mvaac 40,220,248
dm 1,12,24,3072
mvaac 44,212,244
ra 244,2,10240
v_fma_f32 v16, v237, v237, v16
mvaac 44,224,248
ra 248,2,11264
ad 13,13,238
mvvac 36,64,228
rv 200,126,16384
v_fma_f32 v16, v238, v238, v16
mvvac 36,76,232
wl 9
ad 13,13,239
v_fma_f32 v16, v239, v239, v16
mvvvz 236,136,176
wl 5
rv 192,122,16384
s_add_u32 s25, s24, 0x1000
v_smfmac_f32_16x16x64_bf16 v[236:239], v[128:131], v[140:147], v6
wl 4
rv 196,123,16384
s_add_u32 m0, s22, 0x1000
v_smfmac_f32_16x16x64_bf16 v[236:239], v[132:135], v[184:191], v6
rv 140,124,16384
ad 14,14,240
mvvac 40,68,228
dm 1,12,25,0
mvvac 40,80,232
rv 144,125,16384
s_add_u32 m0, s22, 0x1000
mvvac 44,72,228
ra 228,2,12288
s_add_u32 s24, s24, 0x6000
mvvac 44,84,232
ra 232,2,13312
v_fma_f32 v17, v240, v240, v17
mvvac 36,88,236
dm 1,12,25,1024
mvvac 36,148,240
rv 176,116,16896
ad 14,14,241
mvvac 40,92,236
v_fma_f32 v17, v241, v241, v17
aw 85,215
mvvac 40,156,240
ad 14,14,242
v_fma_f32 v17, v242, v242, v17
mvvac 44,96,236
ra 236,2,14336
ad 14,14,243
mvvac 44,164,240
wl 10
ra 240,2,15360
v_fma_f32 v17, v243, v243, v17
mvvac 36,152,244
wl 9
cv 215,242,243
ad 12,12,232
mvvvz 240,136,200
wl 7
rv 136,5,11264
v_fma_f32 v15, v232, v232, v15
v_smfmac_f32_16x16x64_bf16 v[240:243], v[128:131], v[192:199], v6
wl 6
rv 128,5,9216
ad 12,12,233
v_smfmac_f32_16x16x64_bf16 v[240:243], v[132:135], v[140:147], v6
rv 184,112,16896
rv 188,113,16896
mvvac 36,180,248
rv 132,5,10240
s_add_u32 m0, s80, 0x15000
mvvac 40,160,244
rv 192,114,16896
s_add_u32 s81, s42, 0x240
mvvac 40,252,248
rv 196,115,16896
v_fma_f32 v15, v233, v233, v15
mvvac 44,168,244
ra 244,2,16384
ad 12,12,234
mvvac 44,172,248
rv 200,121,16896
v_fma_f32 v15, v234, v234, v15
ad 12,12,235
rv 140,117,16896
v_fma_f32 v15, v235, v235, v15
rv 144,118,16896
cv 212,232,233
ra 248,2,17408
cv 213,234,235
wl 11
mvvvz 232,136,176
wl 8
dm 8,8,81,0
v_smfmac_f32_16x16x64_bf16 v[232:235], v[128:131], v[184:191], v6
wl 5
rv 184,119,16896
s_add_u32 m0, s80, 0x15400
v_smfmac_f32_16x16x64_bf16 v[232:235], v[132:135], v[192:199], v6
s_add_u32 s81, s43, 0x240
rv 188,120,16896
rv 176,126,16896
ad 13,13,236
rv 192,122,16896
v_fma_f32 v16, v236, v236, v16
rv 196,123,16896
ad 13,13,237
v_fma_f32 v16, v237, v237, v16
aw 93,215
ad 13,13,238
v_fma_f32 v16, v238, v238, v16
ad 13,13,239
v_fma_f32 v16, v239, v239, v16
cv 214,236,237
cv 215,238,239
wl 8
mvvvz 236,136,200
wl 6
dm 9,8,81,0
v_smfmac_f32_16x16x64_bf16 v[236:239], v[128:131], v[140:147], v6
wl 3
rv 140,124,16896
s_add_u32 m0, s80, 0x15800
v_smfmac_f32_16x16x64_bf16 v[236:239], v[132:135], v[184:191], v6
s_add_u32 s81, s46, 0x240
rv 144,125,16896
ad 14,14,240
v_fma_f32 v17, v240, v240, v17
ad 14,14,241
dm 10,8,81,0
s_add_u32 m0, s80, 0x15c00
s_add_u32 s81, s47, 0x240
v_fma_f32 v17, v241, v241, v17
aw 74,212
aw 86,213
ad 14,14,242
v_fma_f32 v17, v242, v242, v17
ad 14,14,243
v_fma_f32 v17, v243, v243, v17
cv 212,240,241
cv 213,242,243
wl 4
mvvvz 240,136,176
wl 2
dm 11,8,81,0
v_smfmac_f32_16x16x64_bf16 v[240:243], v[128:131], v[192:199], v6
wl 0
cv 208,48,100
v_smfmac_f32_16x16x64_bf16 v[240:243], v[132:135], v[140:147], v6
cv 210,49,101
cv 244,50,102
cv 246,51,103
mvaaz 48,108,184
cv 248,52,104
cv 250,53,105
mvaac 48,144,228
cv 24,54,106
cv 26,55,107
mvaac 48,156,232
cv 28,56,108
cv 30,57,109
mvaaz 52,112,184
cv 32,58,110
cv 204,59,111
mvaac 52,148,228
v_add_u32 v3, 0x6000, v1
ad 12,12,232
mvaac 52,160,232
v_fma_f32 v15, v232, v232, v15
ad 12,12,233
mvaaz 56,116,184
v_fma_f32 v15, v233, v233, v15
aw 78,214
mvaac 56,152,228
ra 228,2,18432
aw 90,215
mvaac 56,164,232
ra 232,2,19456
ad 12,12,234
mvaac 48,168,236
v_fma_f32 v15, v234, v234, v15
ad 12,12,235
mvaac 48,192,240
v_fma_f32 v15, v235, v235, v15
cv 214,232,233
mvaac 52,172,236
cv 215,234,235
ad 13,13,236
mvaac 52,196,240
v_fma_f32 v16, v236, v236, v16
ad 13,13,237
mvaac 56,176,236
ra 236,2,20480
v_fma_f32 v16, v237, v237, v16
mvaac 56,200,240
ra 240,2,21504
aw 82,212
mvaac 48,204,244
aw 94,213
ad 13,13,238
mvaac 48,216,248
v_fma_f32 v16, v238, v238, v16
ad 13,13,239
mvaac 52,208,244
v_fma_f32 v16, v239, v239, v16
wv 4
s_barrier
mvaac 52,220,248
rv 136,5,2048
cv 212,236,237
mvaac 56,212,244
ra 244,2,22528
cv 213,238,239
mvaac 56,224,248
wl 5
ra 248,2,23552
ad 14,14,240
mvvac 48,64,228
wl 5
rv 200,116,32768
v_fma_f32 v17, v240, v240, v17
mvvac 48,76,232
rv 128,5,0
ad 14,14,241
mvvac 52,68,228
rv 184,112,32768
s_lshl_b32 s44, s20, 10
mvvac 52,80,232
s_add_u32 s45, s44, 0x12d800
s_add_u32 m0, s44, 0x13800
rv 188,113,32768
mvvac 56,72,228
ra 228,3,0
s_and_b32 s44, s20, 1
mvvac 56,84,232
wl 9
ra 232,3,1024
s_lshl_b32 s44, s44, 10
mvvac 48,88,236
wl 9
dm 1,12,45,0
mvvac 48,148,240
s_add_u32 s45, s44, 0x12e800
s_add_u32 m0, s44, 0x14800
s_add_u32 s22, s23, 0xc000
mvvac 52,92,236
rv 132,5,1024
s_add_u32 s25, s24, 0x1000
mvvac 52,156,240
dm 1,12,45,0
mvvac 56,96,236
ra 236,3,2048
s_mov_b32 m0, s22
mvvac 56,164,240
wl 9
ra 240,3,3072
v_fma_f32 v17, v241, v241, v17
mvvac 48,152,244
wl 9
dm 1,12,24,0
mvvac 48,180,248
s_mov_b32 m0, s22
rv 192,114,32768
aw 75,214
mvvac 52,160,244
dm 1,12,24,1024
mvvac 52,252,248
rv 196,115,32768
s_mov_b32 m0, s22
mvvac 56,168,244
ra 244,3,4096
cv 209,36,48
mvvac 56,172,248
ra 248,3,5120
cv 211,37,49
mvaaz 100,120,180
wl 8
rv 176,121,32768
aw 87,215
mvaac 100,144,228
wl 8
dm 1,12,24,2048
mvaac 100,156,232
rv 140,117,32768
s_mov_b32 m0, s22
mvaaz 104,124,180
rv 144,118,32768
ad 14,14,242
mvaac 104,148,228
v_fma_f32 v17, v242, v242, v17
ad 14,14,243
mvaac 104,160,232
buffer_store_dwordx2 v[208:209], v224, s[16:19], 0 offen offset:512
mvaaz 108,128,180
v_fma_f32 v17, v243, v243, v17
cv 214,240,241
mvaac 108,152,228
ra 228,3,6144
cv 215,242,243
mvaac 108,164,232
ra 232,3,7168
cv 245,38,50
mvvvz 232,136,200
dm 1,12,24,3072
v_smfmac_f32_16x16x64_bf16 v[232:235], v[128:131], v[184:191], v6
wl 7
rv 184,119,32768
s_add_u32 m0, s22, 0x1000
v_smfmac_f32_16x16x64_bf16 v[232:235], v[132:135], v[192:199], v6
rv 188,120,32768
aw 79,212
mvaac 100,168,236
rv 200,126,32768
aw 91,213
mvaac 100,192,240
dm 1,12,25,0
mvaac 104,172,236
buffer_store_dwordx2 v[210:211], v225, s[16:19], 0 offen offset:512
mvaac 104,196,240
rv 192,122,32768
s_add_u32 m0, s22, 0x1000
mvaac 108,176,236
ra 236,3,8192
s_add_u32 s24, s24, 0x6000
mvaac 108,200,240
wl 9
ra 240,3,9216
ad 12,12,232
mvvvz 236,136,176
wl 8
rv 196,123,32768
v_fma_f32 v15, v232, v232, v15
v_smfmac_f32_16x16x64_bf16 v[236:239], v[128:131], v[140:147], v6
wl 5
rv 140,124,32768
ad 12,12,233
v_smfmac_f32_16x16x64_bf16 v[236:239], v[132:135], v[184:191], v6
rv 144,125,32768
v_fma_f32 v15, v233, v233, v15
mvaac 100,204,244
dm 1,12,25,1024
mvaac 100,216,248
buffer_store_dwordx2 v[244:245], v226, s[16:19], 0 offen offset:512
mvaac 104,208,244
rv 176,116,33280
cv 247,39,51
mvaac 104,220,248
rv 184,112,33280
ad 12,12,234
mvaac 108,212,244
ra 244,3,10240
v_fma_f32 v15, v234, v234, v15
mvaac 108,224,248
wl 9
ra 248,3,11264
ad 12,12,235
mvvvz 240,136,200
wl 6
rv 136,5,5120
v_fma_f32 v15, v235, v235, v15
v_smfmac_f32_16x16x64_bf16 v[240:243], v[128:131], v[192:199], v6
wl 5
rv 128,5,3072
cv 212,232,233
v_smfmac_f32_16x16x64_bf16 v[240:243], v[132:135], v[140:147], v6
rv 188,113,33280
s_add_u32 m0, s80, 0x19000
mvvac 100,64,228
rv 132,5,4096
s_add_u32 s81, s42, 0x280
mvvac 100,76,232
rv 192,114,33280
rv 196,115,33280
mvvac 104,68,228
dm 8,8,81,0
mvvac 104,80,232
buffer_store_dwordx2 v[246:247], v227, s[16:19], 0 offen offset:512
mvvac 108,72,228
ra 228,3,12288
cv 213,234,235
mvvac 108,84,232
wl 6
ra 232,3,13312
s_add_u32 m0, s80, 0x19400
mvvvz 232,136,176
wl 5
rv 200,121,33280
s_add_u32 s81, s43, 0x280
v_smfmac_f32_16x16x64_bf16 v[232:235], v[128:131], v[184:191], v6
rv 140,117,33280
cv 249,40,52
mvvac 100,88,236
wl 4
rv 144,118,33280
ad 13,13,236
v_smfmac_f32_16x16x64_bf16 v[232:235], v[132:135], v[192:199], v6
rv 184,119,33280
v_fma_f32 v16, v236, v236, v16
mvvac 100,148,240
rv 188,120,33280
ad 13,13,237
mvvac 104,92,236
dm 9,8,81,0
mvvac 104,156,240
buffer_store_dwordx2 v[248:249], v228, s[16:19], 0 offen offset:512
mvvac 108,96,236
ra 236,3,14336
v_fma_f32 v16, v237, v237, v16
mvvac 108,164,240
ra 240,3,15360
aw 83,214
mvvac 100,152,244
rv 176,126,33280
aw 95,215
mvvac 100,180,248
ad 13,13,238
v_fma_f32 v16, v238, v238, v16
mvvac 104,160,244
ad 13,13,239
v_fma_f32 v16, v239, v239, v16
mvvac 104,252,248
wl 7
cv 214,236,237
cv 215,238,239
mvvvz 236,136,200
wl 5
rv 192,122,33280
s_add_u32 m0, s80, 0x19800
v_smfmac_f32_16x16x64_bf16 v[236:239], v[128:131], v[140:147], v6
wl 4
rv 196,123,33280
s_add_u32 s81, s46, 0x280
v_smfmac_f32_16x16x64_bf16 v[236:239], v[132:135], v[184:191], v6
rv 140,124,33280
cv 251,41,53
mvvac 108,168,244
ra 244,3,16384
dm 10,8,81,0
mvvac 108,172,248
ra 248,3,17408
s_add_u32 m0, s80, 0x19c00
mvaaz 36,120,184
rv 144,125,33280
s_add_u32 s81, s47, 0x280
mvaac 36,144,228
buffer_store_dwordx2 v[250:251], v229, s[16:19], 0 offen offset:512
mvaac 36,156,232
wl 8
dm 11,8,81,0
mvaac 36,168,236
wl 7
ad 14,14,240
v_fma_f32 v17, v240, v240, v17
mvaac 36,192,240
wl 2
ad 14,14,241
v_fma_f32 v17, v241, v241, v17
mvaac 36,204,244
wl 1
aw 96,212
aw 108,213
mvaac 36,216,248
ad 14,14,242
v_fma_f32 v17, v242, v242, v17
mvaaz 48,132,180
s_mov_b32 s24, s23
ad 14,14,243
v_fma_f32 v17, v243, v243, v17
cv 212,240,241
cv 213,242,243
mvvvz 240,136,176
cv 25,42,54
cv 27,43,55
v_smfmac_f32_16x16x64_bf16 v[240:243], v[128:131], v[192:199], v6
wl 0
buffer_store_dwordx2 v[24:25], v230, s[16:19], 0 offen offset:512
v_smfmac_f32_16x16x64_bf16 v[240:243], v[132:135], v[140:147], v6
buffer_store_dwordx2 v[26:27], v231, s[16:19], 0 offen offset:512
mvaaz 40,124,184
cv 29,44,56
cv 31,45,57
mvaac 40,148,228
cv 33,46,58
cv 205,47,59
mvaac 40,160,232
buffer_store_dwordx2 v[28:29], v60, s[16:19], 0 offen offset:512
mvaaz 44,128,184
wv 11
s_barrier
v_add_u32 v4, 0xc000, v1
ad 12,12,232
mvaac 44,152,228
ra 228,3,18432
v_fma_f32 v15, v232, v232, v15
mvaac 44,164,232
ra 232,3,19456
ad 12,12,233
mvaac 40,172,236
rv 136,5,8192
v_fma_f32 v15, v233, v233, v15
mvaac 40,196,240
rv 200,116,0
aw 100,214
mvaac 44,176,236
ra 236,3,20480
aw 112,215
mvaac 44,200,240
ra 240,3,21504
ad 12,12,234
mvaac 40,208,244
rv 128,5,6144
v_fma_f32 v15, v234, v234, v15
mvaac 40,220,248
rv 184,112,0
ad 12,12,235
mvaac 44,212,244
ra 244,3,22528
v_fma_f32 v15, v235, v235, v15
mvaac 44,224,248
wl 8
ra 248,3,23552
cv 214,232,233
mvvac 36,64,228
wl 8
buffer_store_dwordx2 v[30:31], v61, s[16:19], 0 offen offset:512
mvvac 36,76,232
rv 188,113,0
cv 215,234,235
mvvac 40,68,228
s_lshl_b32 s44, s20, 10
s_add_u32 s45, s44, 0x12f000
s_add_u32 m0, s44, 0x12000
mvvac 40,80,232
rv 132,5,7168
ad 13,13,236
mvvac 44,72,228
ra 228,4,0
s_and_b32 s44, s20, 1
mvvac 44,84,232
wl 8
ra 232,4,1024
s_lshl_b32 s44, s44, 10
mvvac 36,88,236
wl 8
dm 1,12,45,0
mvvac 36,148,240
s_add_u32 s45, s44, 0x130000
s_add_u32 m0, s44, 0x13000
s_add_u32 s22, s23, 0
mvvac 40,92,236
rv 192,114,0
v_fma_f32 v16, v236, v236, v16
mvvac 40,156,240
dm 1,12,45,0
mvvac 44,96,236
ra 236,4,2048
s_mov_b32 m0, s22
mvvac 44,164,240
wl 7
ra 240,4,3072
ad 13,13,237
mvvac 36,152,244
wl 7
buffer_store_dwordx2 v[32:33], v62, s[16:19], 0 offen offset:512
mvvac 36,180,248
dm 1,12,24,0
mvvac 40,160,244
s_mov_b32 m0, s22
rv 196,115,0
v_fma_f32 v16, v237, v237, v16
mvvac 40,252,248
dm 1,12,24,1024
mvvac 44,168,244
ra 244,4,4096
s_mov_b32 m0, s22
mvvac 44,172,248
wl 6
ra 248,4,5120
aw 104,212
mvaac 48,144,228
wl 6
buffer_store_dwordx2 v[204:205], v63, s[16:19], 0 offen offset:512
mvaac 48,156,232
dm 1,12,24,2048
mvaaz 52,136,180
rv 176,121,0
s_mov_b32 m0, s22
mvaac 52,148,228
rv 140,117,0
aw 116,213
mvaac 52,160,232
rv 144,118,0
ad 13,13,238
mvaaz 56,140,180
v_fma_f32 v16, v238, v238, v16
ad 13,13,239
mvaac 56,152,228
ra 228,4,6144
v_fma_f32 v16, v239, v239, v16
mvaac 56,164,232
ra 232,4,7168
cv 212,236,237
mvvvz 232,136,200
dm 1,12,24,3072
v_smfmac_f32_16x16x64_bf16 v[232:235], v[128:131], v[184:191], v6
wl 7
rv 184,119,0
cv 213,238,239
v_smfmac_f32_16x16x64_bf16 v[232:235], v[132:135], v[192:199], v6
rv 188,120,0
s_add_u32 s25, s24, 0x1000
mvaac 48,168,236
rv 200,126,0
s_add_u32 m0, s22, 0x1000
mvaac 48,192,240
rv 192,122,0
ad 14,14,240
mvaac 52,172,236
dm 1,12,25,0
mvaac 52,196,240
rv 196,123,0
s_add_u32 m0, s22, 0x1000
mvaac 56,176,236
ra 236,4,8192
s_add_u32 s24, s24, 0x6000
mvaac 56,200,240
wl 10
ra 240,4,9216
v_fma_f32 v17, v240, v240, v17
mvvvz 236,136,176
wl 9
rv 176,116,512
ad 14,14,241
v_smfmac_f32_16x16x64_bf16 v[236:239], v[128:131], v[140:147], v6
wl 6
rv 140,124,0
v_fma_f32 v17, v241, v241, v17
v_smfmac_f32_16x16x64_bf16 v[236:239], v[132:135], v[184:191], v6
rv 144,125,0
aw 97,214
mvaac 48,204,244
dm 1,12,25,1024
mvaac 48,216,248
aw 109,215
ad 14,14,242
mvaac 52,208,244
v_fma_f32 v17, v242, v242, v17
ad 14,14,243
mvaac 52,220,248
v_fma_f32 v17, v243, v243, v17
cv 214,240,241
mvaac 56,212,244
ra 244,4,10240
cv 215,242,243
mvaac 56,224,248
wl 8
ra 248,4,11264
ad 12,12,232
mvvvz 240,136,200
wl 7
rv 136,5,11264
v_fma_f32 v15, v232, v232, v15
v_smfmac_f32_16x16x64_bf16 v[240:243], v[128:131], v[192:199], v6
wl 3
rv 128,5,9216
ad 12,12,233
v_smfmac_f32_16x16x64_bf16 v[240:243], v[132:135], v[140:147], v6
rv 184,112,512
s_add_u32 m0, s80, 0x1d000
mvvac 48,64,228
rv 188,113,512
s_add_u32 s81, s42, 0x2c0
mvvac 48,76,232
rv 132,5,10240
rv 192,114,512
mvvac 52,68,228
rv 196,115,512
v_fma_f32 v15, v233, v233, v15
mvvac 52,80,232
dm 8,8,81,0
mvvac 56,72,228
ra 228,4,12288
aw 101,212
mvvac 56,84,232
ra 232,4,13312
aw 113,213
mvvac 48,88,236
rv 200,121,512
ad 12,12,234
mvvac 48,148,240
v_fma_f32 v15, v234, v234, v15
ad 12,12,235
mvvac 52,92,236
v_fma_f32 v15, v235, v235, v15
cv 212,232,233
mvvac 52,156,240
wl 9
cv 213,234,235
s_add_u32 m0, s80, 0x1d400
mvvvz 232,136,176
wl 6
rv 140,117,512
s_add_u32 s81, s43, 0x2c0
v_smfmac_f32_16x16x64_bf16 v[232:235], v[128:131], v[184:191], v6
wl 4
rv 144,118,512
ad 13,13,236
v_smfmac_f32_16x16x64_bf16 v[232:235], v[132:135], v[192:199], v6
rv 184,119,512
v_fma_f32 v16, v236, v236, v16
mvvac 56,96,236
ra 236,4,14336
rv 188,120,512
mvvac 56,164,240
ra 240,4,15360
ad 13,13,237
mvvac 48,152,244
dm 9,8,81,0
mvvac 48,180,248
rv 176,126,512
v_fma_f32 v16, v237, v237, v16
mvvac 52,160,244
aw 105,214
aw 117,215
mvvac 52,252,248
ad 13,13,238
v_fma_f32 v16, v238, v238, v16
mvvac 56,168,244
ra 244,4,16384
ad 13,13,239
mvvac 56,172,248
s_add_u32 m0, s80, 0x1d800
rv 192,122,512
rv 196,123,512
v_fma_f32 v16, v239, v239, v16
ra 248,4,17408
cv 214,236,237
cv 215,238,239
wl 11
mvvvz 236,136,200
wl 9
s_add_u32 s81, s46, 0x2c0
ad 14,14,240
v_fma_f32 v17, v240, v240, v17
v_smfmac_f32_16x16x64_bf16 v[236:239], v[128:131], v[140:147], v6
wl 6
dm 10,8,81,0
v_smfmac_f32_16x16x64_bf16 v[236:239], v[132:135], v[184:191], v6
rv 140,124,512
rv 144,125,512
s_add_u32 m0, s80, 0x1dc00
s_add_u32 s81, s47, 0x2c0
ad 14,14,241
v_fma_f32 v17, v241, v241, v17
aw 98,212
aw 110,213
ad 14,14,242
v_fma_f32 v17, v242, v242, v17
ad 14,14,243
v_fma_f32 v17, v243, v243, v17
cv 212,240,241
cv 213,242,243
wl 6
mvvvz 240,136,176
wl 3
dm 11,8,81,0
v_smfmac_f32_16x16x64_bf16 v[240:243], v[128:131], v[192:199], v6
cv 208,100,36
cv 210,101,37
cv 244,102,38
cv 246,103,39
mvaaz 100,132,184
cv 248,104,40
cv 250,105,41
mvaac 100,144,228
wl 0
cv 24,106,42
cv 26,107,43
v_smfmac_f32_16x16x64_bf16 v[240:243], v[132:135], v[140:147], v6
cv 28,108,44
mvaac 100,156,232
cv 30,109,45
cv 32,110,46
mvaaz 104,136,184
cv 204,111,47
aw 102,214
mvaac 104,148,228
aw 114,215
ad 12,12,232
mvaac 104,160,232
v_fma_f32 v15, v232, v232, v15
cv 214,232,233
mvaaz 108,140,184
cv 215,234,235
ad 13,13,236
mvaac 108,152,228
ra 228,4,18432
v_fma_f32 v16, v236, v236, v16
mvaac 108,164,232
ra 232,4,19456
ad 14,14,240
mvaac 100,168,236
v_fma_f32 v17, v240, v240, v17
aw 106,212
mvaac 100,192,240
aw 118,213
ad 12,12,233
mvaac 104,172,236
v_fma_f32 v15, v233, v233, v15
aw 99,214
mvaac 104,196,240
aw 111,215
ad 13,13,237
mvaac 108,176,236
ra 236,4,20480
v_fma_f32 v16, v237, v237, v16
mvaac 108,200,240
ra 240,4,21504
ad 14,14,241
mvaac 100,204,244
v_fma_f32 v17, v241, v241, v17
ad 12,12,234
mvaac 100,216,248
v_fma_f32 v15, v234, v234, v15
ad 13,13,238
mvaac 104,208,244
v_fma_f32 v16, v238, v238, v16
wv 4
s_barrier
mvaac 104,220,248
cv 212,236,237
cv 213,238,239
mvaac 108,212,244
ra 244,4,22528
ad 14,14,242
mvaac 108,224,248
wl 4
ra 248,4,23552
v_fma_f32 v17, v242, v242, v17
mvvac 100,64,228
wl 4
cv 214,240,241
cv 215,242,243
mvvac 100,76,232
v_add_u32 v2, 0, v1
ad 12,12,235
mvvac 104,68,228
v_fma_f32 v15, v235, v235, v15
s_lshl_b32 s44, s20, 10
mvvac 104,80,232
s_add_u32 s45, s44, 0x130800
s_add_u32 m0, s44, 0x13800
ad 13,13,239
mvvac 108,72,228
ra 228,2,0
s_and_b32 s44, s20, 1
mvvac 108,84,232
wl 4
ra 232,2,1024
s_lshl_b32 s44, s44, 10
mvvac 100,88,236
wl 4
dm 1,12,45,0
mvvac 100,148,240
s_add_u32 s45, s44, 0x131800
s_add_u32 m0, s44, 0x14800
s_add_u32 s22, s23, 0x6000
mvvac 104,92,236
s_add_u32 s25, s24, 0x1000
v_fma_f32 v16, v239, v239, v16
aw 103,212
mvvac 104,156,240
dm 1,12,45,0
mvvac 108,96,236
ra 236,2,2048
s_mov_b32 m0, s22
mvvac 108,164,240
wl 4
ra 240,2,3072
aw 115,213
mvvac 100,152,244
wl 4
dm 1,12,24,0
mvvac 100,180,248
s_mov_b32 m0, s22
ad 14,14,243
v_fma_f32 v17, v243, v243, v17
mvvac 104,160,244
dm 1,12,24,1024
mvvac 104,252,248
s_mov_b32 m0, s22
cv 209,48,100
cv 211,49,101
mvvac 108,168,244
cv 245,50,102
cv 247,51,103
mvvac 108,172,248
dm 1,12,24,2048
s_mov_b32 m0, s22
cv 249,52,104
cv 251,53,105
cv 25,54,106
cv 27,55,107
dm 1,12,24,3072
s_add_u32 m0, s22, 0x1000
buffer_store_dwordx2 v[208:209], v224, s[16:19], 0 offen offset:640
cv 29,56,108
cv 31,57,109
dm 1,12,25,0
s_add_u32 m0, s22, 0x1000
buffer_store_dwordx2 v[210:211], v225, s[16:19], 0 offen offset:640
s_add_u32 s24, s24, 0x6000
dm 1,12,25,1024
s_add_u32 s21, s21, 1
buffer_store_dwordx2 v[244:245], v226, s[16:19], 0 offen offset:640
s_add_u32 s37, s35, s21
buffer_store_dwordx2 v[246:247], v227, s[16:19], 0 offen offset:640
s_lshl_b32 s39, s21, 2
buffer_store_dwordx2 v[248:249], v228, s[16:19], 0 offen offset:640
s_add_u32 s39, s39, s20
buffer_store_dwordx2 v[250:251], v229, s[16:19], 0 offen offset:640
s_mul_i32 s39, s39, 0x910
buffer_store_dwordx2 v[24:25], v230, s[16:19], 0 offen offset:640
s_add_u32 s39, s39, 0x21340
buffer_store_dwordx2 v[26:27], v231, s[16:19], 0 offen offset:640
v_and_b32 v27, 15, v0
cv 33,58,110
cv 205,59,111
aw 107,214
aw 119,215
s_mul_i32 s33, s37, 14
buffer_store_dwordx2 v[28:29], v60, s[16:19], 0 offen offset:640
v_lshrrev_b32 v28, 4, v0
v_lshlrev_b32 v20, 4, v28
v_lshrrev_b32 v29, 2, v27
v_add_u32 v20, s39, v20
v_lshlrev_b32 v29, 4, v29
s_add_u32 s39, s39, 0x600
buffer_store_dwordx2 v[30:31], v61, s[16:19], 0 offen offset:640
v_and_b32 v30, 3, v27
v_lshl_add_u32 v29, v30, 1, v29
v_add_u32 v21, s39, v29
buffer_store_dwordx2 v[32:33], v62, s[16:19], 0 offen offset:640
buffer_store_dwordx2 v[204:205], v63, s[16:19], 0 offen offset:640
s_branch L_round
L_outl:
mvvvz 232,100,172
v_and_b32 v24, 15, v0
v_lshrrev_b32 v25, 4, v0
mvvvz 236,108,172
v_and_b32 v60, 3, v24
v_cmp_eq_u32 vcc, v60, v25
mvvvz 240,116,172
v_lshrrev_b32 v61, 2, v24
v_mov_b32 v60, 63
mvvvz 244,124,172
v_cndmask_b32 v61, v60, v61, vcc
v_cmp_eq_u32 vcc, 0, v61
mvvvz 184,132,172
v_mov_b32 v24, 0x3f80
v_cndmask_b32 v60, 0, v24, vcc
mvvvz 192,100,148
v_cmp_eq_u32 vcc, 1, v61
aw 180,60
mvvvz 196,108,148
s_add_u32 s85, s77, 0x1000
v_lshlrev_b32 v62, 16, v60
v_cndmask_b32 v60, 0, v24, vcc
aw 184,62
v_cmp_eq_u32 vcc, 2, v61
aw 181,60
v_lshlrev_b32 v62, 16, v60
v_cndmask_b32 v60, 0, v24, vcc
aw 185,62
v_cmp_eq_u32 vcc, 3, v61
aw 182,60
v_lshlrev_b32 v62, 16, v60
aw 186,62
v_cndmask_b32 v60, 0, v24, vcc
ds_read_u16 v106, v21 offset:576
ds_read_u16 v114, v21 offset:584
ds_read_u16 v122, v21 offset:640
ds_read_u16 v130, v21 offset:648
ds_read_u16 v138, v21 offset:704
ds_read_u16 v146, v21 offset:712
v_lshlrev_b32 v62, 16, v60
aw 183,60
cv 140,48,49
cv 141,50,51
mvaaz 36,0,180
wl 9
cv 142,52,53
cv 143,54,55
mvaac 36,144,228
aw 187,62
cv 144,56,57
mvvvz 188,140,172
wl 5
cv 145,58,59
v_max3_f32 v26, v200, v201, v202
mvvvc 232,104,176
wl 4
ra 244,2,4096
v_max3_f32 v26, v26, v203, v204
mvvvc 236,112,176
wl 4
ra 248,2,5120
v_max3_f32 v26, v26, v205, v206
mvvvc 240,120,176
wl 4
v_max3_f32 v26, v26, v207, v208
v_max3_f32 v26, v26, v209, v210
mvvvc 244,128,176
wl 3
v_max3_f32 v26, v26, v211, v212
v_mov_b32 v27, v26
mvvvc 184,136,176
wl 2
v_permlane16_swap_b32 v26, v27
mvvvc 188,144,176
mx 26,26,27
v_mov_b32 v27, v26
mvvvc 192,104,152
v_max3_f32 v29, v216, v217, v218
v_max3_f32 v29, v29, v219, v220
mvvvc 196,112,152
v_permlane32_swap_b32 v26, v27
mvaac 36,156,232
v_max3_f32 v29, v29, v221, v222
v_max3_f32 v29, v29, v223, v224
mvaaz 40,4,180
mx 26,26,27
v_max3_f32 v29, v29, v225, v226
mvaac 40,148,228
v_mul_f32 v28, s61, v26
v_max3_f32 v29, v29, v227, v228
mvaac 40,160,232
v_fma_f32 v200, v200, s32, v28
v_fma_f32 v201, v201, s32, v28
mvaaz 44,8,180
v_mov_b32 v30, v29
ex 200,200
mvaac 44,152,228
ra 228,2,6144
ex 201,201
mvaac 44,164,232
ra 232,2,7168
v_fma_f32 v202, v202, s32, v28
mvaac 36,168,236
ex 202,202
mvaac 36,192,240
v_fma_f32 v203, v203, s32, v28
ex 203,203
mvaac 40,172,236
v_fma_f32 v204, v204, s32, v28
v_permlane16_swap_b32 v29, v30
mvaac 40,196,240
ex 204,204
mvaac 44,176,236
ra 236,2,8192
v_fma_f32 v205, v205, s32, v28
mvaac 44,200,240
wl 4
ra 240,2,12288
ad 249,200,201
mvaac 36,204,244
wl 4
ex 205,205
mvaac 36,216,248
v_fma_f32 v206, v206, s32, v28
ad 249,249,202
mvaac 40,208,244
mx 29,29,30
ex 206,206
mvaac 40,220,248
v_fma_f32 v207, v207, s32, v28
ad 249,249,203
mvaac 44,212,244
ra 244,2,13312
v_mov_b32 v30, v29
mvaac 44,224,248
wl 4
ra 248,2,14336
ex 207,207
mvvac 36,64,228
wl 4
v_fma_f32 v208, v208, s32, v28
ad 249,249,204
mvvac 36,76,232
ex 208,208
mvvac 40,68,228
v_fma_f32 v209, v209, s32, v28
ad 249,249,205
mvvac 40,80,232
ex 209,209
mvvac 44,72,228
ra 228,2,15360
v_fma_f32 v210, v210, s32, v28
mvvac 44,84,232
wl 4
ra 232,2,16384
ad 249,249,206
mvvac 36,88,236
v_permlane32_swap_b32 v29, v30
mvvac 40,92,236
ex 210,210
mvvac 44,96,236
ra 236,2,17408
v_fma_f32 v211, v211, s32, v28
mvaaz 48,0,184
wl 5
v_fma_f32 v212, v212, s32, v28
ad 249,249,207
mvaac 48,144,240
wl 4
ex 211,211
mvaac 48,156,244
ex 212,212
mvaaz 52,4,184
ad 249,249,208
mx 29,29,30
mvaac 52,148,240
ad 249,249,209
v_mul_f32 v31, s61, v29
mvaac 52,160,244
ad 249,249,210
v_fma_f32 v216, v216, s32, v31
mvaaz 56,8,184
v_fma_f32 v217, v217, s32, v31
mu 212,23,212
mvaac 56,152,240
ra 240,2,18432
ad 249,249,211
mvaac 56,164,244
wl 4
ra 244,2,19456
ex 216,216
mvaac 48,168,248
wl 4
ex 217,217
mvaac 48,192,228
v_fma_f32 v218, v218, s32, v31
ad 249,249,212
mvaac 52,172,248
ex 218,218
mvaac 52,196,228
v_fma_f32 v219, v219, s32, v31
v_mov_b32 v32, v249
mvaac 56,176,248
ra 248,2,20480
ex 219,219
mvaac 56,200,228
wl 4
ra 228,2,9216
v_fma_f32 v220, v220, s32, v31
mvaac 48,204,232
wl 4
ex 220,220
mvaac 48,216,236
v_fma_f32 v221, v221, s32, v31
ad 250,216,217
mvaac 52,208,232
ex 221,221
mvaac 52,220,236
v_fma_f32 v222, v222, s32, v31
ad 250,250,218
mvaac 56,212,232
ra 232,2,10240
v_permlane16_swap_b32 v249, v32
mvaac 56,224,236
wl 4
ra 236,2,11264
ex 222,222
mvvac 48,64,240
wl 4
v_fma_f32 v223, v223, s32, v31
ad 250,250,219
mvvac 48,76,244
ex 223,223
mvvac 52,68,240
v_fma_f32 v224, v224, s32, v31
ad 250,250,220
mvvac 52,80,244
ad 249,249,32
ex 224,224
mvvac 56,72,240
ra 240,2,21504
v_fma_f32 v225, v225, s32, v31
mvvac 56,84,244
wl 4
ra 244,2,22528
ad 250,250,221
mvvac 48,88,248
v_mov_b32 v32, v249
ex 225,225
mvvac 52,92,248
v_fma_f32 v226, v226, s32, v31
ad 250,250,222
mvvac 56,96,248
s_add_u32 s37, s33, s73
ra 248,2,23552
ex 226,226
v_fma_f32 v227, v227, s32, v31
v_fma_f32 v228, v228, s32, v31
ad 250,250,223
ex 227,227
ex 228,228
ad 250,250,224
v_permlane32_swap_b32 v249, v32
ad 250,250,225
ad 250,250,226
ad 249,249,32
mu 228,23,228
ad 250,250,227
v_rcp_f32 v249, v249
ad 250,250,228
v_mov_b32 v32, v250
mu 204,12,204
mu 205,13,205
mu 206,14,206
mu 207,15,207
mu 204,249,204
mu 205,249,205
mu 206,249,206
mu 207,249,207
cv 34,232,233
cv 35,234,235
cv 158,204,205
cv 159,206,207
mvvvz 204,124,148
s_mov_b64 exec, s[58:59]
ds_write_b64 v20, v[34:35] offset:576
s_mov_b64 exec, -1
mvvvc 204,128,152
s_add_u32 s38, s34, s74
v_permlane16_swap_b32 v250, v32
ad 250,250,32
v_mov_b32 v32, v250
cv 34,236,237
cv 35,238,239
v_permlane32_swap_b32 v250, v32
mu 200,8,200
mu 201,9,201
mu 202,10,202
mu 203,11,203
mu 208,16,208
mu 209,17,209
mu 210,18,210
mu 211,19,211
mu 200,249,200
mu 201,249,201
mu 202,249,202
mu 203,249,203
mu 208,249,208
mu 209,249,209
mu 210,249,210
mu 211,249,211
mu 212,249,212
ad 250,250,32
cv 156,200,201
cv 157,202,203
mvvvz 200,116,148
s_mov_b64 exec, s[58:59]
ds_write_b64 v20, v[34:35] offset:584
s_mov_b64 exec, -1
mvvvc 200,120,152
cv 160,208,209
cv 161,210,211
mvvvz 208,132,148
v_cvt_pk_bf16_f32 v162, v212, 0
v_rcp_f32 v250, v250
mvvvc 208,136,152
mu 216,8,216
mu 217,9,217
mvvvz 212,140,148
mu 218,10,218
mu 219,11,219
mvvvc 212,144,152
mu 220,12,220
mu 221,13,221
mvvvz 232,100,156
mu 222,14,222
mu 223,15,223
mvvvz 236,108,156
s_mul_i32 s37, s37, 0x46e00
cv 34,240,241
cv 35,242,243
mvvvz 240,116,156
s_mul_i32 s38, s38, 0x300
s_mov_b64 exec, s[58:59]
ds_write_b64 v20, v[34:35] offset:640
s_mov_b64 exec, -1
mu 216,250,216
mu 217,250,217
mu 218,250,218
mu 219,250,219
mu 220,250,220
mu 221,250,221
mu 222,250,222
mu 223,250,223
cv 164,216,217
cv 165,218,219
cv 166,220,221
cv 167,222,223
mu 224,16,224
mu 225,17,225
mu 226,18,226
mu 227,19,227
cv 154,204,205
cv 155,206,207
mvvvz 204,124,164
s_add_u32 s39, s37, s38
mu 224,250,224
mu 225,250,225
mu 226,250,226
mu 227,250,227
mu 228,250,228
cv 168,224,225
cv 169,226,227
v_cvt_pk_bf16_f32 v170, v228, 0
v_mov_b32 v171, 0
cv 34,244,245
cv 35,246,247
mvvvz 244,124,156
s_mov_b64 exec, s[58:59]
ds_write_b64 v20, v[34:35] offset:648
s_mov_b64 exec, -1
mvvvc 204,128,168
s_mov_b32 s40, 0x46e00
cv 34,184,185
cv 35,186,187
mvvvz 184,132,156
s_add_u32 s22, s23, 0x12000
s_mov_b64 exec, s[58:59]
ds_write_b64 v20, v[34:35] offset:704
s_mov_b64 exec, -1
cv 148,192,193
cv 149,194,195
mvvvz 192,100,164
cv 150,196,197
cv 151,198,199
mvvvc 192,104,168
cv 152,200,201
cv 153,202,203
mvvvz 196,108,164
cv 180,208,209
cv 181,210,211
mvvvc 196,112,168
cv 182,212,213
cv 183,214,215
mvvvz 200,116,164
buffer_load_dwordx4 v[224:227], v1, s[12:15], s85 offen offset:0
mvvvc 200,120,168
buffer_load_dwordx4 v[228:231], v1, s[12:15], s85 offen offset:1024
mvvvz 208,132,164
buffer_load_dwordx4 v[60:63], v1, s[12:15], s85 offen offset:2048
mvvvc 208,136,168
cv 34,188,189
cv 35,190,191
mvvvz 188,140,156
s_mov_b64 exec, s[58:59]
ds_write_b64 v20, v[34:35] offset:712
s_mov_b64 exec, -1
mvvvz 212,140,164
v_and_b32 v26, 15, v0
v_min_u32 v28, 11, v26
mvvvc 212,144,168
wl 11
cv 171,206,207
v_lshrrev_b32 v29, 2, v26
mvvac 36,148,228
wl 10
v_mul_u32_u24 v206, 0x910, v28
v_add_u32 v29, s35, v29
mvvac 36,152,232
wl 9
v_mul_u32_u24 v29, 14, v29
v_bfe_u32 v28, v26, 1, 1
mvvac 36,180,236
wl 8
v_add3_u32 v29, v29, v28, 6
v_mul_lo_u32 v29, v29, s40
mvvac 48,148,240
wl 7
s_lshl_b32 s40, s20, 1
s_mov_b32 m0, s22
s_and_b32 s41, s20, 1
mvvac 48,152,244
s_add_u32 s45, s60, 0
v_mov_b32 v163, 0
s_waitcnt vmcnt(11) lgkmcnt(0)
s_barrier
mvvac 48,180,248
dm 1,12,24,0
mvvvc 232,104,160
cv 164,192,193
cv 165,194,195
mvvvc 236,112,160
buffer_load_dwordx4 v[112:115], v1, s[12:15], s45 offen offset:0
mvvvc 240,120,160
s_add_u32 s45, s60, 0x400
cv 156,232,233
cv 157,234,235
mvvvc 244,128,160
buffer_load_dwordx4 v[116:119], v1, s[12:15], s45 offen offset:0
mvvvc 184,136,160
s_add_u32 s45, s60, 0x800
cv 158,236,237
cv 159,238,239
mvvvc 188,144,160
buffer_load_dwordx4 v[236:239], v1, s[12:15], s45 offen offset:0
mvvac 40,156,228
s_add_u32 s45, s60, 0xc00
cv 160,240,241
cv 161,242,243
mvvac 52,156,240
buffer_load_dwordx4 v[240:243], v1, s[12:15], s45 offen offset:0
mvaaz 100,12,180
s_add_u32 s45, s60, 0x1000
cv 162,244,245
cv 163,246,247
mvaaz 104,16,180
buffer_load_dwordx4 v[12:15], v1, s[12:15], s45 offen offset:0
mvvac 40,160,232
cv 166,196,197
cv 167,198,199
mvvac 52,160,244
s_add_u32 s45, s60, 0x1400
s_mov_b32 m0, s22
cv 168,200,201
mvvac 44,164,228
buffer_load_dwordx4 v[16:19], v1, s[12:15], s45 offen offset:0
mvvac 56,164,240
dm 1,12,24,1024
mvaaz 108,20,180
s_mov_b32 m0, s22
cv 169,202,203
cv 170,204,205
cv 252,184,185
cv 253,186,187
mvvac 44,168,232
cv 254,188,189
cv 255,190,191
mvvac 56,168,244
cv 172,208,209
cv 173,210,211
mvvac 40,252,236
cv 174,212,213
cv 175,214,215
mvvac 52,252,248
v_add_u32 v3, 0x6000, v1
s_cmp_ge_u32 s20, 2
mvvac 44,172,236
ra 228,3,0
ra 232,3,1024
mvvac 56,172,248
ra 244,3,2048
dm 1,12,24,2048
ra 248,3,3072
s_mov_b32 s38, 0
v_lshrrev_b32 v27, 4, v0
s_cselect_b32 s37, 0x6000, s38
v_lshl_add_u32 v206, v27, 4, v206
s_add_u32 s37, s37, s72
v_add_u32 v206, 0x21340, v206
rv 120,206,0
v_add_u32 v214, s37, v1
v_and_b32 v28, 1, v26
v_add3_u32 v30, v28, s34, 6
v_mul_u32_u24 v30, 0x300, v30
v_lshlrev_b32 v28, 5, v27
v_add3_u32 v207, v29, v30, v28
v_add_u32 v207, s40, v207
v_mov_b32 v28, 0x80000000
wl 4
mvaac 100,144,228
wl 3
ra 236,214,0
v_cmp_eq_u32 s[82:83], 1, s41
mvaac 100,156,232
ra 240,214,1024
v_cndmask_b32 v207, v28, v207, s[56:57]
mvaac 104,148,228
rv 124,206,64
ar 8,180
mvaac 104,160,232
ar 28,184
v_cndmask_b32 v8, v8, v28, s[82:83]
mvaac 108,152,228
ra 228,214,2048
ar 9,181
mvaac 108,164,232
wl 6
ra 232,214,3072
ar 28,185
mvaac 100,168,244
wl 6
v_cndmask_b32 v9, v9, v28, s[82:83]
ar 10,182
mvaac 100,192,248
ar 28,186
s_mov_b32 m0, s22
mvaac 104,172,244
v_cndmask_b32 v10, v10, v28, s[82:83]
ar 11,183
mvaac 104,196,248
dm 1,12,24,3072
mvaac 108,176,244
ra 244,214,4096
ar 28,187
mvaac 108,200,248
s_add_u32 s25, s24, 0x1000
rv 128,206,128
rv 132,206,192
v_cndmask_b32 v11, v11, v28, s[82:83]
rv 136,206,256
s_add_u32 m0, s22, 0x1000
rv 140,206,320
ra 248,214,5120
rv 144,206,384
dm 1,12,25,0
s_add_u32 m0, s22, 0x1000
rv 184,206,448
s_add_u32 s24, s24, 0x6000
rv 188,206,512
rv 192,206,576
rv 196,206,640
rv 200,206,704
cv 208,36,48
cv 210,37,49
cv 244,38,50
cv 246,39,51
mvaaz 36,12,184
cv 248,40,52
cv 250,41,53
mvaaz 48,24,180
cv 24,42,54
cv 26,43,55
mvaaz 40,16,184
cv 28,44,56
cv 30,45,57
mvaaz 52,28,180
cv 32,46,58
cv 204,47,59
mvaaz 44,20,184
s_add_u32 s22, s23, 0
v_add_u32 v4, 0xc000, v1
v_add_u32 v2, 0x12000, v1
mvaaz 56,32,180
wv 13
s_mov_b32 s38, 0xc000
v_add_u32 v224, s39, v224
v_add_u32 v225, s39, v225
v_add_u32 v226, s39, v226
v_add_u32 v227, s39, v227
wv 12
v_add_u32 v228, s39, v228
v_add_u32 v229, s39, v229
v_add_u32 v230, s39, v230
v_add_u32 v231, s39, v231
wv 11
v_add_u32 v60, s39, v60
v_add_u32 v61, s39, v61
v_add_u32 v62, s39, v62
v_add_u32 v63, s39, v63
wv 9
mvvvz 232,8,112
wl 15
mvavc 232,236,120
wl 14
ra 236,3,4096
mvavc 232,240,124
wl 11
ra 240,3,5120
mvavc 232,228,128
wl 11
ra 228,3,6144
mvavc 232,232,132
wl 11
ra 232,3,7168
mvavc 232,244,136
wl 10
ra 244,3,8192
mvavc 232,248,140
wl 4
ra 248,3,9216
mvaac 100,204,236
wl 4
mvaac 100,216,240
mvaac 104,208,236
mvaac 104,220,240
mvaac 108,212,236
ra 236,214,6144
mvaac 108,224,240
wl 4
ra 240,214,7168
mvvac 100,64,228
wl 4
dm 1,12,25,1024
mvvac 100,76,232
s_mov_b32 m0, s22
s_add_u32 s25, s24, 0x1000
mvvac 104,68,228
mvvac 104,80,232
mvvac 108,72,228
ra 228,214,8192
mvvac 108,84,232
wl 2
ra 232,214,9216
mvavc 232,236,144
wl 2
ra 236,3,10240
mvavc 232,240,184
ra 240,3,11264
mvvac 100,88,244
mvvac 100,148,248
mvvac 104,92,244
mvvac 104,156,248
mvvac 108,96,244
ra 244,214,10240
mvvac 108,164,248
wl 4
ra 248,214,11264
mvavc 232,228,188
wl 4
ra 228,3,12288
mvavc 232,232,192
wl 4
ra 232,3,13312
mvvac 100,152,236
wl 4
mvvac 100,180,240
mvvac 104,160,236
mvvac 104,252,240
mvvac 108,168,236
ra 236,3,14336
wl 3
s_barrier
mvvac 108,172,240
ra 240,3,15360
mvavc 232,244,196
ra 244,3,16384
mvavc 232,248,200
wl 4
ra 248,3,17408
mvaac 36,144,228
wl 4
dm 1,12,24,0
mvaac 36,156,232
cv 212,232,232
s_mov_b32 m0, s22
mvaac 40,148,228
cv 213,233,233
cv 215,234,234
mvaac 40,160,232
cv 5,235,235
mvaac 44,152,228
ra 228,3,18432
mvaac 44,164,232
wl 4
ra 232,3,19456
mvaac 36,168,236
wl 4
buffer_store_short v212, v207, s[16:19], 0 offen offset:0
mvaac 36,192,240
mvaac 40,172,236
mvaac 40,196,240
mvaac 44,176,236
ra 236,3,20480
mvaac 44,200,240
wl 4
ra 240,3,21504
mvaac 36,204,244
wl 4
buffer_store_short v213, v207, s[16:19], 0 offen offset:8
mvaac 36,216,248
dm 1,12,24,1024
mvaac 40,208,244
s_mov_b32 m0, s22
mvaac 40,220,248
mvaac 44,212,244
ra 244,3,22528
mvaac 44,224,248
wl 4
ra 248,3,23552
v_add_u32 v3, 0, v1
mvvac 36,64,228
wl 4
buffer_store_short v215, v207, s[16:19], 0 offen offset:16
mvvac 36,76,232
mvvac 40,68,228
mvvac 40,80,232
dm 1,12,24,2048
mvvac 44,72,228
ra 228,4,0
s_mov_b32 m0, s22
mvvac 44,84,232
wl 4
ra 232,4,1024
mvvac 36,88,236
wl 4
buffer_store_short v5, v207, s[16:19], 0 offen offset:24
mvvac 36,148,240
mvvac 40,92,236
mvvac 40,156,240
mvvac 44,96,236
ra 236,4,2048
mvvac 44,164,240
wl 4
ra 240,4,3072
mvvac 36,152,244
wl 4
mvvac 36,180,248
mvvac 40,160,244
dm 1,12,24,3072
mvvac 40,252,248
cv 209,100,36
s_add_u32 m0, s22, 0x1000
mvvac 44,168,244
ra 244,4,4096
cv 211,101,37
mvvac 44,172,248
wl 4
ra 248,4,5120
cv 245,102,38
mvaac 48,144,228
wl 4
buffer_store_dwordx2 v[208:209], v224, s[16:19], 0 offen offset:0
mvaac 48,156,232
cv 247,103,39
cv 249,104,40
mvaac 52,148,228
cv 251,105,41
cv 25,106,42
mvaac 52,160,232
cv 27,107,43
cv 29,108,44
mvaac 56,152,228
ra 228,4,6144
cv 31,109,45
mvaac 56,164,232
wl 4
ra 232,4,7168
cv 33,110,46
mvaac 48,168,236
wl 4
dm 1,12,25,0
mvaac 48,192,240
buffer_store_dwordx2 v[210:211], v225, s[16:19], 0 offen offset:0
mvaac 52,172,236
s_add_u32 m0, s22, 0x1000
s_add_u32 s24, s24, 0x6000
cv 205,111,47
mvaac 52,196,240
s_add_u32 s22, s23, 0x6000
mvaac 56,176,236
ra 236,4,8192
mvaac 56,200,240
wl 4
ra 240,4,9216
mvaac 48,204,244
wl 4
buffer_store_dwordx2 v[244:245], v226, s[16:19], 0 offen offset:0
mvaac 48,216,248
mvaac 52,208,244
mvaac 52,220,248
dm 1,12,25,1024
mvaac 56,212,244
ra 244,4,10240
s_mov_b32 m0, s22
mvaac 56,224,248
wl 4
ra 248,4,11264
s_add_u32 s25, s24, 0x1000
mvvac 48,64,228
wl 4
buffer_store_dwordx2 v[246:247], v227, s[16:19], 0 offen offset:0
mvvac 48,76,232
mvvac 52,68,228
mvvac 52,80,232
wv 14
s_barrier
mvvac 56,72,228
ra 228,4,12288
mvvac 56,84,232
wl 4
ra 232,4,13312
mvvac 48,88,236
wl 4
buffer_store_dwordx2 v[248:249], v228, s[16:19], 0 offen offset:0
mvvac 48,148,240
mvvac 52,92,236
mvvac 52,156,240
buffer_store_dwordx2 v[250:251], v229, s[16:19], 0 offen offset:0
mvvac 56,96,236
ra 236,4,14336
mvvac 56,164,240
wl 4
ra 240,4,15360
mvvac 48,152,244
wl 4
mvvac 48,180,248
mvvac 52,160,244
buffer_store_dwordx2 v[24:25], v230, s[16:19], 0 offen offset:0
mvvac 52,252,248
mvvac 56,168,244
ra 244,4,16384
mvvac 56,172,248
ra 248,4,17408
mvaaz 100,24,184
wl 5
mvaac 100,144,228
wl 4
buffer_store_dwordx2 v[26:27], v231, s[16:19], 0 offen offset:0
mvaac 100,156,232
dm 1,12,24,0
mvaaz 104,28,184
s_mov_b32 m0, s22
mvaac 104,148,228
mvaac 104,160,232
mvaaz 108,32,184
buffer_store_dwordx2 v[28:29], v60, s[16:19], 0 offen offset:0
mvaac 108,152,228
ra 228,4,18432
mvaac 108,164,232
wl 4
ra 232,4,19456
mvaac 100,168,236
wl 4
mvaac 100,192,240
mvaac 104,172,236
buffer_store_dwordx2 v[30:31], v61, s[16:19], 0 offen offset:0
mvaac 104,196,240
mvaac 108,176,236
ra 236,4,20480
mvaac 108,200,240
wl 4
ra 240,4,21504
mvaac 100,204,244
wl 4
dm 1,12,24,1024
mvaac 100,216,248
buffer_store_dwordx2 v[32:33], v62, s[16:19], 0 offen offset:0
mvaac 104,208,244
s_mov_b32 m0, s22
mvaac 104,220,248
mvaac 108,212,244
ra 244,4,22528
mvaac 108,224,248
wl 4
ra 248,4,23552
v_add_u32 v4, 0x6000, v1
mvvac 100,64,228
wl 4
buffer_store_dwordx2 v[204:205], v63, s[16:19], 0 offen offset:0
mvvac 100,76,232
mvvac 104,68,228
mvvac 104,80,232
dm 1,12,24,2048
mvvac 108,72,228
ra 228,2,0
s_mov_b32 m0, s22
mvvac 108,84,232
wl 4
ra 232,2,1024
mvvac 100,88,236
wl 4
mvvac 100,148,240
mvvac 104,92,236
mvvac 104,156,240
mvvac 108,96,236
mvvac 108,164,240
wl 3
mvvac 100,152,244
wl 2
mvvac 100,180,248
mvvac 104,160,244
dm 1,12,24,3072
mvvac 104,252,248
s_add_u32 m0, s22, 0x1000
s_cmp_ge_u32 s20, 2
s_cselect_b32 s37, 0x12000, s38
mvvac 108,168,244
ra 244,2,2048
s_add_u32 s37, s37, s72
mvvac 108,172,248
ra 248,2,3072
v_add_u32 v214, s37, v1
mvaaz 36,36,180
wl 3
ra 236,214,0
cv 208,48,100
mvaac 36,144,228
wl 3
ra 240,214,1024
cv 210,49,101
mvaac 36,156,232
cv 244,50,102
cv 246,51,103
mvaaz 40,40,180
cv 248,52,104
cv 250,53,105
mvaac 40,148,228
cv 24,54,106
cv 26,55,107
mvaac 40,160,232
cv 28,56,108
cv 30,57,109
mvaaz 44,44,180
cv 32,58,110
cv 204,59,111
mvaac 44,152,228
ra 228,214,2048
s_mov_b32 s38, 0
mvaac 44,164,232
ra 232,214,3072
mvvvz 232,8,116
wl 3
dm 1,12,25,0
mvavc 232,236,120
wl 2
ra 236,2,4096
s_add_u32 m0, s22, 0x1000
mvavc 232,240,124
ra 240,2,5120
s_add_u32 s24, s24, 0x6000
mvaac 36,168,244
s_add_u32 s22, s23, 0xc000
mvaac 36,192,248
mvaac 40,172,244
mvaac 40,196,248
mvaac 44,176,244
ra 244,214,4096
mvaac 44,200,248
wl 4
ra 248,214,5120
mvavc 232,228,128
wl 4
ra 228,2,6144
mvavc 232,232,132
wl 4
ra 232,2,7168
mvaac 36,204,236
wl 4
dm 1,12,25,1024
mvaac 36,216,240
s_mov_b32 m0, s22
s_add_u32 s25, s24, 0x1000
mvaac 40,208,236
mvaac 40,220,240
mvaac 44,212,236
ra 236,214,6144
mvaac 44,224,240
wl 4
ra 240,214,7168
mvavc 232,244,136
wl 4
ra 244,2,8192
mvavc 232,248,140
wl 4
ra 248,2,9216
mvvac 36,64,228
wl 4
mvvac 36,76,232
mvvac 40,68,228
mvvac 40,80,232
mvvac 44,72,228
ra 228,214,8192
mvvac 44,84,232
wl 4
ra 232,214,9216
mvavc 232,236,144
wl 4
ra 236,2,10240
mvavc 232,240,184
wl 4
ra 240,2,11264
mvvac 36,88,244
wl 4
mvvac 36,148,248
mvvac 40,92,244
mvvac 40,156,248
mvvac 44,96,244
ra 244,214,10240
mvvac 44,164,248
wl 4
ra 248,214,11264
mvavc 232,228,188
wl 4
ra 228,2,12288
mvavc 232,232,192
wl 4
ra 232,2,13312
mvvac 36,152,236
wl 4
mvvac 36,180,240
mvvac 40,160,236
mvvac 40,252,240
mvvac 44,168,236
ra 236,2,14336
s_waitcnt vmcnt(15) lgkmcnt(3)
s_barrier
mvvac 44,172,240
ra 240,2,15360
mvavc 232,244,196
ra 244,2,16384
mvavc 232,248,200
ra 248,2,17408
mvaaz 48,36,184
wl 5
mvaac 48,144,228
wl 4
cv 212,232,232
cv 213,233,233
mvaac 48,156,232
dm 1,12,24,0
mvaaz 52,40,184
s_mov_b32 m0, s22
cv 215,234,234
cv 5,235,235
mvaac 52,148,228
mvaac 52,160,232
mvaaz 56,44,184
mvaac 56,152,228
ra 228,2,18432
mvaac 56,164,232
wl 4
ra 232,2,19456
mvaac 48,168,236
wl 4
buffer_store_short v212, v207, s[16:19], 0 offen offset:128
mvaac 48,192,240
mvaac 52,172,236
mvaac 52,196,240
mvaac 56,176,236
ra 236,2,20480
mvaac 56,200,240
wl 4
ra 240,2,21504
mvaac 48,204,244
wl 4
buffer_store_short v213, v207, s[16:19], 0 offen offset:136
mvaac 48,216,248
dm 1,12,24,1024
mvaac 52,208,244
s_mov_b32 m0, s22
mvaac 52,220,248
mvaac 56,212,244
ra 244,2,22528
mvaac 56,224,248
wl 4
ra 248,2,23552
v_add_u32 v2, 0xc000, v1
mvvac 48,64,228
wl 4
buffer_store_short v215, v207, s[16:19], 0 offen offset:144
mvvac 48,76,232
mvvac 52,68,228
mvvac 52,80,232
dm 1,12,24,2048
mvvac 56,72,228
ra 228,3,0
s_mov_b32 m0, s22
mvvac 56,84,232
wl 4
ra 232,3,1024
mvvac 48,88,236
wl 4
buffer_store_short v5, v207, s[16:19], 0 offen offset:152
mvvac 48,148,240
mvvac 52,92,236
mvvac 52,156,240
mvvac 56,96,236
ra 236,3,2048
mvvac 56,164,240
wl 4
ra 240,3,3072
mvvac 48,152,244
wl 4
mvvac 48,180,248
mvvac 52,160,244
dm 1,12,24,3072
mvvac 52,252,248
cv 209,36,48
s_add_u32 m0, s22, 0x1000
mvvac 56,168,244
ra 244,3,4096
cv 211,37,49
mvvac 56,172,248
ra 248,3,5120
cv 245,38,50
mvaaz 100,48,180
wl 5
cv 247,39,51
cv 249,40,52
mvaac 100,144,228
wl 4
cv 251,41,53
cv 25,42,54
mvaac 100,156,232
cv 27,43,55
cv 29,44,56
mvaaz 104,52,180
cv 31,45,57
cv 33,46,58
mvaac 104,148,228
cv 205,47,59
mvaac 104,160,232
buffer_store_dwordx2 v[208:209], v224, s[16:19], 0 offen offset:128
mvaaz 108,56,180
mvaac 108,152,228
ra 228,3,6144
mvaac 108,164,232
wl 4
ra 232,3,7168
mvaac 100,168,236
wl 4
dm 1,12,25,0
mvaac 100,192,240
buffer_store_dwordx2 v[210:211], v225, s[16:19], 0 offen offset:128
mvaac 104,172,236
s_add_u32 m0, s22, 0x1000
s_add_u32 s24, s24, 0x6000
s_add_u32 s22, s23, 0x12000
mvaac 104,196,240
mvaac 108,176,236
ra 236,3,8192
mvaac 108,200,240
wl 4
ra 240,3,9216
mvaac 100,204,244
wl 4
buffer_store_dwordx2 v[244:245], v226, s[16:19], 0 offen offset:128
mvaac 100,216,248
mvaac 104,208,244
mvaac 104,220,248
dm 1,12,25,1024
mvaac 108,212,244
ra 244,3,10240
s_mov_b32 m0, s22
mvaac 108,224,248
wl 4
ra 248,3,11264
s_add_u32 s25, s24, 0x1000
mvvac 100,64,228
wl 4
buffer_store_dwordx2 v[246:247], v227, s[16:19], 0 offen offset:128
mvvac 100,76,232
mvvac 104,68,228
mvvac 104,80,232
wv 14
s_barrier
mvvac 108,72,228
ra 228,3,12288
mvvac 108,84,232
wl 4
ra 232,3,13312
mvvac 100,88,236
wl 4
buffer_store_dwordx2 v[248:249], v228, s[16:19], 0 offen offset:128
mvvac 100,148,240
mvvac 104,92,236
mvvac 104,156,240
buffer_store_dwordx2 v[250:251], v229, s[16:19], 0 offen offset:128
mvvac 108,96,236
ra 236,3,14336
mvvac 108,164,240
wl 4
ra 240,3,15360
mvvac 100,152,244
wl 4
mvvac 100,180,248
mvvac 104,160,244
buffer_store_dwordx2 v[24:25], v230, s[16:19], 0 offen offset:128
mvvac 104,252,248
mvvac 108,168,244
ra 244,3,16384
mvvac 108,172,248
ra 248,3,17408
mvaaz 36,48,184
wl 5
mvaac 36,144,228
wl 4
buffer_store_dwordx2 v[26:27], v231, s[16:19], 0 offen offset:128
mvaac 36,156,232
dm 1,12,24,0
mvaaz 40,52,184
s_mov_b32 m0, s22
mvaac 40,148,228
mvaac 40,160,232
mvaaz 44,56,184
buffer_store_dwordx2 v[28:29], v60, s[16:19], 0 offen offset:128
mvaac 44,152,228
ra 228,3,18432
mvaac 44,164,232
wl 4
ra 232,3,19456
mvaac 36,168,236
wl 4
mvaac 36,192,240
mvaac 40,172,236
buffer_store_dwordx2 v[30:31], v61, s[16:19], 0 offen offset:128
mvaac 40,196,240
mvaac 44,176,236
ra 236,3,20480
mvaac 44,200,240
wl 4
ra 240,3,21504
mvaac 36,204,244
wl 4
dm 1,12,24,1024
mvaac 36,216,248
buffer_store_dwordx2 v[32:33], v62, s[16:19], 0 offen offset:128
mvaac 40,208,244
s_mov_b32 m0, s22
mvaac 40,220,248
mvaac 44,212,244
ra 244,3,22528
mvaac 44,224,248
wl 4
ra 248,3,23552
v_add_u32 v3, 0x12000, v1
mvvac 36,64,228
wl 4
buffer_store_dwordx2 v[204:205], v63, s[16:19], 0 offen offset:128
mvvac 36,76,232
mvvac 40,68,228
mvvac 40,80,232
dm 1,12,24,2048
mvvac 44,72,228
ra 228,4,0
s_mov_b32 m0, s22
mvvac 44,84,232
wl 4
ra 232,4,1024
mvvac 36,88,236
wl 4
mvvac 36,148,240
mvvac 40,92,236
mvvac 40,156,240
mvvac 44,96,236
mvvac 44,164,240
wl 3
mvvac 36,152,244
wl 2
mvvac 36,180,248
mvvac 40,160,244
dm 1,12,24,3072
mvvac 40,252,248
s_add_u32 m0, s22, 0x1000
s_cmp_ge_u32 s20, 2
s_cselect_b32 s37, 0x6000, s38
mvvac 44,168,244
ra 244,4,2048
s_add_u32 s37, s37, s72
mvvac 44,172,248
ra 248,4,3072
v_add_u32 v214, s37, v1
mvaaz 48,60,180
wl 3
ra 236,214,0
cv 208,100,36
mvaac 48,144,228
wl 3
ra 240,214,1024
cv 210,101,37
mvaac 48,156,232
cv 244,102,38
cv 246,103,39
mvaaz 52,64,180
cv 248,104,40
cv 250,105,41
mvaac 52,148,228
cv 24,106,42
cv 26,107,43
mvaac 52,160,232
cv 28,108,44
cv 30,109,45
mvaaz 56,68,180
cv 32,110,46
cv 204,111,47
mvaac 56,152,228
ra 228,214,2048
s_mov_b32 s38, 0xc000
mvaac 56,164,232
ra 232,214,3072
mvvvz 232,8,236
wl 3
dm 1,12,25,0
mvavc 232,236,120
wl 2
ra 236,4,4096
s_add_u32 m0, s22, 0x1000
mvavc 232,240,124
ra 240,4,5120
s_add_u32 s24, s24, 0x6000
mvaac 48,168,244
s_add_u32 s22, s23, 0
mvaac 48,192,248
mvaac 52,172,244
mvaac 52,196,248
mvaac 56,176,244
ra 244,214,4096
mvaac 56,200,248
wl 4
ra 248,214,5120
mvavc 232,228,128
wl 4
ra 228,4,6144
mvavc 232,232,132
wl 4
ra 232,4,7168
mvaac 48,204,236
wl 4
dm 1,12,25,1024
mvaac 48,216,240
s_mov_b32 m0, s22
s_add_u32 s25, s24, 0x1000
mvaac 52,208,236
mvaac 52,220,240
mvaac 56,212,236
ra 236,214,6144
mvaac 56,224,240
wl 4
ra 240,214,7168
mvavc 232,244,136
wl 4
ra 244,4,8192
mvavc 232,248,140
wl 4
ra 248,4,9216
mvvac 48,64,228
wl 4
mvvac 48,76,232
mvvac 52,68,228
mvvac 52,80,232
mvvac 56,72,228
ra 228,214,8192
mvvac 56,84,232
wl 4
ra 232,214,9216
mvavc 232,236,144
wl 4
ra 236,4,10240
mvavc 232,240,184
wl 4
ra 240,4,11264
mvvac 48,88,244
wl 4
mvvac 48,148,248
mvvac 52,92,244
mvvac 52,156,248
mvvac 56,96,244
ra 244,214,10240
mvvac 56,164,248
wl 4
ra 248,214,11264
mvavc 232,228,188
wl 4
ra 228,4,12288
mvavc 232,232,192
wl 4
ra 232,4,13312
mvvac 48,152,236
wl 4
mvvac 48,180,240
mvvac 52,160,236
mvvac 52,252,240
mvvac 56,168,236
ra 236,4,14336
s_waitcnt vmcnt(15) lgkmcnt(3)
s_barrier
mvvac 56,172,240
ra 240,4,15360
mvavc 232,244,196
ra 244,4,16384
mvavc 232,248,200
ra 248,4,17408
mvaaz 100,60,184
wl 5
mvaac 100,144,228
wl 4
cv 212,232,232
cv 213,233,233
mvaac 100,156,232
dm 1,12,24,0
mvaaz 104,64,184
s_mov_b32 m0, s22
cv 215,234,234
cv 5,235,235
mvaac 104,148,228
mvaac 104,160,232
mvaaz 108,68,184
mvaac 108,152,228
ra 228,4,18432
mvaac 108,164,232
wl 4
ra 232,4,19456
mvaac 100,168,236
wl 4
buffer_store_short v212, v207, s[16:19], 0 offen offset:256
mvaac 100,192,240
mvaac 104,172,236
mvaac 104,196,240
mvaac 108,176,236
ra 236,4,20480
mvaac 108,200,240
wl 4
ra 240,4,21504
mvaac 100,204,244
wl 4
buffer_store_short v213, v207, s[16:19], 0 offen offset:264
mvaac 100,216,248
dm 1,12,24,1024
mvaac 104,208,244
s_mov_b32 m0, s22
mvaac 104,220,248
mvaac 108,212,244
ra 244,4,22528
mvaac 108,224,248
wl 4
ra 248,4,23552
v_add_u32 v4, 0, v1
mvvac 100,64,228
wl 4
buffer_store_short v215, v207, s[16:19], 0 offen offset:272
mvvac 100,76,232
mvvac 104,68,228
mvvac 104,80,232
dm 1,12,24,2048
mvvac 108,72,228
ra 228,2,0
s_mov_b32 m0, s22
mvvac 108,84,232
wl 4
ra 232,2,1024
mvvac 100,88,236
wl 4
buffer_store_short v5, v207, s[16:19], 0 offen offset:280
mvvac 100,148,240
mvvac 104,92,236
mvvac 104,156,240
mvvac 108,96,236
ra 236,2,2048
mvvac 108,164,240
wl 4
ra 240,2,3072
mvvac 100,152,244
wl 4
mvvac 100,180,248
mvvac 104,160,244
dm 1,12,24,3072
mvvac 104,252,248
cv 209,48,100
s_add_u32 m0, s22, 0x1000
mvvac 108,168,244
ra 244,2,4096
cv 211,49,101
mvvac 108,172,248
ra 248,2,5120
cv 245,50,102
mvaaz 36,72,180
wl 5
cv 247,51,103
cv 249,52,104
mvaac 36,144,228
wl 4
cv 251,53,105
cv 25,54,106
mvaac 36,156,232
cv 27,55,107
cv 29,56,108
mvaaz 40,76,180
cv 31,57,109
cv 33,58,110
mvaac 40,148,228
cv 205,59,111
mvaac 40,160,232
buffer_store_dwordx2 v[208:209], v224, s[16:19], 0 offen offset:256
mvaaz 44,80,180
mvaac 44,152,228
ra 228,2,6144
mvaac 44,164,232
wl 4
ra 232,2,7168
mvaac 36,168,236
wl 4
dm 1,12,25,0
mvaac 36,192,240
buffer_store_dwordx2 v[210:211], v225, s[16:19], 0 offen offset:256
mvaac 40,172,236
s_add_u32 m0, s22, 0x1000
s_add_u32 s24, s24, 0x6000
s_add_u32 s22, s23, 0x6000
mvaac 40,196,240
mvaac 44,176,236
ra 236,2,8192
mvaac 44,200,240
wl 4
ra 240,2,9216
mvaac 36,204,244
wl 4
buffer_store_dwordx2 v[244:245], v226, s[16:19], 0 offen offset:256
mvaac 36,216,248
mvaac 40,208,244
mvaac 40,220,248
dm 1,12,25,1024
mvaac 44,212,244
ra 244,2,10240
s_mov_b32 m0, s22
mvaac 44,224,248
wl 4
ra 248,2,11264
s_add_u32 s25, s24, 0x1000
mvvac 36,64,228
wl 4
buffer_store_dwordx2 v[246:247], v227, s[16:19], 0 offen offset:256
mvvac 36,76,232
mvvac 40,68,228
mvvac 40,80,232
wv 14
s_barrier
mvvac 44,72,228
ra 228,2,12288
mvvac 44,84,232
wl 4
ra 232,2,13312
mvvac 36,88,236
wl 4
buffer_store_dwordx2 v[248:249], v228, s[16:19], 0 offen offset:256
mvvac 36,148,240
mvvac 40,92,236
mvvac 40,156,240
buffer_store_dwordx2 v[250:251], v229, s[16:19], 0 offen offset:256
mvvac 44,96,236
ra 236,2,14336
mvvac 44,164,240
wl 4
ra 240,2,15360
mvvac 36,152,244
wl 4
mvvac 36,180,248
mvvac 40,160,244
buffer_store_dwordx2 v[24:25], v230, s[16:19], 0 offen offset:256
mvvac 40,252,248
mvvac 44,168,244
ra 244,2,16384
mvvac 44,172,248
ra 248,2,17408
mvaaz 48,72,184
wl 5
mvaac 48,144,228
wl 4
buffer_store_dwordx2 v[26:27], v231, s[16:19], 0 offen offset:256
mvaac 48,156,232
dm 1,12,24,0
mvaaz 52,76,184
s_mov_b32 m0, s22
mvaac 52,148,228
mvaac 52,160,232
mvaaz 56,80,184
buffer_store_dwordx2 v[28:29], v60, s[16:19], 0 offen offset:256
mvaac 56,152,228
ra 228,2,18432
mvaac 56,164,232
wl 4
ra 232,2,19456
mvaac 48,168,236
wl 4
mvaac 48,192,240
mvaac 52,172,236
buffer_store_dwordx2 v[30:31], v61, s[16:19], 0 offen offset:256
mvaac 52,196,240
mvaac 56,176,236
ra 236,2,20480
mvaac 56,200,240
wl 4
ra 240,2,21504
mvaac 48,204,244
wl 4
dm 1,12,24,1024
mvaac 48,216,248
buffer_store_dwordx2 v[32:33], v62, s[16:19], 0 offen offset:256
mvaac 52,208,244
s_mov_b32 m0, s22
mvaac 52,220,248
mvaac 56,212,244
ra 244,2,22528
mvaac 56,224,248
wl 4
ra 248,2,23552
v_add_u32 v2, 0x6000, v1
mvvac 48,64,228
wl 4
buffer_store_dwordx2 v[204:205], v63, s[16:19], 0 offen offset:256
mvvac 48,76,232
mvvac 52,68,228
mvvac 52,80,232
dm 1,12,24,2048
mvvac 56,72,228
ra 228,3,0
s_mov_b32 m0, s22
mvvac 56,84,232
wl 4
ra 232,3,1024
mvvac 48,88,236
wl 4
mvvac 48,148,240
mvvac 52,92,236
mvvac 52,156,240
mvvac 56,96,236
mvvac 56,164,240
wl 3
mvvac 48,152,244
wl 2
mvvac 48,180,248
mvvac 52,160,244
dm 1,12,24,3072
mvvac 52,252,248
s_add_u32 m0, s22, 0x1000
s_cmp_ge_u32 s20, 2
s_cselect_b32 s37, 0x12000, s38
mvvac 56,168,244
ra 244,3,2048
s_add_u32 s37, s37, s72
mvvac 56,172,248
ra 248,3,3072
v_add_u32 v214, s37, v1
mvaaz 100,84,180
wl 3
ra 236,214,0
cv 208,36,48
mvaac 100,144,228
wl 3
ra 240,214,1024
cv 210,37,49
mvaac 100,156,232
cv 244,38,50
cv 246,39,51
mvaaz 104,88,180
cv 248,40,52
cv 250,41,53
mvaac 104,148,228
cv 24,42,54
cv 26,43,55
mvaac 104,160,232
cv 28,44,56
cv 30,45,57
mvaaz 108,92,180
cv 32,46,58
cv 204,47,59
mvaac 108,152,228
ra 228,214,2048
s_mov_b32 s38, 0
mvaac 108,164,232
ra 232,214,3072
mvvvz 232,8,240
wl 3
dm 1,12,25,0
mvavc 232,236,120
wl 2
ra 236,3,4096
s_add_u32 m0, s22, 0x1000
mvavc 232,240,124
ra 240,3,5120
s_add_u32 s24, s24, 0x6000
mvaac 100,168,244
s_add_u32 s22, s23, 0xc000
mvaac 100,192,248
mvaac 104,172,244
mvaac 104,196,248
mvaac 108,176,244
ra 244,214,4096
mvaac 108,200,248
wl 4
ra 248,214,5120
mvavc 232,228,128
wl 4
ra 228,3,6144
mvavc 232,232,132
wl 4
ra 232,3,7168
mvaac 100,204,236
wl 4
dm 1,12,25,1024
mvaac 100,216,240
s_mov_b32 m0, s22
s_add_u32 s25, s24, 0x1000
mvaac 104,208,236
mvaac 104,220,240
mvaac 108,212,236
ra 236,214,6144
mvaac 108,224,240
wl 4
ra 240,214,7168
mvavc 232,244,136
wl 4
ra 244,3,8192
mvavc 232,248,140
wl 4
ra 248,3,9216
mvvac 100,64,228
wl 4
mvvac 100,76,232
mvvac 104,68,228
mvvac 104,80,232
mvvac 108,72,228
ra 228,214,8192
mvvac 108,84,232
wl 4
ra 232,214,9216
mvavc 232,236,144
wl 4
ra 236,3,10240
mvavc 232,240,184
wl 4
ra 240,3,11264
mvvac 100,88,244
wl 4
mvvac 100,148,248
mvvac 104,92,244
mvvac 104,156,248
mvvac 108,96,244
ra 244,214,10240
mvvac 108,164,248
wl 4
ra 248,214,11264
mvavc 232,228,188
wl 4
ra 228,3,12288
mvavc 232,232,192
wl 4
ra 232,3,13312
mvvac 100,152,236
wl 4
mvvac 100,180,240
mvvac 104,160,236
mvvac 104,252,240
mvvac 108,168,236
ra 236,3,14336
s_waitcnt vmcnt(15) lgkmcnt(3)
s_barrier
mvvac 108,172,240
ra 240,3,15360
mvavc 232,244,196
ra 244,3,16384
mvavc 232,248,200
ra 248,3,17408
mvaaz 36,84,184
wl 5
mvaac 36,144,228
wl 4
cv 212,232,232
cv 213,233,233
mvaac 36,156,232
dm 1,12,24,0
mvaaz 40,88,184
s_mov_b32 m0, s22
cv 215,234,234
cv 5,235,235
mvaac 40,148,228
mvaac 40,160,232
mvaaz 44,92,184
mvaac 44,152,228
ra 228,3,18432
mvaac 44,164,232
wl 4
ra 232,3,19456
mvaac 36,168,236
wl 4
buffer_store_short v212, v207, s[16:19], 0 offen offset:384
mvaac 36,192,240
mvaac 40,172,236
mvaac 40,196,240
mvaac 44,176,236
ra 236,3,20480
mvaac 44,200,240
wl 4
ra 240,3,21504
mvaac 36,204,244
wl 4
buffer_store_short v213, v207, s[16:19], 0 offen offset:392
mvaac 36,216,248
dm 1,12,24,1024
mvaac 40,208,244
s_mov_b32 m0, s22
mvaac 40,220,248
mvaac 44,212,244
ra 244,3,22528
mvaac 44,224,248
wl 4
ra 248,3,23552
v_add_u32 v3, 0xc000, v1
mvvac 36,64,228
wl 4
buffer_store_short v215, v207, s[16:19], 0 offen offset:400
mvvac 36,76,232
mvvac 40,68,228
mvvac 40,80,232
dm 1,12,24,2048
mvvac 44,72,228
ra 228,4,0
s_mov_b32 m0, s22
mvvac 44,84,232
wl 4
ra 232,4,1024
mvvac 36,88,236
wl 4
buffer_store_short v5, v207, s[16:19], 0 offen offset:408
mvvac 36,148,240
mvvac 40,92,236
mvvac 40,156,240
mvvac 44,96,236
ra 236,4,2048
mvvac 44,164,240
wl 4
ra 240,4,3072
mvvac 36,152,244
wl 4
mvvac 36,180,248
mvvac 40,160,244
dm 1,12,24,3072
mvvac 40,252,248
cv 209,100,36
s_add_u32 m0, s22, 0x1000
mvvac 44,168,244
ra 244,4,4096
cv 211,101,37
mvvac 44,172,248
ra 248,4,5120
cv 245,102,38
mvaaz 48,96,180
wl 5
cv 247,103,39
cv 249,104,40
mvaac 48,144,228
wl 4
cv 251,105,41
cv 25,106,42
mvaac 48,156,232
cv 27,107,43
cv 29,108,44
mvaaz 52,100,180
cv 31,109,45
cv 33,110,46
mvaac 52,148,228
cv 205,111,47
mvaac 52,160,232
buffer_store_dwordx2 v[208:209], v224, s[16:19], 0 offen offset:384
mvaaz 56,104,180
mvaac 56,152,228
ra 228,4,6144
mvaac 56,164,232
wl 4
ra 232,4,7168
mvaac 48,168,236
wl 4
dm 1,12,25,0
mvaac 48,192,240
buffer_store_dwordx2 v[210:211], v225, s[16:19], 0 offen offset:384
mvaac 52,172,236
s_add_u32 m0, s22, 0x1000
s_add_u32 s24, s24, 0x6000
s_add_u32 s22, s23, 0x12000
mvaac 52,196,240
mvaac 56,176,236
ra 236,4,8192
mvaac 56,200,240
wl 4
ra 240,4,9216
mvaac 48,204,244
wl 4
buffer_store_dwordx2 v[244:245], v226, s[16:19], 0 offen offset:384
mvaac 48,216,248
mvaac 52,208,244
mvaac 52,220,248
dm 1,12,25,1024
mvaac 56,212,244
ra 244,4,10240
s_mov_b32 m0, s22
mvaac 56,224,248
wl 4
ra 248,4,11264
s_add_u32 s25, s24, 0x1000
mvvac 48,64,228
wl 4
buffer_store_dwordx2 v[246:247], v227, s[16:19], 0 offen offset:384
mvvac 48,76,232
mvvac 52,68,228
mvvac 52,80,232
wv 14
s_barrier
mvvac 56,72,228
ra 228,4,12288
mvvac 56,84,232
wl 4
ra 232,4,13312
mvvac 48,88,236
wl 4
buffer_store_dwordx2 v[248:249], v228, s[16:19], 0 offen offset:384
mvvac 48,148,240
mvvac 52,92,236
mvvac 52,156,240
buffer_store_dwordx2 v[250:251], v229, s[16:19], 0 offen offset:384
mvvac 56,96,236
ra 236,4,14336
mvvac 56,164,240
wl 4
ra 240,4,15360
mvvac 48,152,244
wl 4
mvvac 48,180,248
mvvac 52,160,244
buffer_store_dwordx2 v[24:25], v230, s[16:19], 0 offen offset:384
mvvac 52,252,248
mvvac 56,168,244
ra 244,4,16384
mvvac 56,172,248
ra 248,4,17408
mvaaz 100,96,184
wl 5
mvaac 100,144,228
wl 4
buffer_store_dwordx2 v[26:27], v231, s[16:19], 0 offen offset:384
mvaac 100,156,232
dm 1,12,24,0
mvaaz 104,100,184
s_mov_b32 m0, s22
mvaac 104,148,228
mvaac 104,160,232
mvaaz 108,104,184
buffer_store_dwordx2 v[28:29], v60, s[16:19], 0 offen offset:384
mvaac 108,152,228
ra 228,4,18432
mvaac 108,164,232
wl 4
ra 232,4,19456
mvaac 100,168,236
wl 4
mvaac 100,192,240
mvaac 104,172,236
buffer_store_dwordx2 v[30:31], v61, s[16:19], 0 offen offset:384
mvaac 104,196,240
mvaac 108,176,236
ra 236,4,20480
mvaac 108,200,240
wl 4
ra 240,4,21504
mvaac 100,204,244
wl 4
dm 1,12,24,1024
mvaac 100,216,248
buffer_store_dwordx2 v[32:33], v62, s[16:19], 0 offen offset:384
mvaac 104,208,244
s_mov_b32 m0, s22
mvaac 104,220,248
mvaac 108,212,244
ra 244,4,22528
mvaac 108,224,248
wl 4
ra 248,4,23552
v_add_u32 v4, 0x12000, v1
mvvac 100,64,228
wl 4
buffer_store_dwordx2 v[204:205], v63, s[16:19], 0 offen offset:384
mvvac 100,76,232
mvvac 104,68,228
mvvac 104,80,232
dm 1,12,24,2048
mvvac 108,72,228
ra 228,2,0
s_mov_b32 m0, s22
mvvac 108,84,232
wl 4
ra 232,2,1024
mvvac 100,88,236
wl 4
mvvac 100,148,240
mvvac 104,92,236
mvvac 104,156,240
mvvac 108,96,236
mvvac 108,164,240
wl 3
mvvac 100,152,244
wl 2
mvvac 100,180,248
mvvac 104,160,244
dm 1,12,24,3072
mvvac 104,252,248
s_add_u32 m0, s22, 0x1000
s_cmp_ge_u32 s20, 2
s_cselect_b32 s37, 0x6000, s38
mvvac 108,168,244
ra 244,2,2048
s_add_u32 s37, s37, s72
mvvac 108,172,248
ra 248,2,3072
v_add_u32 v214, s37, v1
mvaaz 36,108,180
wl 3
ra 236,214,0
cv 208,48,100
mvaac 36,144,228
wl 3
ra 240,214,1024
cv 210,49,101
mvaac 36,156,232
cv 244,50,102
cv 246,51,103
mvaaz 40,112,180
cv 248,52,104
cv 250,53,105
mvaac 40,148,228
cv 24,54,106
cv 26,55,107
mvaac 40,160,232
cv 28,56,108
cv 30,57,109
mvaaz 44,116,180
cv 32,58,110
cv 204,59,111
mvaac 44,152,228
ra 228,214,2048
s_mov_b32 s38, 0xc000
mvaac 44,164,232
ra 232,214,3072
mvvvz 232,8,12
wl 3
dm 1,12,25,0
mvavc 232,236,120
wl 2
ra 236,2,4096
s_add_u32 m0, s22, 0x1000
mvavc 232,240,124
ra 240,2,5120
s_add_u32 s24, s24, 0x6000
mvaac 36,168,244
s_cmp_ge_u32 s20, 2
s_cselect_b32 s37, 0x12000, s38
s_add_u32 s37, s37, s72
mvaac 36,192,248
mvaac 40,172,244
mvaac 40,196,248
mvaac 44,176,244
ra 244,214,4096
mvaac 44,200,248
wl 4
ra 248,214,5120
mvavc 232,228,128
wl 4
ra 228,2,6144
mvavc 232,232,132
wl 4
ra 232,2,7168
mvaac 36,204,236
wl 4
dm 1,12,25,1024
mvaac 36,216,240
mvaac 40,208,236
mvaac 40,220,240
mvaac 44,212,236
ra 236,214,6144
mvaac 44,224,240
wl 4
ra 240,214,7168
mvavc 232,244,136
wl 4
ra 244,2,8192
mvavc 232,248,140
wl 4
ra 248,2,9216
mvvac 36,64,228
wl 4
mvvac 36,76,232
mvvac 40,68,228
mvvac 40,80,232
mvvac 44,72,228
ra 228,214,8192
mvvac 44,84,232
wl 4
ra 232,214,9216
mvavc 232,236,144
wl 4
ra 236,2,10240
mvavc 232,240,184
wl 4
ra 240,2,11264
mvvac 36,88,244
wl 4
mvvac 36,148,248
mvvac 40,92,244
mvvac 40,156,248
mvvac 44,96,244
ra 244,214,10240
mvvac 44,164,248
wl 4
ra 248,214,11264
v_add_u32 v214, s37, v1
mvavc 232,228,188
wl 4
ra 228,2,12288
mvavc 232,232,192
wl 4
ra 232,2,13312
mvvac 36,152,236
wl 4
mvvac 36,180,240
mvvac 40,160,236
mvvac 40,252,240
mvvac 44,168,236
ra 236,2,14336
s_waitcnt vmcnt(15) lgkmcnt(3)
s_barrier
mvvac 44,172,240
ra 240,2,15360
mvavc 232,244,196
ra 244,2,16384
mvavc 232,248,200
ra 248,2,17408
mvaaz 48,108,184
wl 5
mvaac 48,144,228
wl 4
cv 212,232,232
cv 213,233,233
mvaac 48,156,232
cv 215,234,234
cv 5,235,235
mvaaz 52,112,184
mvaac 52,148,228
mvaac 52,160,232
mvaaz 56,116,184
mvaac 56,152,228
ra 228,2,18432
mvaac 56,164,232
wl 4
ra 232,2,19456
mvaac 48,168,236
wl 4
buffer_store_short v212, v207, s[16:19], 0 offen offset:512
mvaac 48,192,240
mvaac 52,172,236
mvaac 52,196,240
mvaac 56,176,236
ra 236,2,20480
mvaac 56,200,240
wl 4
ra 240,2,21504
mvaac 48,204,244
wl 4
buffer_store_short v213, v207, s[16:19], 0 offen offset:520
mvaac 48,216,248
mvaac 52,208,244
mvaac 52,220,248
mvaac 56,212,244
ra 244,2,22528
mvaac 56,224,248
wl 4
ra 248,2,23552
mvvac 48,64,228
wl 4
buffer_store_short v215, v207, s[16:19], 0 offen offset:528
mvvac 48,76,232
mvvac 52,68,228
mvvac 52,80,232
mvvac 56,72,228
ra 228,3,0
mvvac 56,84,232
wl 4
ra 232,3,1024
mvvac 48,88,236
wl 4
buffer_store_short v5, v207, s[16:19], 0 offen offset:536
mvvac 48,148,240
mvvac 52,92,236
mvvac 52,156,240
mvvac 56,96,236
ra 236,3,2048
mvvac 56,164,240
wl 4
ra 240,3,3072
mvvac 48,152,244
wl 4
mvvac 48,180,248
mvvac 52,160,244
mvvac 52,252,248
cv 209,36,48
cv 211,37,49
mvvac 56,168,244
ra 244,3,4096
cv 245,38,50
mvvac 56,172,248
ra 248,3,5120
cv 247,39,51
mvaaz 100,120,180
wl 5
cv 249,40,52
cv 251,41,53
mvaac 100,144,228
wl 4
cv 25,42,54
cv 27,43,55
mvaac 100,156,232
cv 29,44,56
cv 31,45,57
mvaaz 104,124,180
cv 33,46,58
cv 205,47,59
mvaac 104,148,228
mvaac 104,160,232
buffer_store_dwordx2 v[208:209], v224, s[16:19], 0 offen offset:512
mvaaz 108,128,180
mvaac 108,152,228
ra 228,3,6144
mvaac 108,164,232
wl 4
ra 232,3,7168
mvaac 100,168,236
wl 4
mvaac 100,192,240
buffer_store_dwordx2 v[210:211], v225, s[16:19], 0 offen offset:512
mvaac 104,172,236
mvaac 104,196,240
mvaac 108,176,236
ra 236,3,8192
mvaac 108,200,240
wl 4
ra 240,3,9216
mvaac 100,204,244
wl 4
buffer_store_dwordx2 v[244:245], v226, s[16:19], 0 offen offset:512
mvaac 100,216,248
mvaac 104,208,244
mvaac 104,220,248
mvaac 108,212,244
ra 244,3,10240
mvaac 108,224,248
wl 4
ra 248,3,11264
mvvac 100,64,228
wl 4
buffer_store_dwordx2 v[246:247], v227, s[16:19], 0 offen offset:512
mvvac 100,76,232
mvvac 104,68,228
mvvac 104,80,232
wv 8
s_barrier
mvvac 108,72,228
ra 228,3,12288
mvvac 108,84,232
wl 4
ra 232,3,13312
mvvac 100,88,236
wl 4
buffer_store_dwordx2 v[248:249], v228, s[16:19], 0 offen offset:512
mvvac 100,148,240
mvvac 104,92,236
mvvac 104,156,240
buffer_store_dwordx2 v[250:251], v229, s[16:19], 0 offen offset:512
mvvac 108,96,236
ra 236,3,14336
mvvac 108,164,240
wl 4
ra 240,3,15360
mvvac 100,152,244
wl 4
mvvac 100,180,248
mvvac 104,160,244
buffer_store_dwordx2 v[24:25], v230, s[16:19], 0 offen offset:512
mvvac 104,252,248
mvvac 108,168,244
ra 244,3,16384
mvvac 108,172,248
ra 248,3,17408
mvaaz 36,120,184
wl 5
mvaac 36,144,228
wl 4
buffer_store_dwordx2 v[26:27], v231, s[16:19], 0 offen offset:512
mvaac 36,156,232
mvaaz 40,124,184
mvaac 40,148,228
mvaac 40,160,232
mvaaz 44,128,184
buffer_store_dwordx2 v[28:29], v60, s[16:19], 0 offen offset:512
mvaac 44,152,228
ra 228,3,18432
mvaac 44,164,232
wl 4
ra 232,3,19456
mvaac 36,168,236
wl 4
mvaac 36,192,240
mvaac 40,172,236
buffer_store_dwordx2 v[30:31], v61, s[16:19], 0 offen offset:512
mvaac 40,196,240
mvaac 44,176,236
ra 236,3,20480
mvaac 44,200,240
wl 4
ra 240,3,21504
mvaac 36,204,244
wl 4
mvaac 36,216,248
buffer_store_dwordx2 v[32:33], v62, s[16:19], 0 offen offset:512
mvaac 40,208,244
mvaac 40,220,248
mvaac 44,212,244
ra 244,3,22528
mvaac 44,224,248
wl 4
ra 248,3,23552
mvvac 36,64,228
wl 4
buffer_store_dwordx2 v[204:205], v63, s[16:19], 0 offen offset:512
mvvac 36,76,232
mvvac 40,68,228
mvvac 40,80,232
mvvac 44,72,228
ra 228,4,0
mvvac 44,84,232
wl 4
ra 232,4,1024
mvvac 36,88,236
wl 4
mvvac 36,148,240
mvvac 40,92,236
mvvac 40,156,240
mvvac 44,96,236
ra 236,214,0
mvvac 44,164,240
wl 4
ra 240,214,1024
mvvac 36,152,244
wl 4
mvvac 36,180,248
mvvac 40,160,244
mvvac 40,252,248
cv 208,100,36
cv 210,101,37
mvvac 44,168,244
ra 244,4,2048
cv 244,102,38
mvvac 44,172,248
ra 248,4,3072
cv 246,103,39
mvaaz 48,132,180
wl 5
cv 248,104,40
cv 250,105,41
mvaac 48,144,228
wl 4
cv 24,106,42
cv 26,107,43
mvaac 48,156,232
cv 28,108,44
cv 30,109,45
mvaaz 52,136,180
cv 32,110,46
cv 204,111,47
mvaac 52,148,228
mvaac 52,160,232
mvaaz 56,140,180
mvaac 56,152,228
ra 228,214,2048
mvaac 56,164,232
ra 232,214,3072
mvvvz 232,8,16
wl 5
mvavc 232,236,120
wl 4
ra 236,4,4096
mvavc 232,240,124
wl 4
ra 240,4,5120
mvaac 48,168,244
wl 4
mvaac 48,192,248
mvaac 52,172,244
mvaac 52,196,248
mvaac 56,176,244
ra 244,214,4096
mvaac 56,200,248
wl 4
ra 248,214,5120
mvavc 232,228,128
wl 4
ra 228,4,6144
mvavc 232,232,132
wl 4
ra 232,4,7168
mvaac 48,204,236
wl 4
mvaac 48,216,240
mvaac 52,208,236
mvaac 52,220,240
mvaac 56,212,236
ra 236,214,6144
mvaac 56,224,240
wl 4
ra 240,214,7168
mvavc 232,244,136
wl 4
ra 244,4,8192
mvavc 232,248,140
wl 4
ra 248,4,9216
mvvac 48,64,228
wl 4
mvvac 48,76,232
mvvac 52,68,228
mvvac 52,80,232
mvvac 56,72,228
ra 228,214,8192
mvvac 56,84,232
wl 4
ra 232,214,9216
mvavc 232,236,144
wl 4
ra 236,4,10240
mvavc 232,240,184
wl 4
ra 240,4,11264
mvvac 48,88,244
wl 4
mvvac 48,148,248
mvvac 52,92,244
mvvac 52,156,248
mvvac 56,96,244
ra 244,214,10240
mvvac 56,164,248
wl 4
ra 248,214,11264
mvavc 232,228,188
wl 4
ra 228,4,12288
mvavc 232,232,192
wl 4
ra 232,4,13312
mvvac 48,152,236
wl 4
mvvac 48,180,240
mvvac 52,160,236
mvvac 52,252,240
mvvac 56,168,236
ra 236,4,14336
mvvac 56,172,240
wl 4
ra 240,4,15360
mvavc 232,244,196
wl 4
ra 244,4,16384
mvavc 232,248,200
ra 248,4,17408
mvaaz 100,132,184
wl 5
mvaac 100,144,228
wl 4
cv 212,232,232
cv 213,233,233
mvaac 100,156,232
cv 215,234,234
cv 5,235,235
mvaaz 104,136,184
mvaac 104,148,228
mvaac 104,160,232
mvaaz 108,140,184
mvaac 108,152,228
ra 228,4,18432
mvaac 108,164,232
wl 4
ra 232,4,19456
mvaac 100,168,236
wl 4
buffer_store_short v212, v207, s[16:19], 0 offen offset:640
mvaac 100,192,240
mvaac 104,172,236
mvaac 104,196,240
mvaac 108,176,236
ra 236,4,20480
mvaac 108,200,240
wl 4
ra 240,4,21504
mvaac 100,204,244
wl 4
buffer_store_short v213, v207, s[16:19], 0 offen offset:648
mvaac 100,216,248
mvaac 104,208,244
mvaac 104,220,248
mvaac 108,212,244
ra 244,4,22528
mvaac 108,224,248
wl 4
ra 248,4,23552
mvvac 100,64,228
wl 4
buffer_store_short v215, v207, s[16:19], 0 offen offset:656
mvvac 100,76,232
mvvac 104,68,228
mvvac 104,80,232
mvvac 108,72,228
buffer_store_short v5, v207, s[16:19], 0 offen offset:664
mvvac 108,84,232
wl 3
mvvac 100,88,236
wl 2
mvvac 100,148,240
mvvac 104,92,236
mvvac 104,156,240
mvvac 108,96,236
mvvac 108,164,240
wl 1
mvvac 100,152,244
wl 0
mvvac 100,180,248
mvvac 104,160,244
mvvac 104,252,248
cv 209,48,100
cv 211,49,101
mvvac 108,168,244
buffer_store_dwordx2 v[208:209], v224, s[16:19], 0 offen offset:640
mvvac 108,172,248
buffer_store_dwordx2 v[210:211], v225, s[16:19], 0 offen offset:640
cv 245,50,102
cv 247,51,103
cv 249,52,104
cv 251,53,105
cv 25,54,106
cv 27,55,107
s_nop 0
cv 29,56,108
cv 31,57,109
cv 33,58,110
cv 205,59,111
buffer_store_dwordx2 v[244:245], v226, s[16:19], 0 offen offset:640
buffer_store_dwordx2 v[246:247], v227, s[16:19], 0 offen offset:640
buffer_store_dwordx2 v[248:249], v228, s[16:19], 0 offen offset:640
buffer_store_dwordx2 v[250:251], v229, s[16:19], 0 offen offset:640
buffer_store_dwordx2 v[24:25], v230, s[16:19], 0 offen offset:640
buffer_store_dwordx2 v[26:27], v231, s[16:19], 0 offen offset:640
buffer_store_dwordx2 v[28:29], v60, s[16:19], 0 offen offset:640
buffer_store_dwordx2 v[30:31], v61, s[16:19], 0 offen offset:640
buffer_store_dwordx2 v[32:33], v62, s[16:19], 0 offen offset:640
buffer_store_dwordx2 v[204:205], v63, s[16:19], 0 offen offset:640
L_end:
s_endpgm
L_codeend:
s_endpgm
.section .rodata,"a"
.p2align 6
.amdhsa_kernel standalone__window_attn_davit__vision_kernel
  .amdhsa_next_free_vgpr 512
  .amdhsa_next_free_sgpr 102
  .amdhsa_accum_offset 256
  .amdhsa_group_segment_fixed_size 0
  .amdhsa_kernarg_size 56
  .amdhsa_user_sgpr_count 2
  .amdhsa_user_sgpr_kernarg_segment_ptr 1
  .amdhsa_system_sgpr_workgroup_id_x 1
  .amdhsa_float_denorm_mode_32 3
.end_amdhsa_kernel
```
